```python
import torch

def _softmax(x, axis=-1):
    return torch.softmax(x, dim=axis)

def _gelu(x):
    return torch.nn.functional.gelu(x, approximate='tanh')

def _silu(x):
    return torch.nn.functional.silu(x)

def _sigmoid(x):
    return torch.sigmoid(x)

def _layernorm(x, axis=-1, eps=1e-05):
    m = x.mean(dim=axis, keepdim=True)
    v = x.var(dim=axis, keepdim=True, unbiased=False)
    return (x - m) / torch.sqrt(v + eps)

def _scatter_add(tgt, idx, src, axis=0):
    return tgt.clone().index_add_(axis, idx, src)

def _segment_sum(src, seg, n):
    out = torch.zeros((n,) + src.shape[1:], dtype=src.dtype)
    return out.index_add_(0, seg, src)

def _pad(x, pw):
    flat = tuple((v for pair in reversed(pw) for v in pair))
    return torch.nn.functional.pad(x, flat)
kernel_name = 'adaLN_cond__grouped_kv_mqa__swiglu_ffn__prompt'

def setup_inputs():

    _w = lambda a: (lambda t: t.to(torch.bfloat16) if t.is_floating_point() else t)(torch.as_tensor(a))

    def _A_setup():
        B, S, D, H = (1, 2048, 512, 32)
        Dh = D // H
        return {'x': _w((lambda *s: torch.randn(*s, dtype=torch.bfloat16) * 0.05)(B, S, D)), 'wq': _w((lambda *s: torch.randn(*s, dtype=torch.bfloat16) * 0.05)(D, H * Dh)), 'wk': _w((lambda *s: torch.randn(*s, dtype=torch.bfloat16) * 0.05)(D, Dh)), 'wv': _w((lambda *s: torch.randn(*s, dtype=torch.bfloat16) * 0.05)(D, Dh)), 'wo': _w((lambda *s: torch.randn(*s, dtype=torch.bfloat16) * 0.05)(H * Dh, D))}
    _A_in = _A_setup()

    def _B_setup():
        B, S, D, F = (1, 2048, 512, 1792)
        return {'x': _w((lambda *s: torch.randn(*s, dtype=torch.bfloat16) * 0.05)(B, S, D)), 'w_gate': _w((lambda *s: torch.randn(*s, dtype=torch.bfloat16) * 0.05)(D, F)), 'w_up': _w((lambda *s: torch.randn(*s, dtype=torch.bfloat16) * 0.05)(D, F)), 'w_down': _w((lambda *s: torch.randn(*s, dtype=torch.bfloat16) * 0.05)(F, D))}
    _B_in = _B_setup()
    return {'A_x': _A_in['x'], 'A_wq': _A_in['wq'], 'A_wk': _A_in['wk'], 'A_wv': _A_in['wv'], 'A_wo': _A_in['wo'], 'B_x': _B_in['x'], 'B_w_gate': _B_in['w_gate'], 'B_w_up': _B_in['w_up'], 'B_w_down': _B_in['w_down'], 'c': _w((lambda *s: torch.randn(*s, dtype=torch.bfloat16) * 0.1)(1, 512) * 8.0), 'w_mod': _w((lambda *s: torch.randn(*s, dtype=torch.bfloat16) * 0.1)(512, 6 * 512) * 512 ** (-0.5) * 8.0)}

def reference(A_x, A_wq, A_wk, A_wv, A_wo, B_x, B_w_gate, B_w_up, B_w_down, c, w_mod):

    def _A_ref(x, wq, wk, wv, wo):
        B, S, D = x.shape
        H = 32
        Dh = D // H
        q = (lambda x, *d: x.permute(*d))((x @ wq).reshape(B, S, H, Dh), 0, 2, 1, 3)
        k = x @ wk
        v = x @ wv
        scores = torch.einsum('bhqd,bkd->bhqk', q, k) * Dh ** (-0.5)
        p = _softmax(scores, axis=-1)
        o = torch.einsum('bhqk,bkd->bhqd', p, v)
        return (lambda x, *d: x.permute(*d))(o, 0, 2, 1, 3).reshape(B, S, H * Dh) @ wo

    def _B_ref(x, w_gate, w_up, w_down):
        g = _silu(x @ w_gate)
        u = x @ w_up
        return g * u @ w_down
    x = A_x
    mod = (_silu(c) @ w_mod).reshape(c.shape[0], 6, 1, -1)
    sa, ca, ga, sb, cb, gb = (mod[:, 0].clone(), mod[:, 1].clone(), mod[:, 2].clone(), mod[:, 3].clone(), mod[:, 4].clone(), mod[:, 5].clone())
    h = _layernorm(x, axis=-1) * (1 + ca) + sa
    x = x + ga * _A_ref(h, A_wq, A_wk, A_wv, A_wo)
    h = _layernorm(x, axis=-1) * (1 + cb) + sb
    x = x + gb * _B_ref(h, B_w_gate, B_w_up, B_w_down)
    return x
```

```asm
; @launch grid=(256,1,1) block=(256,1,1) lds=163840
.amdgcn_target "amdgcn-amd-amdhsa--gfx950"
.text
.globl adaLN_cond__grouped_kv_mqa__swiglu_ffn__prompt_kernel
.p2align 8
.type adaLN_cond__grouped_kv_mqa__swiglu_ffn__prompt_kernel,@function
adaLN_cond__grouped_kv_mqa__swiglu_ffn__prompt_kernel:
  s_cmp_ge_u32 s2, 256
  s_cbranch_scc1 L_END
  s_load_dwordx16 s[4:19], s[0:1], 0
  s_load_dwordx8 s[20:27], s[0:1], 64
  s_load_dwordx4 s[28:31], s[0:1], 96
  s_getpc_b64 s[98:99]
  v_lshrrev_b32 v2, 6, v0
  v_and_b32 v1, 63, v0
  v_readfirstlane_b32 s32, v2
  s_lshr_b32 s34, s2, 3
  v_lshlrev_b32 v3, 5, v1
  v_add_u32 v3, s34, v3
  v_lshlrev_b32 v3, 6, v3
  s_cmp_lg_u32 s32, 0
  s_cbranch_scc1 L_nopf
  v_cmp_gt_u32 vcc, L_CODE_END-adaLN_cond__grouped_kv_mqa__swiglu_ffn__prompt_kernel-256, v3
  s_and_saveexec_b64 s[40:41], vcc
  s_cbranch_execz L_pfskip
  global_load_dword v255, v3, s[98:99]
L_pfskip:
  s_mov_b64 exec, -1
L_nopf:
  s_and_b32 s33, s2, 7
  s_lshr_b32 s35, s34, 3
  s_lshl_b32 s40, s33, 2
  s_add_u32 s35, s35, s40
  s_and_b32 s36, s34, 7
  s_mov_b32 s95, s36
  s_lshr_b32 s37, s34, 4
  s_lshl_b32 s40, s33, 1
  s_add_u32 s37, s37, s40
  s_and_b32 s38, s34, 15
  v_lshlrev_b32 v2, 4, v1
  s_waitcnt lgkmcnt(0)
  s_cmp_eq_u32 s36, 3
  s_cselect_b32 s95, 7, s95
  s_cmp_eq_u32 s36, 7
  s_cselect_b32 s95, 3, s95
  s_or_b32 s40, s2, s32
  s_cmp_lg_u32 s40, 0
  s_cbranch_scc1 L_non_1
  s_memrealtime s[42:43]
  s_waitcnt lgkmcnt(0)
  s_or_b32 s40, s42, 1
  v_mov_b32 v8, s40
  v_mov_b32 v9, 0
  s_mov_b64 exec, 1
  global_store_dword v9, v8, s[28:29] sc1
  s_mov_b64 exec, -1
L_non_1:
  s_cmp_lg_u32 s36, 4
  s_cbranch_scc1 L_nomod_2
  s_cmp_lg_u32 s32, 0
  s_cbranch_scc1 L_nz0_5
  v_lshlrev_b32 v10, 12, v1
  s_lshl_b32 s40, s35, 7
  v_add_u32 v10, s40, v10
  v_mov_b32 v11, 0
  s_mov_b64 exec, 0x3f
  global_store_dword v10, v11, s[30:31] sc1
  s_mov_b64 exec, -1
  v_lshlrev_b32 v10, 7, v1
  s_lshl_b32 s40, s35, 8
  s_add_u32 s40, s40, 24576
  v_add_u32 v10, s40, v10
  s_mov_b64 exec, 3
  global_store_dword v10, v11, s[30:31] sc1
  s_mov_b64 exec, -1
L_nz0_5:
  s_sub_u32 s76, s36, 4
  s_lshl_b32 s76, s76, 10
  s_lshl_b32 s40, s35, 5
  s_add_u32 s76, s76, s40
  s_lshl_b32 s40, s76, 1
  s_add_u32 s98, s24, s40
  s_addc_u32 s99, s25, 0
  v_lshrrev_b32 v8, 2, v0
  v_and_b32 v9, 3, v0
  v_lshlrev_b32 v10, 4, v8
  global_load_dwordx4 v[48:51], v10, s[22:23]
  v_mul_u32_u24 v10, 49152, v8
  v_lshl_add_u32 v10, v9, 4, v10
  global_load_dwordx4 v[16:19], v10, s[98:99]
  v_add_u32 v10, 6144, v10
  global_load_dwordx4 v[20:23], v10, s[98:99]
  v_add_u32 v10, 6144, v10
  global_load_dwordx4 v[24:27], v10, s[98:99]
  v_add_u32 v10, 6144, v10
  global_load_dwordx4 v[28:31], v10, s[98:99]
  v_add_u32 v10, 6144, v10
  global_load_dwordx4 v[32:35], v10, s[98:99]
  v_add_u32 v10, 6144, v10
  global_load_dwordx4 v[36:39], v10, s[98:99]
  v_add_u32 v10, 6144, v10
  global_load_dwordx4 v[40:43], v10, s[98:99]
  v_add_u32 v10, 6144, v10
  global_load_dwordx4 v[44:47], v10, s[98:99]
  s_waitcnt vmcnt(8)
  v_mov_b32 v5, 0
  global_load_dword v6, v5, s[28:29] sc1
  v_lshlrev_b32 v52, 16, v48
  v_and_b32 v53, 0xffff0000, v48
  v_lshlrev_b32 v54, 16, v49
  v_and_b32 v55, 0xffff0000, v49
  v_lshlrev_b32 v56, 16, v50
  v_and_b32 v57, 0xffff0000, v50
  v_lshlrev_b32 v58, 16, v51
  v_and_b32 v59, 0xffff0000, v51
  v_mul_f32 v68, 0xbfb8aa3b, v52
  v_mul_f32 v69, 0xbfb8aa3b, v53
  v_mul_f32 v70, 0xbfb8aa3b, v54
  v_mul_f32 v71, 0xbfb8aa3b, v55
  v_mul_f32 v72, 0xbfb8aa3b, v56
  v_mul_f32 v73, 0xbfb8aa3b, v57
  v_mul_f32 v74, 0xbfb8aa3b, v58
  v_mul_f32 v75, 0xbfb8aa3b, v59
  v_exp_f32 v68, v68
  v_exp_f32 v69, v69
  v_exp_f32 v70, v70
  v_exp_f32 v71, v71
  v_exp_f32 v72, v72
  v_exp_f32 v73, v73
  v_exp_f32 v74, v74
  v_exp_f32 v75, v75
  v_add_f32 v68, 1.0, v68
  v_add_f32 v69, 1.0, v69
  v_add_f32 v70, 1.0, v70
  v_add_f32 v71, 1.0, v71
  v_add_f32 v72, 1.0, v72
  v_add_f32 v73, 1.0, v73
  v_add_f32 v74, 1.0, v74
  v_add_f32 v75, 1.0, v75
  v_rcp_f32 v68, v68
  v_rcp_f32 v69, v69
  v_rcp_f32 v70, v70
  v_rcp_f32 v71, v71
  v_rcp_f32 v72, v72
  v_rcp_f32 v73, v73
  v_rcp_f32 v74, v74
  v_rcp_f32 v75, v75
  v_mul_f32 v52, v52, v68
  v_mul_f32 v53, v53, v69
  v_mul_f32 v54, v54, v70
  v_mul_f32 v55, v55, v71
  v_mul_f32 v56, v56, v72
  v_mul_f32 v57, v57, v73
  v_mul_f32 v58, v58, v74
  v_mul_f32 v59, v59, v75
  v_cvt_pk_bf16_f32 v68, v52, v53
  v_cvt_pk_bf16_f32 v69, v54, v55
  v_cvt_pk_bf16_f32 v70, v56, v57
  v_cvt_pk_bf16_f32 v71, v58, v59
  v_lshlrev_b32 v52, 16, v68
  v_and_b32 v53, 0xffff0000, v68
  v_lshlrev_b32 v54, 16, v69
  v_and_b32 v55, 0xffff0000, v69
  v_lshlrev_b32 v56, 16, v70
  v_and_b32 v57, 0xffff0000, v70
  v_lshlrev_b32 v58, 16, v71
  v_and_b32 v59, 0xffff0000, v71
  v_mov_b32 v60, 0
  v_mov_b32 v61, 0
  v_mov_b32 v62, 0
  v_mov_b32 v63, 0
  v_mov_b32 v64, 0
  v_mov_b32 v65, 0
  v_mov_b32 v66, 0
  v_mov_b32 v67, 0
  s_waitcnt vmcnt(8)
  v_lshlrev_b32 v68, 16, v16
  v_and_b32 v69, 0xffff0000, v16
  v_lshlrev_b32 v70, 16, v17
  v_and_b32 v71, 0xffff0000, v17
  v_lshlrev_b32 v72, 16, v18
  v_and_b32 v73, 0xffff0000, v18
  v_lshlrev_b32 v74, 16, v19
  v_and_b32 v75, 0xffff0000, v19
  v_pk_fma_f32 v[60:61], v[68:69], v[52:53], v[60:61] op_sel:[0,0,0] op_sel_hi:[1,0,1]
  v_pk_fma_f32 v[62:63], v[70:71], v[52:53], v[62:63] op_sel:[0,0,0] op_sel_hi:[1,0,1]
  v_pk_fma_f32 v[64:65], v[72:73], v[52:53], v[64:65] op_sel:[0,0,0] op_sel_hi:[1,0,1]
  v_pk_fma_f32 v[66:67], v[74:75], v[52:53], v[66:67] op_sel:[0,0,0] op_sel_hi:[1,0,1]
  s_waitcnt vmcnt(7)
  v_lshlrev_b32 v68, 16, v20
  v_and_b32 v69, 0xffff0000, v20
  v_lshlrev_b32 v70, 16, v21
  v_and_b32 v71, 0xffff0000, v21
  v_lshlrev_b32 v72, 16, v22
  v_and_b32 v73, 0xffff0000, v22
  v_lshlrev_b32 v74, 16, v23
  v_and_b32 v75, 0xffff0000, v23
  v_pk_fma_f32 v[60:61], v[68:69], v[52:53], v[60:61] op_sel:[0,1,0] op_sel_hi:[1,1,1]
  v_pk_fma_f32 v[62:63], v[70:71], v[52:53], v[62:63] op_sel:[0,1,0] op_sel_hi:[1,1,1]
  v_pk_fma_f32 v[64:65], v[72:73], v[52:53], v[64:65] op_sel:[0,1,0] op_sel_hi:[1,1,1]
  v_pk_fma_f32 v[66:67], v[74:75], v[52:53], v[66:67] op_sel:[0,1,0] op_sel_hi:[1,1,1]
  s_waitcnt vmcnt(6)
  v_lshlrev_b32 v68, 16, v24
  v_and_b32 v69, 0xffff0000, v24
  v_lshlrev_b32 v70, 16, v25
  v_and_b32 v71, 0xffff0000, v25
  v_lshlrev_b32 v72, 16, v26
  v_and_b32 v73, 0xffff0000, v26
  v_lshlrev_b32 v74, 16, v27
  v_and_b32 v75, 0xffff0000, v27
  v_pk_fma_f32 v[60:61], v[68:69], v[54:55], v[60:61] op_sel:[0,0,0] op_sel_hi:[1,0,1]
  v_pk_fma_f32 v[62:63], v[70:71], v[54:55], v[62:63] op_sel:[0,0,0] op_sel_hi:[1,0,1]
  v_pk_fma_f32 v[64:65], v[72:73], v[54:55], v[64:65] op_sel:[0,0,0] op_sel_hi:[1,0,1]
  v_pk_fma_f32 v[66:67], v[74:75], v[54:55], v[66:67] op_sel:[0,0,0] op_sel_hi:[1,0,1]
  s_waitcnt vmcnt(5)
  v_lshlrev_b32 v68, 16, v28
  v_and_b32 v69, 0xffff0000, v28
  v_lshlrev_b32 v70, 16, v29
  v_and_b32 v71, 0xffff0000, v29
  v_lshlrev_b32 v72, 16, v30
  v_and_b32 v73, 0xffff0000, v30
  v_lshlrev_b32 v74, 16, v31
  v_and_b32 v75, 0xffff0000, v31
  v_pk_fma_f32 v[60:61], v[68:69], v[54:55], v[60:61] op_sel:[0,1,0] op_sel_hi:[1,1,1]
  v_pk_fma_f32 v[62:63], v[70:71], v[54:55], v[62:63] op_sel:[0,1,0] op_sel_hi:[1,1,1]
  v_pk_fma_f32 v[64:65], v[72:73], v[54:55], v[64:65] op_sel:[0,1,0] op_sel_hi:[1,1,1]
  v_pk_fma_f32 v[66:67], v[74:75], v[54:55], v[66:67] op_sel:[0,1,0] op_sel_hi:[1,1,1]
  s_waitcnt vmcnt(4)
  v_lshlrev_b32 v68, 16, v32
  v_and_b32 v69, 0xffff0000, v32
  v_lshlrev_b32 v70, 16, v33
  v_and_b32 v71, 0xffff0000, v33
  v_lshlrev_b32 v72, 16, v34
  v_and_b32 v73, 0xffff0000, v34
  v_lshlrev_b32 v74, 16, v35
  v_and_b32 v75, 0xffff0000, v35
  v_pk_fma_f32 v[60:61], v[68:69], v[56:57], v[60:61] op_sel:[0,0,0] op_sel_hi:[1,0,1]
  v_pk_fma_f32 v[62:63], v[70:71], v[56:57], v[62:63] op_sel:[0,0,0] op_sel_hi:[1,0,1]
  v_pk_fma_f32 v[64:65], v[72:73], v[56:57], v[64:65] op_sel:[0,0,0] op_sel_hi:[1,0,1]
  v_pk_fma_f32 v[66:67], v[74:75], v[56:57], v[66:67] op_sel:[0,0,0] op_sel_hi:[1,0,1]
  s_waitcnt vmcnt(3)
  v_lshlrev_b32 v68, 16, v36
  v_and_b32 v69, 0xffff0000, v36
  v_lshlrev_b32 v70, 16, v37
  v_and_b32 v71, 0xffff0000, v37
  v_lshlrev_b32 v72, 16, v38
  v_and_b32 v73, 0xffff0000, v38
  v_lshlrev_b32 v74, 16, v39
  v_and_b32 v75, 0xffff0000, v39
  v_pk_fma_f32 v[60:61], v[68:69], v[56:57], v[60:61] op_sel:[0,1,0] op_sel_hi:[1,1,1]
  v_pk_fma_f32 v[62:63], v[70:71], v[56:57], v[62:63] op_sel:[0,1,0] op_sel_hi:[1,1,1]
  v_pk_fma_f32 v[64:65], v[72:73], v[56:57], v[64:65] op_sel:[0,1,0] op_sel_hi:[1,1,1]
  v_pk_fma_f32 v[66:67], v[74:75], v[56:57], v[66:67] op_sel:[0,1,0] op_sel_hi:[1,1,1]
  s_waitcnt vmcnt(2)
  v_lshlrev_b32 v68, 16, v40
  v_and_b32 v69, 0xffff0000, v40
  v_lshlrev_b32 v70, 16, v41
  v_and_b32 v71, 0xffff0000, v41
  v_lshlrev_b32 v72, 16, v42
  v_and_b32 v73, 0xffff0000, v42
  v_lshlrev_b32 v74, 16, v43
  v_and_b32 v75, 0xffff0000, v43
  v_pk_fma_f32 v[60:61], v[68:69], v[58:59], v[60:61] op_sel:[0,0,0] op_sel_hi:[1,0,1]
  v_pk_fma_f32 v[62:63], v[70:71], v[58:59], v[62:63] op_sel:[0,0,0] op_sel_hi:[1,0,1]
  v_pk_fma_f32 v[64:65], v[72:73], v[58:59], v[64:65] op_sel:[0,0,0] op_sel_hi:[1,0,1]
  v_pk_fma_f32 v[66:67], v[74:75], v[58:59], v[66:67] op_sel:[0,0,0] op_sel_hi:[1,0,1]
  s_waitcnt vmcnt(1)
  v_lshlrev_b32 v68, 16, v44
  v_and_b32 v69, 0xffff0000, v44
  v_lshlrev_b32 v70, 16, v45
  v_and_b32 v71, 0xffff0000, v45
  v_lshlrev_b32 v72, 16, v46
  v_and_b32 v73, 0xffff0000, v46
  v_lshlrev_b32 v74, 16, v47
  v_and_b32 v75, 0xffff0000, v47
  v_pk_fma_f32 v[60:61], v[68:69], v[58:59], v[60:61] op_sel:[0,1,0] op_sel_hi:[1,1,1]
  v_pk_fma_f32 v[62:63], v[70:71], v[58:59], v[62:63] op_sel:[0,1,0] op_sel_hi:[1,1,1]
  v_pk_fma_f32 v[64:65], v[72:73], v[58:59], v[64:65] op_sel:[0,1,0] op_sel_hi:[1,1,1]
  v_pk_fma_f32 v[66:67], v[74:75], v[58:59], v[66:67] op_sel:[0,1,0] op_sel_hi:[1,1,1]
  s_nop 1
  v_add_f32_dpp v60, v60, v60 row_ror:4 row_mask:0xf bank_mask:0xf
  v_add_f32_dpp v61, v61, v61 row_ror:4 row_mask:0xf bank_mask:0xf
  v_add_f32_dpp v62, v62, v62 row_ror:4 row_mask:0xf bank_mask:0xf
  v_add_f32_dpp v63, v63, v63 row_ror:4 row_mask:0xf bank_mask:0xf
  v_add_f32_dpp v64, v64, v64 row_ror:4 row_mask:0xf bank_mask:0xf
  v_add_f32_dpp v65, v65, v65 row_ror:4 row_mask:0xf bank_mask:0xf
  v_add_f32_dpp v66, v66, v66 row_ror:4 row_mask:0xf bank_mask:0xf
  v_add_f32_dpp v67, v67, v67 row_ror:4 row_mask:0xf bank_mask:0xf
  v_add_f32_dpp v60, v60, v60 row_ror:8 row_mask:0xf bank_mask:0xf
  v_add_f32_dpp v61, v61, v61 row_ror:8 row_mask:0xf bank_mask:0xf
  v_add_f32_dpp v62, v62, v62 row_ror:8 row_mask:0xf bank_mask:0xf
  v_add_f32_dpp v63, v63, v63 row_ror:8 row_mask:0xf bank_mask:0xf
  v_add_f32_dpp v64, v64, v64 row_ror:8 row_mask:0xf bank_mask:0xf
  v_add_f32_dpp v65, v65, v65 row_ror:8 row_mask:0xf bank_mask:0xf
  v_add_f32_dpp v66, v66, v66 row_ror:8 row_mask:0xf bank_mask:0xf
  v_add_f32_dpp v67, v67, v67 row_ror:8 row_mask:0xf bank_mask:0xf
  v_lshrrev_b32 v10, 4, v0
  v_lshlrev_b32 v10, 7, v10
  v_lshl_add_u32 v10, v9, 5, v10
  v_add_u32 v10, 65536, v10
  ds_write_b128 v10, v[60:63]
  ds_write_b128 v10, v[64:67] offset:16
  s_waitcnt lgkmcnt(0)
  s_barrier
  s_cmp_lg_u32 s32, 0
  s_cbranch_scc1 L_modnw0_3
  v_and_b32 v9, 31, v1
  v_lshlrev_b32 v10, 2, v9
  v_add_u32 v11, 65536, v10
  ds_read_b32 v16, v11 offset:0
  ds_read_b32 v17, v11 offset:128
  ds_read_b32 v18, v11 offset:256
  ds_read_b32 v19, v11 offset:384
  ds_read_b32 v20, v11 offset:512
  ds_read_b32 v21, v11 offset:640
  ds_read_b32 v22, v11 offset:768
  ds_read_b32 v23, v11 offset:896
  ds_read_b32 v24, v11 offset:1024
  ds_read_b32 v25, v11 offset:1152
  ds_read_b32 v26, v11 offset:1280
  ds_read_b32 v27, v11 offset:1408
  ds_read_b32 v28, v11 offset:1536
  ds_read_b32 v29, v11 offset:1664
  ds_read_b32 v30, v11 offset:1792
  ds_read_b32 v31, v11 offset:1920
  s_waitcnt lgkmcnt(0)
  v_add_f32 v16, v16, v24
  v_add_f32 v17, v17, v25
  v_add_f32 v18, v18, v26
  v_add_f32 v19, v19, v27
  v_add_f32 v20, v20, v28
  v_add_f32 v21, v21, v29
  v_add_f32 v22, v22, v30
  v_add_f32 v23, v23, v31
  v_add_f32 v16, v16, v20
  v_add_f32 v17, v17, v21
  v_add_f32 v18, v18, v22
  v_add_f32 v19, v19, v23
  v_add_f32 v16, v16, v18
  v_add_f32 v17, v17, v19
  v_add_f32 v16, v16, v17
  v_cvt_pk_bf16_f32 v16, v16, v16
  v_lshlrev_b32 v16, 16, v16
  s_lshl_b32 s40, s76, 2
  s_add_u32 s40, s40, 32768
  v_add_u32 v10, s40, v10
  s_waitcnt vmcnt(0)
  s_mov_b32 s92, 0
L_nl_6:
  v_readfirstlane_b32 s90, v6
  s_cmp_lg_u32 s90, 0
  s_cbranch_scc1 L_nok_7
  s_add_u32 s92, s92, 1
  s_cmp_gt_u32 s92, 200000
  s_cbranch_scc1 L_nok_7
  global_load_dword v6, v5, s[28:29] sc1
  s_waitcnt vmcnt(0)
  s_branch L_nl_6
L_nok_7:
  s_and_b32 s91, s90, 0xffff
  s_lshr_b32 s93, s90, 16
  v_and_b32 v11, 2, v9
  v_cmp_eq_u32 vcc, 0, v11
  v_mov_b32 v11, s91
  v_mov_b32 v12, s93
  v_cndmask_b32 v11, v12, v11, vcc
  v_or_b32 v16, v11, v16
  global_store_dword v10, v16, s[30:31] sc1
L_modnw0_3:
L_nomod_2:
  s_lshl_b32 s40, s35, 6
  s_lshl_b32 s41, s32, 4
  s_add_u32 s40, s40, s41
  s_lshl_b32 s40, s40, 10
  s_add_u32 s98, s4, s40
  s_addc_u32 s99, s5, 0
  global_load_dwordx4 v[16:19], v2, s[98:99] offset:0
  global_load_dwordx4 v[20:23], v2, s[98:99] offset:1024
  global_load_dwordx4 v[24:27], v2, s[98:99] offset:2048
  global_load_dwordx4 v[28:31], v2, s[98:99] offset:3072
  s_add_u32 s98, s98, 4096
  s_addc_u32 s99, s99, 0
  global_load_dwordx4 v[32:35], v2, s[98:99] offset:0
  global_load_dwordx4 v[36:39], v2, s[98:99] offset:1024
  global_load_dwordx4 v[40:43], v2, s[98:99] offset:2048
  global_load_dwordx4 v[44:47], v2, s[98:99] offset:3072
  s_add_u32 s98, s98, 4096
  s_addc_u32 s99, s99, 0
  global_load_dwordx4 v[48:51], v2, s[98:99] offset:0
  global_load_dwordx4 v[52:55], v2, s[98:99] offset:1024
  global_load_dwordx4 v[56:59], v2, s[98:99] offset:2048
  global_load_dwordx4 v[60:63], v2, s[98:99] offset:3072
  s_add_u32 s98, s98, 4096
  s_addc_u32 s99, s99, 0
  global_load_dwordx4 v[64:67], v2, s[98:99] offset:0
  global_load_dwordx4 v[68:71], v2, s[98:99] offset:1024
  global_load_dwordx4 v[72:75], v2, s[98:99] offset:2048
  global_load_dwordx4 v[76:79], v2, s[98:99] offset:3072
  v_lshrrev_b32 v248, 2, v1
  v_lshlrev_b32 v248, 10, v248
  v_and_b32 v9, 3, v1
  v_lshl_add_u32 v248, v9, 4, v248
  s_and_b32 s40, s32, 1
  s_lshl_b32 s40, s40, 18
  s_lshr_b32 s41, s32, 1
  s_lshl_b32 s41, s41, 6
  s_add_u32 s40, s40, s41
  s_lshl_b32 s41, s36, 7
  s_add_u32 s40, s40, s41
  s_add_u32 s100, s6, s40
  s_addc_u32 s101, s7, 0
  s_lshl_b32 s77, s32, 14
  s_add_u32 s77, s77, 98304
  v_lshrrev_b32 v10, 2, v1
  v_lshlrev_b32 v10, 5, v10
  v_and_b32 v11, 1, v1
  v_lshl_add_u32 v10, v11, 4, v10
  s_lshl_b32 s40, s32, 12
  v_add_u32 v10, s40, v10
  v_and_b32 v11, 2, v1
  v_cmp_ne_u32 vcc, 0, v11
  v_mov_b32 v12, s8
  v_mov_b32 v13, s10
  v_mov_b32 v14, s9
  v_mov_b32 v15, s11
  v_cndmask_b32 v12, v12, v13, vcc
  v_cndmask_b32 v13, v14, v15, vcc
  v_add_co_u32 v250, vcc, v12, v10
  s_lshl_b32 s78, s32, 13
  s_add_u32 s78, s78, 65536
  v_addc_co_u32 v251, vcc, 0, v13, vcc
  v_mov_b32 v240, 0x3f803f80
  s_waitcnt vmcnt(12)
  s_cmp_ge_u32 s95, 4
  s_cbranch_scc1 L_kvs_8
  s_mov_b32 m0, s78
  s_add_u32 s78, s78, 512
  global_load_lds_dwordx4 v[250:251], off offset:0
L_kvs_8:
  v_dot2_f32_bf16 v208, v16, v240, 0
  v_dot2_f32_bf16 v224, v16, v16, 0
  v_dot2_f32_bf16 v208, v17, v240, v208
  v_dot2_f32_bf16 v224, v17, v17, v224
  v_dot2_f32_bf16 v208, v18, v240, v208
  v_dot2_f32_bf16 v224, v18, v18, v224
  v_dot2_f32_bf16 v208, v19, v240, v208
  v_dot2_f32_bf16 v224, v19, v19, v224
  s_cmp_ge_u32 s95, 4
  s_cbranch_scc1 L_kvs_9
  s_mov_b32 m0, s78
  s_add_u32 s78, s78, 512
  global_load_lds_dwordx4 v[250:251], off offset:512
L_kvs_9:
  v_dot2_f32_bf16 v209, v20, v240, 0
  v_dot2_f32_bf16 v225, v20, v20, 0
  v_dot2_f32_bf16 v209, v21, v240, v209
  v_dot2_f32_bf16 v225, v21, v21, v225
  v_dot2_f32_bf16 v209, v22, v240, v209
  v_dot2_f32_bf16 v225, v22, v22, v225
  v_dot2_f32_bf16 v209, v23, v240, v209
  v_dot2_f32_bf16 v225, v23, v23, v225
  s_cmp_ge_u32 s95, 4
  s_cbranch_scc1 L_kvs_10
  s_mov_b32 m0, s78
  s_add_u32 s78, s78, 512
  global_load_lds_dwordx4 v[250:251], off offset:1024
L_kvs_10:
  v_dot2_f32_bf16 v210, v24, v240, 0
  v_dot2_f32_bf16 v226, v24, v24, 0
  v_dot2_f32_bf16 v210, v25, v240, v210
  v_dot2_f32_bf16 v226, v25, v25, v226
  v_dot2_f32_bf16 v210, v26, v240, v210
  v_dot2_f32_bf16 v226, v26, v26, v226
  v_dot2_f32_bf16 v210, v27, v240, v210
  v_dot2_f32_bf16 v226, v27, v27, v226
  s_cmp_ge_u32 s95, 4
  s_cbranch_scc1 L_kvs_11
  s_mov_b32 m0, s78
  s_add_u32 s78, s78, 512
  global_load_lds_dwordx4 v[250:251], off offset:1536
L_kvs_11:
  v_dot2_f32_bf16 v211, v28, v240, 0
  v_dot2_f32_bf16 v227, v28, v28, 0
  v_dot2_f32_bf16 v211, v29, v240, v211
  v_dot2_f32_bf16 v227, v29, v29, v227
  v_dot2_f32_bf16 v211, v30, v240, v211
  v_dot2_f32_bf16 v227, v30, v30, v227
  v_dot2_f32_bf16 v211, v31, v240, v211
  v_dot2_f32_bf16 v227, v31, v31, v227
  s_waitcnt vmcnt(8)
  s_cmp_ge_u32 s95, 4
  s_cbranch_scc1 L_kvs_12
  s_mov_b32 m0, s78
  s_add_u32 s78, s78, 512
  global_load_lds_dwordx4 v[250:251], off offset:2048
L_kvs_12:
  v_dot2_f32_bf16 v212, v32, v240, 0
  v_dot2_f32_bf16 v228, v32, v32, 0
  v_dot2_f32_bf16 v212, v33, v240, v212
  v_dot2_f32_bf16 v228, v33, v33, v228
  v_dot2_f32_bf16 v212, v34, v240, v212
  v_dot2_f32_bf16 v228, v34, v34, v228
  v_dot2_f32_bf16 v212, v35, v240, v212
  v_dot2_f32_bf16 v228, v35, v35, v228
  s_cmp_ge_u32 s95, 4
  s_cbranch_scc1 L_kvs_13
  s_mov_b32 m0, s78
  s_add_u32 s78, s78, 512
  global_load_lds_dwordx4 v[250:251], off offset:2560
L_kvs_13:
  v_dot2_f32_bf16 v213, v36, v240, 0
  v_dot2_f32_bf16 v229, v36, v36, 0
  v_dot2_f32_bf16 v213, v37, v240, v213
  v_dot2_f32_bf16 v229, v37, v37, v229
  v_dot2_f32_bf16 v213, v38, v240, v213
  v_dot2_f32_bf16 v229, v38, v38, v229
  v_dot2_f32_bf16 v213, v39, v240, v213
  v_dot2_f32_bf16 v229, v39, v39, v229
  s_cmp_ge_u32 s95, 4
  s_cbranch_scc1 L_kvs_14
  s_mov_b32 m0, s78
  s_add_u32 s78, s78, 512
  global_load_lds_dwordx4 v[250:251], off offset:3072
L_kvs_14:
  v_dot2_f32_bf16 v214, v40, v240, 0
  v_dot2_f32_bf16 v230, v40, v40, 0
  v_dot2_f32_bf16 v214, v41, v240, v214
  v_dot2_f32_bf16 v230, v41, v41, v230
  v_dot2_f32_bf16 v214, v42, v240, v214
  v_dot2_f32_bf16 v230, v42, v42, v230
  v_dot2_f32_bf16 v214, v43, v240, v214
  v_dot2_f32_bf16 v230, v43, v43, v230
  s_cmp_ge_u32 s95, 4
  s_cbranch_scc1 L_kvs_15
  s_mov_b32 m0, s78
  s_add_u32 s78, s78, 512
  global_load_lds_dwordx4 v[250:251], off offset:3584
L_kvs_15:
  v_dot2_f32_bf16 v215, v44, v240, 0
  v_dot2_f32_bf16 v231, v44, v44, 0
  v_dot2_f32_bf16 v215, v45, v240, v215
  v_dot2_f32_bf16 v231, v45, v45, v231
  v_dot2_f32_bf16 v215, v46, v240, v215
  v_dot2_f32_bf16 v231, v46, v46, v231
  v_dot2_f32_bf16 v215, v47, v240, v215
  v_dot2_f32_bf16 v231, v47, v47, v231
  s_waitcnt vmcnt(4)
  v_mov_b32 v5, 0
  global_load_dword v6, v5, s[28:29] sc1
  s_mov_b32 m0, s77
  s_add_u32 s77, s77, 1024
  global_load_lds_dwordx4 v248, s[100:101]
  v_add_u32 v248, 16384, v248
  v_dot2_f32_bf16 v216, v48, v240, 0
  v_dot2_f32_bf16 v232, v48, v48, 0
  v_dot2_f32_bf16 v216, v49, v240, v216
  v_dot2_f32_bf16 v232, v49, v49, v232
  v_dot2_f32_bf16 v216, v50, v240, v216
  v_dot2_f32_bf16 v232, v50, v50, v232
  v_dot2_f32_bf16 v216, v51, v240, v216
  v_dot2_f32_bf16 v232, v51, v51, v232
  s_mov_b32 m0, s77
  s_add_u32 s77, s77, 1024
  global_load_lds_dwordx4 v248, s[100:101]
  v_add_u32 v248, 16384, v248
  v_dot2_f32_bf16 v217, v52, v240, 0
  v_dot2_f32_bf16 v233, v52, v52, 0
  v_dot2_f32_bf16 v217, v53, v240, v217
  v_dot2_f32_bf16 v233, v53, v53, v233
  v_dot2_f32_bf16 v217, v54, v240, v217
  v_dot2_f32_bf16 v233, v54, v54, v233
  v_dot2_f32_bf16 v217, v55, v240, v217
  v_dot2_f32_bf16 v233, v55, v55, v233
  s_mov_b32 m0, s77
  s_add_u32 s77, s77, 1024
  global_load_lds_dwordx4 v248, s[100:101]
  v_add_u32 v248, 16384, v248
  v_dot2_f32_bf16 v218, v56, v240, 0
  v_dot2_f32_bf16 v234, v56, v56, 0
  v_dot2_f32_bf16 v218, v57, v240, v218
  v_dot2_f32_bf16 v234, v57, v57, v234
  v_dot2_f32_bf16 v218, v58, v240, v218
  v_dot2_f32_bf16 v234, v58, v58, v234
  v_dot2_f32_bf16 v218, v59, v240, v218
  v_dot2_f32_bf16 v234, v59, v59, v234
  s_mov_b32 m0, s77
  s_add_u32 s77, s77, 1024
  global_load_lds_dwordx4 v248, s[100:101]
  v_add_u32 v248, 16384, v248
  v_dot2_f32_bf16 v219, v60, v240, 0
  v_dot2_f32_bf16 v235, v60, v60, 0
  v_dot2_f32_bf16 v219, v61, v240, v219
  v_dot2_f32_bf16 v235, v61, v61, v235
  v_dot2_f32_bf16 v219, v62, v240, v219
  v_dot2_f32_bf16 v235, v62, v62, v235
  v_dot2_f32_bf16 v219, v63, v240, v219
  v_dot2_f32_bf16 v235, v63, v63, v235
  s_waitcnt vmcnt(5)
  s_mov_b32 m0, s77
  s_add_u32 s77, s77, 1024
  global_load_lds_dwordx4 v248, s[100:101]
  v_add_u32 v248, 16384, v248
  v_dot2_f32_bf16 v220, v64, v240, 0
  v_dot2_f32_bf16 v236, v64, v64, 0
  v_dot2_f32_bf16 v220, v65, v240, v220
  v_dot2_f32_bf16 v236, v65, v65, v236
  v_dot2_f32_bf16 v220, v66, v240, v220
  v_dot2_f32_bf16 v236, v66, v66, v236
  v_dot2_f32_bf16 v220, v67, v240, v220
  v_dot2_f32_bf16 v236, v67, v67, v236
  s_mov_b32 m0, s77
  s_add_u32 s77, s77, 1024
  global_load_lds_dwordx4 v248, s[100:101]
  v_add_u32 v248, 16384, v248
  v_dot2_f32_bf16 v221, v68, v240, 0
  v_dot2_f32_bf16 v237, v68, v68, 0
  v_dot2_f32_bf16 v221, v69, v240, v221
  v_dot2_f32_bf16 v237, v69, v69, v237
  v_dot2_f32_bf16 v221, v70, v240, v221
  v_dot2_f32_bf16 v237, v70, v70, v237
  v_dot2_f32_bf16 v221, v71, v240, v221
  v_dot2_f32_bf16 v237, v71, v71, v237
  s_mov_b32 m0, s77
  s_add_u32 s77, s77, 1024
  global_load_lds_dwordx4 v248, s[100:101]
  v_add_u32 v248, 16384, v248
  v_dot2_f32_bf16 v222, v72, v240, 0
  v_dot2_f32_bf16 v238, v72, v72, 0
  v_dot2_f32_bf16 v222, v73, v240, v222
  v_dot2_f32_bf16 v238, v73, v73, v238
  v_dot2_f32_bf16 v222, v74, v240, v222
  v_dot2_f32_bf16 v238, v74, v74, v238
  v_dot2_f32_bf16 v222, v75, v240, v222
  v_dot2_f32_bf16 v238, v75, v75, v238
  s_mov_b32 m0, s77
  s_add_u32 s77, s77, 1024
  global_load_lds_dwordx4 v248, s[100:101]
  v_add_u32 v248, 16384, v248
  v_dot2_f32_bf16 v223, v76, v240, 0
  v_dot2_f32_bf16 v239, v76, v76, 0
  v_dot2_f32_bf16 v223, v77, v240, v223
  v_dot2_f32_bf16 v239, v77, v77, v239
  v_dot2_f32_bf16 v223, v78, v240, v223
  v_dot2_f32_bf16 v239, v78, v78, v239
  v_dot2_f32_bf16 v223, v79, v240, v223
  v_dot2_f32_bf16 v239, v79, v79, v239
  s_nop 2
  v_permlane32_swap_b32 v208, v210
  v_permlane32_swap_b32 v209, v211
  v_permlane32_swap_b32 v212, v214
  v_permlane32_swap_b32 v213, v215
  v_permlane32_swap_b32 v216, v218
  v_permlane32_swap_b32 v217, v219
  v_permlane32_swap_b32 v220, v222
  v_permlane32_swap_b32 v221, v223
  v_add_f32 v208, v208, v210
  v_add_f32 v209, v209, v211
  v_add_f32 v212, v212, v214
  v_add_f32 v213, v213, v215
  v_add_f32 v216, v216, v218
  v_add_f32 v217, v217, v219
  v_add_f32 v220, v220, v222
  v_add_f32 v221, v221, v223
  s_nop 1
  v_permlane16_swap_b32 v208, v209
  v_permlane16_swap_b32 v212, v213
  v_permlane16_swap_b32 v216, v217
  v_permlane16_swap_b32 v220, v221
  v_add_f32 v208, v208, v209
  v_add_f32 v212, v212, v213
  v_add_f32 v216, v216, v217
  v_add_f32 v220, v220, v221
  v_permlane32_swap_b32 v224, v226
  v_permlane32_swap_b32 v225, v227
  v_permlane32_swap_b32 v228, v230
  v_permlane32_swap_b32 v229, v231
  v_permlane32_swap_b32 v232, v234
  v_permlane32_swap_b32 v233, v235
  v_permlane32_swap_b32 v236, v238
  v_permlane32_swap_b32 v237, v239
  v_add_f32 v224, v224, v226
  v_add_f32 v225, v225, v227
  v_add_f32 v228, v228, v230
  v_add_f32 v229, v229, v231
  v_add_f32 v232, v232, v234
  v_add_f32 v233, v233, v235
  v_add_f32 v236, v236, v238
  v_add_f32 v237, v237, v239
  s_nop 1
  v_permlane16_swap_b32 v224, v225
  v_permlane16_swap_b32 v228, v229
  v_permlane16_swap_b32 v232, v233
  v_permlane16_swap_b32 v236, v237
  v_add_f32 v224, v224, v225
  v_add_f32 v228, v228, v229
  v_add_f32 v232, v232, v233
  v_add_f32 v236, v236, v237
  s_mov_b32 m0, s77
  s_add_u32 s77, s77, 1024
  global_load_lds_dwordx4 v248, s[100:101]
  v_add_u32 v248, 16384, v248
  v_add_f32_dpp v208, v208, v208 row_ror:8 row_mask:0xf bank_mask:0xf
  v_add_f32_dpp v212, v212, v212 row_ror:8 row_mask:0xf bank_mask:0xf
  v_add_f32_dpp v216, v216, v216 row_ror:8 row_mask:0xf bank_mask:0xf
  v_add_f32_dpp v220, v220, v220 row_ror:8 row_mask:0xf bank_mask:0xf
  v_add_f32_dpp v224, v224, v224 row_ror:8 row_mask:0xf bank_mask:0xf
  v_add_f32_dpp v228, v228, v228 row_ror:8 row_mask:0xf bank_mask:0xf
  v_add_f32_dpp v232, v232, v232 row_ror:8 row_mask:0xf bank_mask:0xf
  v_add_f32_dpp v236, v236, v236 row_ror:8 row_mask:0xf bank_mask:0xf
  s_mov_b32 m0, s77
  s_add_u32 s77, s77, 1024
  global_load_lds_dwordx4 v248, s[100:101]
  v_add_u32 v248, 16384, v248
  v_add_f32_dpp v208, v208, v208 row_ror:4 row_mask:0xf bank_mask:0xf
  v_add_f32_dpp v212, v212, v212 row_ror:4 row_mask:0xf bank_mask:0xf
  v_add_f32_dpp v216, v216, v216 row_ror:4 row_mask:0xf bank_mask:0xf
  v_add_f32_dpp v220, v220, v220 row_ror:4 row_mask:0xf bank_mask:0xf
  v_add_f32_dpp v224, v224, v224 row_ror:4 row_mask:0xf bank_mask:0xf
  v_add_f32_dpp v228, v228, v228 row_ror:4 row_mask:0xf bank_mask:0xf
  v_add_f32_dpp v232, v232, v232 row_ror:4 row_mask:0xf bank_mask:0xf
  v_add_f32_dpp v236, v236, v236 row_ror:4 row_mask:0xf bank_mask:0xf
  s_mov_b32 m0, s77
  s_add_u32 s77, s77, 1024
  global_load_lds_dwordx4 v248, s[100:101]
  v_add_u32 v248, 16384, v248
  v_add_f32_dpp v208, v208, v208 row_ror:2 row_mask:0xf bank_mask:0xf
  v_add_f32_dpp v212, v212, v212 row_ror:2 row_mask:0xf bank_mask:0xf
  v_add_f32_dpp v216, v216, v216 row_ror:2 row_mask:0xf bank_mask:0xf
  v_add_f32_dpp v220, v220, v220 row_ror:2 row_mask:0xf bank_mask:0xf
  v_add_f32_dpp v224, v224, v224 row_ror:2 row_mask:0xf bank_mask:0xf
  v_add_f32_dpp v228, v228, v228 row_ror:2 row_mask:0xf bank_mask:0xf
  v_add_f32_dpp v232, v232, v232 row_ror:2 row_mask:0xf bank_mask:0xf
  v_add_f32_dpp v236, v236, v236 row_ror:2 row_mask:0xf bank_mask:0xf
  s_mov_b32 m0, s77
  s_add_u32 s77, s77, 1024
  global_load_lds_dwordx4 v248, s[100:101]
  v_add_u32 v248, 16384, v248
  v_add_f32_dpp v208, v208, v208 row_ror:1 row_mask:0xf bank_mask:0xf
  v_add_f32_dpp v212, v212, v212 row_ror:1 row_mask:0xf bank_mask:0xf
  v_add_f32_dpp v216, v216, v216 row_ror:1 row_mask:0xf bank_mask:0xf
  v_add_f32_dpp v220, v220, v220 row_ror:1 row_mask:0xf bank_mask:0xf
  v_add_f32_dpp v224, v224, v224 row_ror:1 row_mask:0xf bank_mask:0xf
  v_add_f32_dpp v228, v228, v228 row_ror:1 row_mask:0xf bank_mask:0xf
  v_add_f32_dpp v232, v232, v232 row_ror:1 row_mask:0xf bank_mask:0xf
  v_add_f32_dpp v236, v236, v236 row_ror:1 row_mask:0xf bank_mask:0xf
  v_mul_f32 v208, 0x3b000000, v208
  v_mul_f32 v212, 0x3b000000, v212
  v_mul_f32 v216, 0x3b000000, v216
  v_mul_f32 v220, 0x3b000000, v220
  v_mul_f32 v209, v208, v208
  v_mul_f32 v213, v212, v212
  v_mul_f32 v217, v216, v216
  v_mul_f32 v221, v220, v220
  s_mov_b32 s76, 0x3b000000
  v_fma_f32 v224, v224, s76, -v209
  v_fma_f32 v228, v228, s76, -v213
  v_fma_f32 v232, v232, s76, -v217
  v_fma_f32 v236, v236, s76, -v221
  v_max_f32 v224, 0, v224
  v_max_f32 v228, 0, v228
  v_max_f32 v232, 0, v232
  v_max_f32 v236, 0, v236
  v_add_f32 v224, 0x3727c5ac, v224
  v_add_f32 v228, 0x3727c5ac, v228
  v_add_f32 v232, 0x3727c5ac, v232
  v_add_f32 v236, 0x3727c5ac, v236
  v_rsq_f32 v224, v224
  v_rsq_f32 v228, v228
  v_rsq_f32 v232, v232
  v_rsq_f32 v236, v236
  s_nop 0
  v_mul_f32 v208, v208, v224
  v_mul_f32 v212, v212, v228
  v_mul_f32 v216, v216, v232
  v_mul_f32 v220, v220, v236
  v_sub_f32 v208, 0, v208
  v_sub_f32 v212, 0, v212
  v_sub_f32 v216, 0, v216
  v_sub_f32 v220, 0, v220
  s_nop 0
  s_mov_b32 m0, s77
  s_add_u32 s77, s77, 1024
  global_load_lds_dwordx4 v248, s[100:101]
  v_add_u32 v248, 16384, v248
  v_readlane_b32 s44, v224, 0
  v_readlane_b32 s45, v208, 0
  v_readlane_b32 s46, v224, 16
  v_readlane_b32 s47, v208, 16
  v_readlane_b32 s48, v224, 32
  v_readlane_b32 s49, v208, 32
  v_readlane_b32 s50, v224, 48
  v_readlane_b32 s51, v208, 48
  s_mov_b32 m0, s77
  s_add_u32 s77, s77, 1024
  global_load_lds_dwordx4 v248, s[100:101]
  v_add_u32 v248, 16384, v248
  v_readlane_b32 s52, v228, 0
  v_readlane_b32 s53, v212, 0
  v_readlane_b32 s54, v228, 16
  v_readlane_b32 s55, v212, 16
  v_readlane_b32 s56, v228, 32
  v_readlane_b32 s57, v212, 32
  v_readlane_b32 s58, v228, 48
  v_readlane_b32 s59, v212, 48
  s_mov_b32 m0, s77
  s_add_u32 s77, s77, 1024
  global_load_lds_dwordx4 v248, s[100:101]
  v_add_u32 v248, 16384, v248
  v_readlane_b32 s60, v232, 0
  v_readlane_b32 s61, v216, 0
  v_readlane_b32 s62, v232, 16
  v_readlane_b32 s63, v216, 16
  v_readlane_b32 s64, v232, 32
  v_readlane_b32 s65, v216, 32
  v_readlane_b32 s66, v232, 48
  v_readlane_b32 s67, v216, 48
  s_mov_b32 m0, s77
  s_add_u32 s77, s77, 1024
  global_load_lds_dwordx4 v248, s[100:101]
  v_add_u32 v248, 16384, v248
  v_readlane_b32 s68, v236, 0
  v_readlane_b32 s69, v220, 0
  v_readlane_b32 s70, v236, 16
  v_readlane_b32 s71, v220, 16
  v_readlane_b32 s72, v236, 32
  v_readlane_b32 s73, v220, 32
  v_readlane_b32 s74, v236, 48
  v_readlane_b32 s75, v220, 48
  s_nop 1
  v_lshlrev_b32 v240, 16, v16
  v_and_b32 v241, 0xffff0000, v16
  v_lshlrev_b32 v242, 16, v17
  v_and_b32 v243, 0xffff0000, v17
  v_lshlrev_b32 v244, 16, v18
  v_and_b32 v245, 0xffff0000, v18
  v_lshlrev_b32 v246, 16, v19
  v_and_b32 v247, 0xffff0000, v19
  v_pk_fma_f32 v[80:81], v[240:241], s[44:45], s[44:45] op_sel:[0,0,1] op_sel_hi:[1,0,1]
  v_pk_fma_f32 v[82:83], v[242:243], s[44:45], s[44:45] op_sel:[0,0,1] op_sel_hi:[1,0,1]
  v_pk_fma_f32 v[84:85], v[244:245], s[44:45], s[44:45] op_sel:[0,0,1] op_sel_hi:[1,0,1]
  v_pk_fma_f32 v[86:87], v[246:247], s[44:45], s[44:45] op_sel:[0,0,1] op_sel_hi:[1,0,1]
  v_lshlrev_b32 v240, 16, v20
  v_and_b32 v241, 0xffff0000, v20
  v_lshlrev_b32 v242, 16, v21
  v_and_b32 v243, 0xffff0000, v21
  v_lshlrev_b32 v244, 16, v22
  v_and_b32 v245, 0xffff0000, v22
  v_lshlrev_b32 v246, 16, v23
  v_and_b32 v247, 0xffff0000, v23
  v_pk_fma_f32 v[88:89], v[240:241], s[46:47], s[46:47] op_sel:[0,0,1] op_sel_hi:[1,0,1]
  v_pk_fma_f32 v[90:91], v[242:243], s[46:47], s[46:47] op_sel:[0,0,1] op_sel_hi:[1,0,1]
  v_pk_fma_f32 v[92:93], v[244:245], s[46:47], s[46:47] op_sel:[0,0,1] op_sel_hi:[1,0,1]
  v_pk_fma_f32 v[94:95], v[246:247], s[46:47], s[46:47] op_sel:[0,0,1] op_sel_hi:[1,0,1]
  v_lshlrev_b32 v240, 16, v24
  v_and_b32 v241, 0xffff0000, v24
  v_lshlrev_b32 v242, 16, v25
  v_and_b32 v243, 0xffff0000, v25
  v_lshlrev_b32 v244, 16, v26
  v_and_b32 v245, 0xffff0000, v26
  v_lshlrev_b32 v246, 16, v27
  v_and_b32 v247, 0xffff0000, v27
  v_pk_fma_f32 v[96:97], v[240:241], s[48:49], s[48:49] op_sel:[0,0,1] op_sel_hi:[1,0,1]
  v_pk_fma_f32 v[98:99], v[242:243], s[48:49], s[48:49] op_sel:[0,0,1] op_sel_hi:[1,0,1]
  v_pk_fma_f32 v[100:101], v[244:245], s[48:49], s[48:49] op_sel:[0,0,1] op_sel_hi:[1,0,1]
  v_pk_fma_f32 v[102:103], v[246:247], s[48:49], s[48:49] op_sel:[0,0,1] op_sel_hi:[1,0,1]
  v_lshlrev_b32 v240, 16, v28
  v_and_b32 v241, 0xffff0000, v28
  v_lshlrev_b32 v242, 16, v29
  v_and_b32 v243, 0xffff0000, v29
  v_lshlrev_b32 v244, 16, v30
  v_and_b32 v245, 0xffff0000, v30
  v_lshlrev_b32 v246, 16, v31
  v_and_b32 v247, 0xffff0000, v31
  v_pk_fma_f32 v[104:105], v[240:241], s[50:51], s[50:51] op_sel:[0,0,1] op_sel_hi:[1,0,1]
  v_pk_fma_f32 v[106:107], v[242:243], s[50:51], s[50:51] op_sel:[0,0,1] op_sel_hi:[1,0,1]
  v_pk_fma_f32 v[108:109], v[244:245], s[50:51], s[50:51] op_sel:[0,0,1] op_sel_hi:[1,0,1]
  v_pk_fma_f32 v[110:111], v[246:247], s[50:51], s[50:51] op_sel:[0,0,1] op_sel_hi:[1,0,1]
  v_lshlrev_b32 v240, 16, v32
  v_and_b32 v241, 0xffff0000, v32
  v_lshlrev_b32 v242, 16, v33
  v_and_b32 v243, 0xffff0000, v33
  v_lshlrev_b32 v244, 16, v34
  v_and_b32 v245, 0xffff0000, v34
  v_lshlrev_b32 v246, 16, v35
  v_and_b32 v247, 0xffff0000, v35
  v_pk_fma_f32 v[112:113], v[240:241], s[52:53], s[52:53] op_sel:[0,0,1] op_sel_hi:[1,0,1]
  v_pk_fma_f32 v[114:115], v[242:243], s[52:53], s[52:53] op_sel:[0,0,1] op_sel_hi:[1,0,1]
  v_pk_fma_f32 v[116:117], v[244:245], s[52:53], s[52:53] op_sel:[0,0,1] op_sel_hi:[1,0,1]
  v_pk_fma_f32 v[118:119], v[246:247], s[52:53], s[52:53] op_sel:[0,0,1] op_sel_hi:[1,0,1]
  v_lshlrev_b32 v240, 16, v36
  v_and_b32 v241, 0xffff0000, v36
  v_lshlrev_b32 v242, 16, v37
  v_and_b32 v243, 0xffff0000, v37
  v_lshlrev_b32 v244, 16, v38
  v_and_b32 v245, 0xffff0000, v38
  v_lshlrev_b32 v246, 16, v39
  v_and_b32 v247, 0xffff0000, v39
  v_pk_fma_f32 v[120:121], v[240:241], s[54:55], s[54:55] op_sel:[0,0,1] op_sel_hi:[1,0,1]
  v_pk_fma_f32 v[122:123], v[242:243], s[54:55], s[54:55] op_sel:[0,0,1] op_sel_hi:[1,0,1]
  v_pk_fma_f32 v[124:125], v[244:245], s[54:55], s[54:55] op_sel:[0,0,1] op_sel_hi:[1,0,1]
  v_pk_fma_f32 v[126:127], v[246:247], s[54:55], s[54:55] op_sel:[0,0,1] op_sel_hi:[1,0,1]
  v_lshlrev_b32 v240, 16, v40
  v_and_b32 v241, 0xffff0000, v40
  v_lshlrev_b32 v242, 16, v41
  v_and_b32 v243, 0xffff0000, v41
  v_lshlrev_b32 v244, 16, v42
  v_and_b32 v245, 0xffff0000, v42
  v_lshlrev_b32 v246, 16, v43
  v_and_b32 v247, 0xffff0000, v43
  v_pk_fma_f32 v[128:129], v[240:241], s[56:57], s[56:57] op_sel:[0,0,1] op_sel_hi:[1,0,1]
  v_pk_fma_f32 v[130:131], v[242:243], s[56:57], s[56:57] op_sel:[0,0,1] op_sel_hi:[1,0,1]
  v_pk_fma_f32 v[132:133], v[244:245], s[56:57], s[56:57] op_sel:[0,0,1] op_sel_hi:[1,0,1]
  v_pk_fma_f32 v[134:135], v[246:247], s[56:57], s[56:57] op_sel:[0,0,1] op_sel_hi:[1,0,1]
  v_lshlrev_b32 v240, 16, v44
  v_and_b32 v241, 0xffff0000, v44
  v_lshlrev_b32 v242, 16, v45
  v_and_b32 v243, 0xffff0000, v45
  v_lshlrev_b32 v244, 16, v46
  v_and_b32 v245, 0xffff0000, v46
  v_lshlrev_b32 v246, 16, v47
  v_and_b32 v247, 0xffff0000, v47
  v_pk_fma_f32 v[136:137], v[240:241], s[58:59], s[58:59] op_sel:[0,0,1] op_sel_hi:[1,0,1]
  v_pk_fma_f32 v[138:139], v[242:243], s[58:59], s[58:59] op_sel:[0,0,1] op_sel_hi:[1,0,1]
  v_pk_fma_f32 v[140:141], v[244:245], s[58:59], s[58:59] op_sel:[0,0,1] op_sel_hi:[1,0,1]
  v_pk_fma_f32 v[142:143], v[246:247], s[58:59], s[58:59] op_sel:[0,0,1] op_sel_hi:[1,0,1]
  v_lshlrev_b32 v240, 16, v48
  v_and_b32 v241, 0xffff0000, v48
  v_lshlrev_b32 v242, 16, v49
  v_and_b32 v243, 0xffff0000, v49
  v_lshlrev_b32 v244, 16, v50
  v_and_b32 v245, 0xffff0000, v50
  v_lshlrev_b32 v246, 16, v51
  v_and_b32 v247, 0xffff0000, v51
  v_pk_fma_f32 v[144:145], v[240:241], s[60:61], s[60:61] op_sel:[0,0,1] op_sel_hi:[1,0,1]
  v_pk_fma_f32 v[146:147], v[242:243], s[60:61], s[60:61] op_sel:[0,0,1] op_sel_hi:[1,0,1]
  v_pk_fma_f32 v[148:149], v[244:245], s[60:61], s[60:61] op_sel:[0,0,1] op_sel_hi:[1,0,1]
  v_pk_fma_f32 v[150:151], v[246:247], s[60:61], s[60:61] op_sel:[0,0,1] op_sel_hi:[1,0,1]
  v_lshlrev_b32 v240, 16, v52
  v_and_b32 v241, 0xffff0000, v52
  v_lshlrev_b32 v242, 16, v53
  v_and_b32 v243, 0xffff0000, v53
  v_lshlrev_b32 v244, 16, v54
  v_and_b32 v245, 0xffff0000, v54
  v_lshlrev_b32 v246, 16, v55
  v_and_b32 v247, 0xffff0000, v55
  v_pk_fma_f32 v[152:153], v[240:241], s[62:63], s[62:63] op_sel:[0,0,1] op_sel_hi:[1,0,1]
  v_pk_fma_f32 v[154:155], v[242:243], s[62:63], s[62:63] op_sel:[0,0,1] op_sel_hi:[1,0,1]
  v_pk_fma_f32 v[156:157], v[244:245], s[62:63], s[62:63] op_sel:[0,0,1] op_sel_hi:[1,0,1]
  v_pk_fma_f32 v[158:159], v[246:247], s[62:63], s[62:63] op_sel:[0,0,1] op_sel_hi:[1,0,1]
  v_lshlrev_b32 v240, 16, v56
  v_and_b32 v241, 0xffff0000, v56
  v_lshlrev_b32 v242, 16, v57
  v_and_b32 v243, 0xffff0000, v57
  v_lshlrev_b32 v244, 16, v58
  v_and_b32 v245, 0xffff0000, v58
  v_lshlrev_b32 v246, 16, v59
  v_and_b32 v247, 0xffff0000, v59
  v_pk_fma_f32 v[160:161], v[240:241], s[64:65], s[64:65] op_sel:[0,0,1] op_sel_hi:[1,0,1]
  v_pk_fma_f32 v[162:163], v[242:243], s[64:65], s[64:65] op_sel:[0,0,1] op_sel_hi:[1,0,1]
  v_pk_fma_f32 v[164:165], v[244:245], s[64:65], s[64:65] op_sel:[0,0,1] op_sel_hi:[1,0,1]
  v_pk_fma_f32 v[166:167], v[246:247], s[64:65], s[64:65] op_sel:[0,0,1] op_sel_hi:[1,0,1]
  v_lshlrev_b32 v240, 16, v60
  v_and_b32 v241, 0xffff0000, v60
  v_lshlrev_b32 v242, 16, v61
  v_and_b32 v243, 0xffff0000, v61
  v_lshlrev_b32 v244, 16, v62
  v_and_b32 v245, 0xffff0000, v62
  v_lshlrev_b32 v246, 16, v63
  v_and_b32 v247, 0xffff0000, v63
  v_pk_fma_f32 v[168:169], v[240:241], s[66:67], s[66:67] op_sel:[0,0,1] op_sel_hi:[1,0,1]
  v_pk_fma_f32 v[170:171], v[242:243], s[66:67], s[66:67] op_sel:[0,0,1] op_sel_hi:[1,0,1]
  v_pk_fma_f32 v[172:173], v[244:245], s[66:67], s[66:67] op_sel:[0,0,1] op_sel_hi:[1,0,1]
  v_pk_fma_f32 v[174:175], v[246:247], s[66:67], s[66:67] op_sel:[0,0,1] op_sel_hi:[1,0,1]
  v_lshlrev_b32 v240, 16, v64
  v_and_b32 v241, 0xffff0000, v64
  v_lshlrev_b32 v242, 16, v65
  v_and_b32 v243, 0xffff0000, v65
  v_lshlrev_b32 v244, 16, v66
  v_and_b32 v245, 0xffff0000, v66
  v_lshlrev_b32 v246, 16, v67
  v_and_b32 v247, 0xffff0000, v67
  v_pk_fma_f32 v[176:177], v[240:241], s[68:69], s[68:69] op_sel:[0,0,1] op_sel_hi:[1,0,1]
  v_pk_fma_f32 v[178:179], v[242:243], s[68:69], s[68:69] op_sel:[0,0,1] op_sel_hi:[1,0,1]
  v_pk_fma_f32 v[180:181], v[244:245], s[68:69], s[68:69] op_sel:[0,0,1] op_sel_hi:[1,0,1]
  v_pk_fma_f32 v[182:183], v[246:247], s[68:69], s[68:69] op_sel:[0,0,1] op_sel_hi:[1,0,1]
  v_lshlrev_b32 v240, 16, v68
  v_and_b32 v241, 0xffff0000, v68
  v_lshlrev_b32 v242, 16, v69
  v_and_b32 v243, 0xffff0000, v69
  v_lshlrev_b32 v244, 16, v70
  v_and_b32 v245, 0xffff0000, v70
  v_lshlrev_b32 v246, 16, v71
  v_and_b32 v247, 0xffff0000, v71
  v_pk_fma_f32 v[184:185], v[240:241], s[70:71], s[70:71] op_sel:[0,0,1] op_sel_hi:[1,0,1]
  v_pk_fma_f32 v[186:187], v[242:243], s[70:71], s[70:71] op_sel:[0,0,1] op_sel_hi:[1,0,1]
  v_pk_fma_f32 v[188:189], v[244:245], s[70:71], s[70:71] op_sel:[0,0,1] op_sel_hi:[1,0,1]
  v_pk_fma_f32 v[190:191], v[246:247], s[70:71], s[70:71] op_sel:[0,0,1] op_sel_hi:[1,0,1]
  v_lshlrev_b32 v240, 16, v72
  v_and_b32 v241, 0xffff0000, v72
  v_lshlrev_b32 v242, 16, v73
  v_and_b32 v243, 0xffff0000, v73
  v_lshlrev_b32 v244, 16, v74
  v_and_b32 v245, 0xffff0000, v74
  v_lshlrev_b32 v246, 16, v75
  v_and_b32 v247, 0xffff0000, v75
  v_pk_fma_f32 v[192:193], v[240:241], s[72:73], s[72:73] op_sel:[0,0,1] op_sel_hi:[1,0,1]
  v_pk_fma_f32 v[194:195], v[242:243], s[72:73], s[72:73] op_sel:[0,0,1] op_sel_hi:[1,0,1]
  v_pk_fma_f32 v[196:197], v[244:245], s[72:73], s[72:73] op_sel:[0,0,1] op_sel_hi:[1,0,1]
  v_pk_fma_f32 v[198:199], v[246:247], s[72:73], s[72:73] op_sel:[0,0,1] op_sel_hi:[1,0,1]
  v_lshlrev_b32 v240, 16, v76
  v_and_b32 v241, 0xffff0000, v76
  v_lshlrev_b32 v242, 16, v77
  v_and_b32 v243, 0xffff0000, v77
  v_lshlrev_b32 v244, 16, v78
  v_and_b32 v245, 0xffff0000, v78
  v_lshlrev_b32 v246, 16, v79
  v_and_b32 v247, 0xffff0000, v79
  v_pk_fma_f32 v[200:201], v[240:241], s[74:75], s[74:75] op_sel:[0,0,1] op_sel_hi:[1,0,1]
  v_pk_fma_f32 v[202:203], v[242:243], s[74:75], s[74:75] op_sel:[0,0,1] op_sel_hi:[1,0,1]
  v_pk_fma_f32 v[204:205], v[244:245], s[74:75], s[74:75] op_sel:[0,0,1] op_sel_hi:[1,0,1]
  v_pk_fma_f32 v[206:207], v[246:247], s[74:75], s[74:75] op_sel:[0,0,1] op_sel_hi:[1,0,1]
  s_cmp_ge_u32 s95, 4
  s_cbranch_scc1 L_nokvfr_16
  s_waitcnt vmcnt(16)
  v_and_b32 v8, 15, v1
  v_lshrrev_b32 v9, 2, v8
  v_lshrrev_b32 v10, 5, v1
  v_lshl_add_u32 v9, v10, 3, v9
  v_lshlrev_b32 v9, 6, v9
  v_bfe_u32 v10, v1, 4, 1
  v_lshl_add_u32 v9, v10, 5, v9
  v_and_b32 v10, 3, v8
  v_lshl_add_u32 v9, v10, 3, v9
  s_lshl_b32 s40, s32, 13
  s_add_u32 s40, s40, 65536
  v_add_u32 v10, s40, v9
  ds_read_b64_tr_b16 v[16:17], v10 offset:0
  ds_read_b64_tr_b16 v[18:19], v10 offset:256
  ds_read_b64_tr_b16 v[20:21], v10 offset:1024
  ds_read_b64_tr_b16 v[22:23], v10 offset:1280
  ds_read_b64_tr_b16 v[24:25], v10 offset:2048
  ds_read_b64_tr_b16 v[26:27], v10 offset:2304
  ds_read_b64_tr_b16 v[28:29], v10 offset:3072
  ds_read_b64_tr_b16 v[30:31], v10 offset:3328
  ds_read_b64_tr_b16 v[32:33], v10 offset:4096
  ds_read_b64_tr_b16 v[34:35], v10 offset:4352
  ds_read_b64_tr_b16 v[36:37], v10 offset:5120
  ds_read_b64_tr_b16 v[38:39], v10 offset:5376
  ds_read_b64_tr_b16 v[40:41], v10 offset:6144
  ds_read_b64_tr_b16 v[42:43], v10 offset:6400
  ds_read_b64_tr_b16 v[44:45], v10 offset:7168
  ds_read_b64_tr_b16 v[46:47], v10 offset:7424
L_nokvfr_16:
  s_lshr_b32 s40, s32, 1
  s_lshl_b32 s40, s40, 15
  s_and_b32 s41, s32, 1
  s_lshl_b32 s41, s41, 8
  s_add_u32 s40, s40, s41
  v_lshlrev_b32 v9, 9, v1
  v_and_b32 v10, 7, v1
  v_lshl_add_u32 v9, v10, 4, v9
  v_add_u32 v9, s40, v9
  v_xor_b32 v208, 0, v9
  v_xor_b32 v209, 16, v9
  v_xor_b32 v210, 32, v9
  v_xor_b32 v211, 48, v9
  v_xor_b32 v212, 64, v9
  v_xor_b32 v213, 80, v9
  v_xor_b32 v214, 96, v9
  v_xor_b32 v215, 112, v9
  v_and_b32 v8, 31, v1
  v_lshrrev_b32 v9, 5, v1
  v_xor_b32 v8, v8, v9
  v_lshlrev_b32 v8, 4, v8
  v_lshl_add_u32 v8, v9, 9, v8
  v_xor_b32 v216, 0, v8
  v_xor_b32 v217, 32, v8
  v_xor_b32 v218, 64, v8
  v_xor_b32 v219, 96, v8
  s_waitcnt vmcnt(0) lgkmcnt(0)
  s_mov_b32 s92, 0
L_nl_17:
  v_readfirstlane_b32 s90, v6
  s_cmp_lg_u32 s90, 0
  s_cbranch_scc1 L_nok_18
  s_add_u32 s92, s92, 1
  s_cmp_gt_u32 s92, 200000
  s_cbranch_scc1 L_nok_18
  global_load_dword v6, v5, s[28:29] sc1
  s_waitcnt vmcnt(0)
  s_branch L_nl_17
L_nok_18:
  s_and_b32 s91, s90, 0xffff
  s_lshr_b32 s93, s90, 16
  v_lshlrev_b32 v8, 5, v1
  v_add_u32 v8, 32768, v8
  s_mov_b32 s92, 0
L_s0p_19:
  global_load_dwordx4 v[48:51], v8, s[30:31] sc1
  global_load_dwordx4 v[52:55], v8, s[30:31] offset:16 sc1
  global_load_dwordx4 v[56:59], v8, s[30:31] offset:2048 sc1
  global_load_dwordx4 v[60:63], v8, s[30:31] offset:2064 sc1
  s_add_u32 s92, s92, 1
  s_cmp_gt_u32 s92, 200000
  s_cbranch_scc1 L_s0tm_21
  s_waitcnt vmcnt(0)
  v_xor_b32 v9, s91, v48
  v_xor_b32 v10, s93, v55
  v_xor_b32 v11, s91, v56
  v_xor_b32 v12, s93, v63
  v_xor_b32 v13, s93, v51
  v_xor_b32 v14, s91, v52
  v_or3_b32 v9, v9, v10, v11
  v_or3_b32 v12, v12, v13, v14
  v_xor_b32 v13, s93, v59
  v_xor_b32 v14, s91, v60
  v_or3_b32 v9, v9, v13, v14
  v_or_b32 v9, v9, v12
  v_and_b32 v9, 0xffff, v9
  v_cmp_ne_u32 vcc, 0, v9
  s_cbranch_vccnz L_s0p_19
  s_branch L_s0ok_20
L_s0tm_21:
  s_waitcnt vmcnt(0)
  v_mov_b32 v9, 32
  v_mov_b32 v10, 1
  global_store_dword v9, v10, s[28:29]
L_s0ok_20:
  s_cmp_lt_u32 s36, 5
  s_cbranch_scc1 L_nomod_22
  s_cmp_eq_u32 s36, 7
  s_cbranch_scc1 L_nomod_22
  s_sub_u32 s76, s36, 4
  s_lshl_b32 s76, s76, 10
  s_lshl_b32 s40, s35, 5
  s_add_u32 s76, s76, s40
  s_lshl_b32 s40, s76, 1
  s_add_u32 s98, s24, s40
  s_addc_u32 s99, s25, 0
  v_lshrrev_b32 v8, 2, v0
  v_and_b32 v9, 3, v0
  v_lshlrev_b32 v10, 4, v8
  global_load_dwordx4 a[128:131], v10, s[22:23]
  v_mul_u32_u24 v10, 49152, v8
  v_lshl_add_u32 v10, v9, 4, v10
  global_load_dwordx4 a[132:135], v10, s[98:99]
  v_add_u32 v10, 6144, v10
  global_load_dwordx4 a[136:139], v10, s[98:99]
  v_add_u32 v10, 6144, v10
  global_load_dwordx4 a[140:143], v10, s[98:99]
  v_add_u32 v10, 6144, v10
  global_load_dwordx4 a[144:147], v10, s[98:99]
  v_add_u32 v10, 6144, v10
  global_load_dwordx4 a[148:151], v10, s[98:99]
  v_add_u32 v10, 6144, v10
  global_load_dwordx4 a[152:155], v10, s[98:99]
  v_add_u32 v10, 6144, v10
  global_load_dwordx4 a[156:159], v10, s[98:99]
  v_add_u32 v10, 6144, v10
  global_load_dwordx4 a[160:163], v10, s[98:99]
L_nomod_22:
  v_and_b32 v48, 0xffff0000, v48
  v_and_b32 v56, 0xffff0000, v56
  v_and_b32 v49, 0xffff0000, v49
  v_and_b32 v57, 0xffff0000, v57
  v_and_b32 v50, 0xffff0000, v50
  v_and_b32 v58, 0xffff0000, v58
  v_and_b32 v51, 0xffff0000, v51
  v_and_b32 v59, 0xffff0000, v59
  v_and_b32 v52, 0xffff0000, v52
  v_and_b32 v60, 0xffff0000, v60
  v_and_b32 v53, 0xffff0000, v53
  v_and_b32 v61, 0xffff0000, v61
  v_and_b32 v54, 0xffff0000, v54
  v_and_b32 v62, 0xffff0000, v62
  v_and_b32 v55, 0xffff0000, v55
  v_and_b32 v63, 0xffff0000, v63
  v_add_f32 v56, 1.0, v56
  v_add_f32 v57, 1.0, v57
  v_add_f32 v58, 1.0, v58
  v_add_f32 v59, 1.0, v59
  v_add_f32 v60, 1.0, v60
  v_add_f32 v61, 1.0, v61
  v_add_f32 v62, 1.0, v62
  v_add_f32 v63, 1.0, v63
  v_pk_fma_f32 v[64:65], v[80:81], v[56:57], v[48:49]
  v_pk_fma_f32 v[66:67], v[82:83], v[58:59], v[50:51]
  v_pk_fma_f32 v[68:69], v[84:85], v[60:61], v[52:53]
  v_pk_fma_f32 v[70:71], v[86:87], v[62:63], v[54:55]
  v_cvt_pk_bf16_f32 v72, v64, v65
  v_cvt_pk_bf16_f32 v73, v66, v67
  v_cvt_pk_bf16_f32 v74, v68, v69
  v_cvt_pk_bf16_f32 v75, v70, v71
  ds_write_b128 v208, v[72:75] offset:0
  v_pk_fma_f32 v[64:65], v[88:89], v[56:57], v[48:49]
  v_pk_fma_f32 v[66:67], v[90:91], v[58:59], v[50:51]
  v_pk_fma_f32 v[68:69], v[92:93], v[60:61], v[52:53]
  v_pk_fma_f32 v[70:71], v[94:95], v[62:63], v[54:55]
  v_cvt_pk_bf16_f32 v76, v64, v65
  v_cvt_pk_bf16_f32 v77, v66, v67
  v_cvt_pk_bf16_f32 v78, v68, v69
  v_cvt_pk_bf16_f32 v79, v70, v71
  ds_write_b128 v209, v[76:79] offset:0
  v_pk_fma_f32 v[64:65], v[96:97], v[56:57], v[48:49]
  v_pk_fma_f32 v[66:67], v[98:99], v[58:59], v[50:51]
  v_pk_fma_f32 v[68:69], v[100:101], v[60:61], v[52:53]
  v_pk_fma_f32 v[70:71], v[102:103], v[62:63], v[54:55]
  v_cvt_pk_bf16_f32 v72, v64, v65
  v_cvt_pk_bf16_f32 v73, v66, v67
  v_cvt_pk_bf16_f32 v74, v68, v69
  v_cvt_pk_bf16_f32 v75, v70, v71
  ds_write_b128 v210, v[72:75] offset:0
  v_pk_fma_f32 v[64:65], v[104:105], v[56:57], v[48:49]
  v_pk_fma_f32 v[66:67], v[106:107], v[58:59], v[50:51]
  v_pk_fma_f32 v[68:69], v[108:109], v[60:61], v[52:53]
  v_pk_fma_f32 v[70:71], v[110:111], v[62:63], v[54:55]
  v_cvt_pk_bf16_f32 v76, v64, v65
  v_cvt_pk_bf16_f32 v77, v66, v67
  v_cvt_pk_bf16_f32 v78, v68, v69
  v_cvt_pk_bf16_f32 v79, v70, v71
  ds_write_b128 v211, v[76:79] offset:0
  v_pk_fma_f32 v[64:65], v[112:113], v[56:57], v[48:49]
  v_pk_fma_f32 v[66:67], v[114:115], v[58:59], v[50:51]
  v_pk_fma_f32 v[68:69], v[116:117], v[60:61], v[52:53]
  v_pk_fma_f32 v[70:71], v[118:119], v[62:63], v[54:55]
  v_cvt_pk_bf16_f32 v72, v64, v65
  v_cvt_pk_bf16_f32 v73, v66, v67
  v_cvt_pk_bf16_f32 v74, v68, v69
  v_cvt_pk_bf16_f32 v75, v70, v71
  ds_write_b128 v212, v[72:75] offset:0
  v_pk_fma_f32 v[64:65], v[120:121], v[56:57], v[48:49]
  v_pk_fma_f32 v[66:67], v[122:123], v[58:59], v[50:51]
  v_pk_fma_f32 v[68:69], v[124:125], v[60:61], v[52:53]
  v_pk_fma_f32 v[70:71], v[126:127], v[62:63], v[54:55]
  v_cvt_pk_bf16_f32 v76, v64, v65
  v_cvt_pk_bf16_f32 v77, v66, v67
  v_cvt_pk_bf16_f32 v78, v68, v69
  v_cvt_pk_bf16_f32 v79, v70, v71
  ds_write_b128 v213, v[76:79] offset:0
  v_pk_fma_f32 v[64:65], v[128:129], v[56:57], v[48:49]
  v_pk_fma_f32 v[66:67], v[130:131], v[58:59], v[50:51]
  v_pk_fma_f32 v[68:69], v[132:133], v[60:61], v[52:53]
  v_pk_fma_f32 v[70:71], v[134:135], v[62:63], v[54:55]
  v_cvt_pk_bf16_f32 v72, v64, v65
  v_cvt_pk_bf16_f32 v73, v66, v67
  v_cvt_pk_bf16_f32 v74, v68, v69
  v_cvt_pk_bf16_f32 v75, v70, v71
  ds_write_b128 v214, v[72:75] offset:0
  v_pk_fma_f32 v[64:65], v[136:137], v[56:57], v[48:49]
  v_pk_fma_f32 v[66:67], v[138:139], v[58:59], v[50:51]
  v_pk_fma_f32 v[68:69], v[140:141], v[60:61], v[52:53]
  v_pk_fma_f32 v[70:71], v[142:143], v[62:63], v[54:55]
  v_cvt_pk_bf16_f32 v76, v64, v65
  v_cvt_pk_bf16_f32 v77, v66, v67
  v_cvt_pk_bf16_f32 v78, v68, v69
  v_cvt_pk_bf16_f32 v79, v70, v71
  ds_write_b128 v215, v[76:79] offset:0
  v_pk_fma_f32 v[64:65], v[144:145], v[56:57], v[48:49]
  v_pk_fma_f32 v[66:67], v[146:147], v[58:59], v[50:51]
  v_pk_fma_f32 v[68:69], v[148:149], v[60:61], v[52:53]
  v_pk_fma_f32 v[70:71], v[150:151], v[62:63], v[54:55]
  v_cvt_pk_bf16_f32 v72, v64, v65
  v_cvt_pk_bf16_f32 v73, v66, v67
  v_cvt_pk_bf16_f32 v74, v68, v69
  v_cvt_pk_bf16_f32 v75, v70, v71
  ds_write_b128 v208, v[72:75] offset:128
  v_pk_fma_f32 v[64:65], v[152:153], v[56:57], v[48:49]
  v_pk_fma_f32 v[66:67], v[154:155], v[58:59], v[50:51]
  v_pk_fma_f32 v[68:69], v[156:157], v[60:61], v[52:53]
  v_pk_fma_f32 v[70:71], v[158:159], v[62:63], v[54:55]
  v_cvt_pk_bf16_f32 v76, v64, v65
  v_cvt_pk_bf16_f32 v77, v66, v67
  v_cvt_pk_bf16_f32 v78, v68, v69
  v_cvt_pk_bf16_f32 v79, v70, v71
  ds_write_b128 v209, v[76:79] offset:128
  v_pk_fma_f32 v[64:65], v[160:161], v[56:57], v[48:49]
  v_pk_fma_f32 v[66:67], v[162:163], v[58:59], v[50:51]
  v_pk_fma_f32 v[68:69], v[164:165], v[60:61], v[52:53]
  v_pk_fma_f32 v[70:71], v[166:167], v[62:63], v[54:55]
  v_cvt_pk_bf16_f32 v72, v64, v65
  v_cvt_pk_bf16_f32 v73, v66, v67
  v_cvt_pk_bf16_f32 v74, v68, v69
  v_cvt_pk_bf16_f32 v75, v70, v71
  ds_write_b128 v210, v[72:75] offset:128
  v_pk_fma_f32 v[64:65], v[168:169], v[56:57], v[48:49]
  v_pk_fma_f32 v[66:67], v[170:171], v[58:59], v[50:51]
  v_pk_fma_f32 v[68:69], v[172:173], v[60:61], v[52:53]
  v_pk_fma_f32 v[70:71], v[174:175], v[62:63], v[54:55]
  v_cvt_pk_bf16_f32 v76, v64, v65
  v_cvt_pk_bf16_f32 v77, v66, v67
  v_cvt_pk_bf16_f32 v78, v68, v69
  v_cvt_pk_bf16_f32 v79, v70, v71
  ds_write_b128 v211, v[76:79] offset:128
  v_pk_fma_f32 v[64:65], v[176:177], v[56:57], v[48:49]
  v_pk_fma_f32 v[66:67], v[178:179], v[58:59], v[50:51]
  v_pk_fma_f32 v[68:69], v[180:181], v[60:61], v[52:53]
  v_pk_fma_f32 v[70:71], v[182:183], v[62:63], v[54:55]
  v_cvt_pk_bf16_f32 v72, v64, v65
  v_cvt_pk_bf16_f32 v73, v66, v67
  v_cvt_pk_bf16_f32 v74, v68, v69
  v_cvt_pk_bf16_f32 v75, v70, v71
  ds_write_b128 v212, v[72:75] offset:128
  v_pk_fma_f32 v[64:65], v[184:185], v[56:57], v[48:49]
  v_pk_fma_f32 v[66:67], v[186:187], v[58:59], v[50:51]
  v_pk_fma_f32 v[68:69], v[188:189], v[60:61], v[52:53]
  v_pk_fma_f32 v[70:71], v[190:191], v[62:63], v[54:55]
  v_cvt_pk_bf16_f32 v76, v64, v65
  v_cvt_pk_bf16_f32 v77, v66, v67
  v_cvt_pk_bf16_f32 v78, v68, v69
  v_cvt_pk_bf16_f32 v79, v70, v71
  ds_write_b128 v213, v[76:79] offset:128
  v_pk_fma_f32 v[64:65], v[192:193], v[56:57], v[48:49]
  v_pk_fma_f32 v[66:67], v[194:195], v[58:59], v[50:51]
  v_pk_fma_f32 v[68:69], v[196:197], v[60:61], v[52:53]
  v_pk_fma_f32 v[70:71], v[198:199], v[62:63], v[54:55]
  v_cvt_pk_bf16_f32 v72, v64, v65
  v_cvt_pk_bf16_f32 v73, v66, v67
  v_cvt_pk_bf16_f32 v74, v68, v69
  v_cvt_pk_bf16_f32 v75, v70, v71
  ds_write_b128 v214, v[72:75] offset:128
  v_pk_fma_f32 v[64:65], v[200:201], v[56:57], v[48:49]
  v_pk_fma_f32 v[66:67], v[202:203], v[58:59], v[50:51]
  v_pk_fma_f32 v[68:69], v[204:205], v[60:61], v[52:53]
  v_pk_fma_f32 v[70:71], v[206:207], v[62:63], v[54:55]
  v_cvt_pk_bf16_f32 v76, v64, v65
  v_cvt_pk_bf16_f32 v77, v66, v67
  v_cvt_pk_bf16_f32 v78, v68, v69
  v_cvt_pk_bf16_f32 v79, v70, v71
  ds_write_b128 v215, v[76:79] offset:128
  s_waitcnt lgkmcnt(0)
  s_barrier
  s_cmp_ge_u32 s95, 4
  s_cbranch_scc1 L_nokv_25
  s_and_b32 s40, s95, 1
  s_lshl_b32 s40, s40, 15
  s_lshl_b32 s41, s32, 13
  s_add_u32 s40, s40, s41
  v_add_u32 v220, s40, v216
  v_add_u32 v221, s40, v217
  v_add_u32 v222, s40, v218
  v_add_u32 v223, s40, v219
  ds_read_b128 v[80:83], v220 offset:0
  ds_read_b128 v[84:87], v221 offset:1024
  ds_read_b128 v[88:91], v222 offset:2048
  ds_read_b128 v[92:95], v223 offset:3072
  ds_read_b128 v[96:99], v220 offset:4096
  ds_read_b128 v[100:103], v221 offset:5120
  ds_read_b128 v[104:107], v222 offset:6144
  ds_read_b128 v[108:111], v223 offset:7168
  s_cmp_ge_u32 s95, 2
  s_cbranch_scc1 L_vch_26
  s_waitcnt lgkmcnt(7)
  v_mfma_f32_32x32x16_bf16 v[112:127], v[16:19], v[80:83], 0
  s_waitcnt lgkmcnt(6)
  v_mfma_f32_32x32x16_bf16 v[112:127], v[20:23], v[84:87], v[112:127]
  s_waitcnt lgkmcnt(5)
  v_mfma_f32_32x32x16_bf16 v[112:127], v[24:27], v[88:91], v[112:127]
  s_waitcnt lgkmcnt(4)
  v_mfma_f32_32x32x16_bf16 v[112:127], v[28:31], v[92:95], v[112:127]
  s_waitcnt lgkmcnt(3)
  v_mfma_f32_32x32x16_bf16 v[112:127], v[32:35], v[96:99], v[112:127]
  s_waitcnt lgkmcnt(2)
  v_mfma_f32_32x32x16_bf16 v[112:127], v[36:39], v[100:103], v[112:127]
  s_waitcnt lgkmcnt(1)
  v_mfma_f32_32x32x16_bf16 v[112:127], v[40:43], v[104:107], v[112:127]
  s_waitcnt lgkmcnt(0)
  v_mfma_f32_32x32x16_bf16 v[112:127], v[44:47], v[108:111], v[112:127]
  s_branch L_kvred_27
L_vch_26:
  s_waitcnt lgkmcnt(7)
  v_mfma_f32_32x32x16_bf16 v[112:127], v[80:83], v[16:19], 0
  s_waitcnt lgkmcnt(6)
  v_mfma_f32_32x32x16_bf16 v[112:127], v[84:87], v[20:23], v[112:127]
  s_waitcnt lgkmcnt(5)
  v_mfma_f32_32x32x16_bf16 v[112:127], v[88:91], v[24:27], v[112:127]
  s_waitcnt lgkmcnt(4)
  v_mfma_f32_32x32x16_bf16 v[112:127], v[92:95], v[28:31], v[112:127]
  s_waitcnt lgkmcnt(3)
  v_mfma_f32_32x32x16_bf16 v[112:127], v[96:99], v[32:35], v[112:127]
  s_waitcnt lgkmcnt(2)
  v_mfma_f32_32x32x16_bf16 v[112:127], v[100:103], v[36:39], v[112:127]
  s_waitcnt lgkmcnt(1)
  v_mfma_f32_32x32x16_bf16 v[112:127], v[104:107], v[40:43], v[112:127]
  s_waitcnt lgkmcnt(0)
  v_mfma_f32_32x32x16_bf16 v[112:127], v[108:111], v[44:47], v[112:127]
L_kvred_27:
  s_lshl_b32 s40, s32, 12
  s_add_u32 s40, s40, 65536
  v_add_u32 v8, s40, v2
  s_nop 10
  ds_write_b128 v8, v[112:115] offset:0
  ds_write_b128 v8, v[116:119] offset:1024
  ds_write_b128 v8, v[120:123] offset:2048
  ds_write_b128 v8, v[124:127] offset:3072
  s_waitcnt lgkmcnt(0)
  s_barrier
  s_cmp_ge_u32 s32, 2
  s_cbranch_scc1 L_kvdone_28
  s_cmp_ge_u32 s95, 2
  s_cselect_b32 s41, 1, 0
  s_cmp_eq_u32 s32, 1
  s_cselect_b32 s42, 1, 0
  s_sub_u32 s42, s42, s41
  s_cmp_eq_u32 s42, 1
  s_cbranch_scc1 L_kvdone_28
  s_mov_b32 s88, 1
  s_lshl_b32 s40, s32, 11
  s_add_u32 s40, s40, 65536
  v_add_u32 v8, s40, v2
  ds_read_b128 v[80:83], v8 offset:0
  ds_read_b128 v[84:87], v8 offset:1024
  ds_read_b128 v[88:91], v8 offset:4096
  ds_read_b128 v[92:95], v8 offset:5120
  ds_read_b128 v[96:99], v8 offset:8192
  ds_read_b128 v[100:103], v8 offset:9216
  ds_read_b128 v[104:107], v8 offset:12288
  ds_read_b128 v[108:111], v8 offset:13312
  s_waitcnt lgkmcnt(0)
  v_add_f32 v80, v80, v88
  v_add_f32 v96, v96, v104
  v_add_f32 v81, v81, v89
  v_add_f32 v97, v97, v105
  v_add_f32 v82, v82, v90
  v_add_f32 v98, v98, v106
  v_add_f32 v83, v83, v91
  v_add_f32 v99, v99, v107
  v_add_f32 v84, v84, v92
  v_add_f32 v100, v100, v108
  v_add_f32 v85, v85, v93
  v_add_f32 v101, v101, v109
  v_add_f32 v86, v86, v94
  v_add_f32 v102, v102, v110
  v_add_f32 v87, v87, v95
  v_add_f32 v103, v103, v111
  v_add_f32 v80, v80, v96
  v_add_f32 v81, v81, v97
  v_add_f32 v82, v82, v98
  v_add_f32 v83, v83, v99
  v_add_f32 v84, v84, v100
  v_add_f32 v85, v85, v101
  v_add_f32 v86, v86, v102
  v_add_f32 v87, v87, v103
  v_cvt_pk_bf16_f32 v112, v80, v81
  v_cvt_pk_bf16_f32 v113, v82, v83
  v_cvt_pk_bf16_f32 v114, v84, v85
  v_cvt_pk_bf16_f32 v115, v86, v87
  s_and_b32 s40, s95, 1
  s_lshl_b32 s41, s35, 1
  s_add_u32 s40, s40, s41
  s_cmp_ge_u32 s95, 2
  s_cbranch_scc1 L_kvvst_29
  s_lshl_b32 s41, s40, 10
  s_add_u32 s41, s41, 262144
  v_add_u32 v8, s41, v2
  global_store_dwordx4 v8, v[112:115], s[30:31] sc1
  v_mov_b32 v9, 0
  v_dot2_f32_bf16 v9, v112, v112, v9
  v_dot2_f32_bf16 v9, v113, v113, v9
  v_dot2_f32_bf16 v9, v114, v114, v9
  v_dot2_f32_bf16 v9, v115, v115, v9
  s_nop 2
  v_mov_b32 v10, v9
  s_nop 1
  v_permlane32_swap_b32 v9, v10
  v_add_f32 v9, v9, v10
  s_nop 1
  v_max_f32_dpp v9, v9, v9 row_ror:8 row_mask:0xf bank_mask:0xf
  s_nop 1
  v_max_f32_dpp v9, v9, v9 row_ror:4 row_mask:0xf bank_mask:0xf
  s_nop 1
  v_max_f32_dpp v9, v9, v9 row_ror:2 row_mask:0xf bank_mask:0xf
  s_nop 1
  v_max_f32_dpp v9, v9, v9 row_ror:1 row_mask:0xf bank_mask:0xf
  s_nop 1
  v_mov_b32 v10, v9
  s_nop 1
  v_permlane16_swap_b32 v9, v10
  v_max_f32 v9, v9, v10
  s_lshl_b32 s41, s40, 2
  s_add_u32 s41, s41, 49152
  v_mov_b32 v10, s41
  s_mov_b64 exec, 1
  global_store_dword v10, v9, s[30:31] sc1
  s_mov_b64 exec, -1
  s_branch L_kvdone_28
L_kvvst_29:
  s_lshl_b32 s40, s40, 1
  s_add_u32 s40, s40, s32
  s_lshl_b32 s40, s40, 9
  s_add_u32 s40, s40, 327680
  v_and_b32 v8, 15, v1
  v_lshlrev_b32 v8, 4, v8
  v_lshrrev_b32 v9, 5, v1
  v_lshl_add_u32 v8, v9, 8, v8
  v_add_u32 v8, s40, v8
  s_mov_b32 s42, 0xffff0000
  s_mov_b32 s43, 0xffff0000
  s_mov_b64 exec, s[42:43]
  global_store_dwordx4 v8, v[112:115], s[30:31] sc1
  s_mov_b64 exec, -1
L_kvdone_28:
L_nokv_25:
  v_and_b32 v8, 15, v1
  v_lshrrev_b32 v9, 2, v8
  v_lshrrev_b32 v10, 5, v1
  v_lshl_add_u32 v9, v10, 3, v9
  v_lshlrev_b32 v9, 6, v9
  v_bfe_u32 v10, v1, 4, 1
  v_lshl_add_u32 v9, v10, 5, v9
  v_and_b32 v10, 3, v8
  v_lshl_add_u32 v9, v10, 3, v9
  s_lshr_b32 s40, s32, 1
  s_lshl_b32 s40, s40, 15
  s_add_u32 s40, s40, 98304
  v_add_u32 v10, s40, v9
  ds_read_b64_tr_b16 a[0:1], v10 offset:0
  ds_read_b64_tr_b16 a[2:3], v10 offset:256
  ds_read_b64_tr_b16 a[4:5], v10 offset:1024
  ds_read_b64_tr_b16 a[6:7], v10 offset:1280
  ds_read_b64_tr_b16 a[8:9], v10 offset:2048
  ds_read_b64_tr_b16 a[10:11], v10 offset:2304
  ds_read_b64_tr_b16 a[12:13], v10 offset:3072
  ds_read_b64_tr_b16 a[14:15], v10 offset:3328
  ds_read_b64_tr_b16 a[16:17], v10 offset:4096
  ds_read_b64_tr_b16 a[18:19], v10 offset:4352
  ds_read_b64_tr_b16 a[20:21], v10 offset:5120
  ds_read_b64_tr_b16 a[22:23], v10 offset:5376
  ds_read_b64_tr_b16 a[24:25], v10 offset:6144
  ds_read_b64_tr_b16 a[26:27], v10 offset:6400
  ds_read_b64_tr_b16 a[28:29], v10 offset:7168
  ds_read_b64_tr_b16 a[30:31], v10 offset:7424
  ds_read_b64_tr_b16 a[32:33], v10 offset:8192
  ds_read_b64_tr_b16 a[34:35], v10 offset:8448
  ds_read_b64_tr_b16 a[36:37], v10 offset:9216
  ds_read_b64_tr_b16 a[38:39], v10 offset:9472
  ds_read_b64_tr_b16 a[40:41], v10 offset:10240
  ds_read_b64_tr_b16 a[42:43], v10 offset:10496
  ds_read_b64_tr_b16 a[44:45], v10 offset:11264
  ds_read_b64_tr_b16 a[46:47], v10 offset:11520
  ds_read_b64_tr_b16 a[48:49], v10 offset:12288
  ds_read_b64_tr_b16 a[50:51], v10 offset:12544
  ds_read_b64_tr_b16 a[52:53], v10 offset:13312
  ds_read_b64_tr_b16 a[54:55], v10 offset:13568
  ds_read_b64_tr_b16 a[56:57], v10 offset:14336
  ds_read_b64_tr_b16 a[58:59], v10 offset:14592
  ds_read_b64_tr_b16 a[60:61], v10 offset:15360
  ds_read_b64_tr_b16 a[62:63], v10 offset:15616
  ds_read_b64_tr_b16 a[64:65], v10 offset:16384
  ds_read_b64_tr_b16 a[66:67], v10 offset:16640
  ds_read_b64_tr_b16 a[68:69], v10 offset:17408
  ds_read_b64_tr_b16 a[70:71], v10 offset:17664
  ds_read_b64_tr_b16 a[72:73], v10 offset:18432
  ds_read_b64_tr_b16 a[74:75], v10 offset:18688
  ds_read_b64_tr_b16 a[76:77], v10 offset:19456
  ds_read_b64_tr_b16 a[78:79], v10 offset:19712
  ds_read_b64_tr_b16 a[80:81], v10 offset:20480
  ds_read_b64_tr_b16 a[82:83], v10 offset:20736
  ds_read_b64_tr_b16 a[84:85], v10 offset:21504
  ds_read_b64_tr_b16 a[86:87], v10 offset:21760
  ds_read_b64_tr_b16 a[88:89], v10 offset:22528
  ds_read_b64_tr_b16 a[90:91], v10 offset:22784
  ds_read_b64_tr_b16 a[92:93], v10 offset:23552
  ds_read_b64_tr_b16 a[94:95], v10 offset:23808
  ds_read_b64_tr_b16 a[96:97], v10 offset:24576
  ds_read_b64_tr_b16 a[98:99], v10 offset:24832
  ds_read_b64_tr_b16 a[100:101], v10 offset:25600
  ds_read_b64_tr_b16 a[102:103], v10 offset:25856
  ds_read_b64_tr_b16 a[104:105], v10 offset:26624
  ds_read_b64_tr_b16 a[106:107], v10 offset:26880
  ds_read_b64_tr_b16 a[108:109], v10 offset:27648
  ds_read_b64_tr_b16 a[110:111], v10 offset:27904
  ds_read_b64_tr_b16 a[112:113], v10 offset:28672
  ds_read_b64_tr_b16 a[114:115], v10 offset:28928
  ds_read_b64_tr_b16 a[116:117], v10 offset:29696
  ds_read_b64_tr_b16 a[118:119], v10 offset:29952
  ds_read_b64_tr_b16 a[120:121], v10 offset:30720
  ds_read_b64_tr_b16 a[122:123], v10 offset:30976
  ds_read_b64_tr_b16 a[124:125], v10 offset:31744
  ds_read_b64_tr_b16 a[126:127], v10 offset:32000
  s_cmp_ge_u32 s95, 4
  s_cbranch_scc1 L_nokva_30
  s_waitcnt vmcnt(0)
  s_barrier
  s_cmp_lg_u32 s32, 0
  s_cbranch_scc1 L_nokvw_31
  v_lshlrev_b32 v8, 10, v1
  s_lshl_b32 s40, s33, 7
  s_add_u32 s40, s40, 24576
  v_add_u32 v8, s40, v8
  v_mov_b32 v9, 1
  s_mov_b64 exec, 0xff
  global_atomic_add v8, v9, s[30:31] sc1
  s_mov_b64 exec, -1
L_nokvw_31:
L_nokva_30:
  s_waitcnt lgkmcnt(0)
  s_and_b32 s40, s32, 1
  s_lshl_b32 s40, s40, 15
  v_add_u32 v220, s40, v216
  v_add_u32 v221, s40, v217
  v_add_u32 v222, s40, v218
  v_add_u32 v223, s40, v219
  ds_read_b128 v[80:83], v220 offset:0
  ds_read_b128 v[84:87], v221 offset:1024
  ds_read_b128 v[88:91], v222 offset:2048
  ds_read_b128 v[92:95], v223 offset:3072
  ds_read_b128 v[96:99], v220 offset:4096
  ds_read_b128 v[100:103], v221 offset:5120
  ds_read_b128 v[104:107], v222 offset:6144
  ds_read_b128 v[108:111], v223 offset:7168
  s_waitcnt lgkmcnt(7)
  v_mfma_f32_32x32x16_bf16 v[112:127], a[0:3], v[80:83], 0
  ds_read_b128 v[80:83], v220 offset:8192
  s_waitcnt lgkmcnt(7)
  v_mfma_f32_32x32x16_bf16 v[112:127], a[4:7], v[84:87], v[112:127]
  ds_read_b128 v[84:87], v221 offset:9216
  s_waitcnt lgkmcnt(7)
  v_mfma_f32_32x32x16_bf16 v[112:127], a[8:11], v[88:91], v[112:127]
  ds_read_b128 v[88:91], v222 offset:10240
  s_waitcnt lgkmcnt(7)
  v_mfma_f32_32x32x16_bf16 v[112:127], a[12:15], v[92:95], v[112:127]
  ds_read_b128 v[92:95], v223 offset:11264
  s_waitcnt lgkmcnt(7)
  v_mfma_f32_32x32x16_bf16 v[112:127], a[16:19], v[96:99], v[112:127]
  ds_read_b128 v[96:99], v220 offset:12288
  s_waitcnt lgkmcnt(7)
  v_mfma_f32_32x32x16_bf16 v[112:127], a[20:23], v[100:103], v[112:127]
  ds_read_b128 v[100:103], v221 offset:13312
  s_waitcnt lgkmcnt(7)
  v_mfma_f32_32x32x16_bf16 v[112:127], a[24:27], v[104:107], v[112:127]
  ds_read_b128 v[104:107], v222 offset:14336
  s_waitcnt lgkmcnt(7)
  v_mfma_f32_32x32x16_bf16 v[112:127], a[28:31], v[108:111], v[112:127]
  ds_read_b128 v[108:111], v223 offset:15360
  s_waitcnt lgkmcnt(7)
  v_mfma_f32_32x32x16_bf16 v[112:127], a[32:35], v[80:83], v[112:127]
  ds_read_b128 v[80:83], v220 offset:16384
  s_waitcnt lgkmcnt(7)
  v_mfma_f32_32x32x16_bf16 v[112:127], a[36:39], v[84:87], v[112:127]
  ds_read_b128 v[84:87], v221 offset:17408
  s_waitcnt lgkmcnt(7)
  v_mfma_f32_32x32x16_bf16 v[112:127], a[40:43], v[88:91], v[112:127]
  ds_read_b128 v[88:91], v222 offset:18432
  s_waitcnt lgkmcnt(7)
  v_mfma_f32_32x32x16_bf16 v[112:127], a[44:47], v[92:95], v[112:127]
  ds_read_b128 v[92:95], v223 offset:19456
  s_waitcnt lgkmcnt(7)
  v_mfma_f32_32x32x16_bf16 v[112:127], a[48:51], v[96:99], v[112:127]
  ds_read_b128 v[96:99], v220 offset:20480
  s_waitcnt lgkmcnt(7)
  v_mfma_f32_32x32x16_bf16 v[112:127], a[52:55], v[100:103], v[112:127]
  ds_read_b128 v[100:103], v221 offset:21504
  s_waitcnt lgkmcnt(7)
  v_mfma_f32_32x32x16_bf16 v[112:127], a[56:59], v[104:107], v[112:127]
  ds_read_b128 v[104:107], v222 offset:22528
  s_waitcnt lgkmcnt(7)
  v_mfma_f32_32x32x16_bf16 v[112:127], a[60:63], v[108:111], v[112:127]
  ds_read_b128 v[108:111], v223 offset:23552
  s_waitcnt lgkmcnt(7)
  v_mfma_f32_32x32x16_bf16 v[112:127], a[64:67], v[80:83], v[112:127]
  ds_read_b128 v[80:83], v220 offset:24576
  s_waitcnt lgkmcnt(7)
  v_mfma_f32_32x32x16_bf16 v[112:127], a[68:71], v[84:87], v[112:127]
  ds_read_b128 v[84:87], v221 offset:25600
  s_waitcnt lgkmcnt(7)
  v_mfma_f32_32x32x16_bf16 v[112:127], a[72:75], v[88:91], v[112:127]
  ds_read_b128 v[88:91], v222 offset:26624
  s_waitcnt lgkmcnt(7)
  v_mfma_f32_32x32x16_bf16 v[112:127], a[76:79], v[92:95], v[112:127]
  ds_read_b128 v[92:95], v223 offset:27648
  s_waitcnt lgkmcnt(7)
  v_mfma_f32_32x32x16_bf16 v[112:127], a[80:83], v[96:99], v[112:127]
  ds_read_b128 v[96:99], v220 offset:28672
  s_waitcnt lgkmcnt(7)
  v_mfma_f32_32x32x16_bf16 v[112:127], a[84:87], v[100:103], v[112:127]
  ds_read_b128 v[100:103], v221 offset:29696
  s_waitcnt lgkmcnt(7)
  v_mfma_f32_32x32x16_bf16 v[112:127], a[88:91], v[104:107], v[112:127]
  ds_read_b128 v[104:107], v222 offset:30720
  s_waitcnt lgkmcnt(7)
  v_mfma_f32_32x32x16_bf16 v[112:127], a[92:95], v[108:111], v[112:127]
  ds_read_b128 v[108:111], v223 offset:31744
  s_waitcnt lgkmcnt(7)
  v_mfma_f32_32x32x16_bf16 v[112:127], a[96:99], v[80:83], v[112:127]
  s_waitcnt lgkmcnt(6)
  v_mfma_f32_32x32x16_bf16 v[112:127], a[100:103], v[84:87], v[112:127]
  s_waitcnt lgkmcnt(5)
  v_mfma_f32_32x32x16_bf16 v[112:127], a[104:107], v[88:91], v[112:127]
  s_waitcnt lgkmcnt(4)
  v_mfma_f32_32x32x16_bf16 v[112:127], a[108:111], v[92:95], v[112:127]
  s_waitcnt lgkmcnt(3)
  v_mfma_f32_32x32x16_bf16 v[112:127], a[112:115], v[96:99], v[112:127]
  s_waitcnt lgkmcnt(2)
  v_mfma_f32_32x32x16_bf16 v[112:127], a[116:119], v[100:103], v[112:127]
  s_waitcnt lgkmcnt(1)
  v_mfma_f32_32x32x16_bf16 v[112:127], a[120:123], v[104:107], v[112:127]
  s_waitcnt lgkmcnt(0)
  v_mfma_f32_32x32x16_bf16 v[112:127], a[124:127], v[108:111], v[112:127]
  s_mov_b32 s40, 0x3eb8aa3b
  s_nop 10
  v_mul_f32 v112, s40, v112
  v_mul_f32 v113, s40, v113
  v_mul_f32 v114, s40, v114
  v_mul_f32 v115, s40, v115
  v_mul_f32 v116, s40, v116
  v_mul_f32 v117, s40, v117
  v_mul_f32 v118, s40, v118
  v_mul_f32 v119, s40, v119
  v_mul_f32 v120, s40, v120
  v_mul_f32 v121, s40, v121
  v_mul_f32 v122, s40, v122
  v_mul_f32 v123, s40, v123
  v_mul_f32 v124, s40, v124
  v_mul_f32 v125, s40, v125
  v_mul_f32 v126, s40, v126
  v_mul_f32 v127, s40, v127
  v_cvt_pk_bf16_f32 v128, v112, v113
  v_cvt_pk_bf16_f32 v129, v114, v115
  v_cvt_pk_bf16_f32 v130, v116, v117
  v_cvt_pk_bf16_f32 v131, v118, v119
  v_cvt_pk_bf16_f32 v132, v120, v121
  v_cvt_pk_bf16_f32 v133, v122, v123
  v_cvt_pk_bf16_f32 v134, v124, v125
  v_cvt_pk_bf16_f32 v135, v126, v127
  s_cmp_lt_u32 s36, 5
  s_cbranch_scc1 L_nomod_32
  s_cmp_eq_u32 s36, 7
  s_cbranch_scc1 L_nomod_32
  s_sub_u32 s76, s36, 4
  s_lshl_b32 s76, s76, 10
  s_lshl_b32 s40, s35, 5
  s_add_u32 s76, s76, s40
  s_lshl_b32 s40, s76, 1
  s_add_u32 s98, s24, s40
  s_addc_u32 s99, s25, 0
  v_lshrrev_b32 v8, 2, v0
  v_and_b32 v9, 3, v0
  s_waitcnt vmcnt(0)
  v_accvgpr_read_b32 v48, a128
  v_accvgpr_read_b32 v49, a129
  v_accvgpr_read_b32 v50, a130
  v_accvgpr_read_b32 v51, a131
  v_accvgpr_read_b32 v16, a132
  v_accvgpr_read_b32 v17, a133
  v_accvgpr_read_b32 v18, a134
  v_accvgpr_read_b32 v19, a135
  v_accvgpr_read_b32 v20, a136
  v_accvgpr_read_b32 v21, a137
  v_accvgpr_read_b32 v22, a138
  v_accvgpr_read_b32 v23, a139
  v_accvgpr_read_b32 v24, a140
  v_accvgpr_read_b32 v25, a141
  v_accvgpr_read_b32 v26, a142
  v_accvgpr_read_b32 v27, a143
  v_accvgpr_read_b32 v28, a144
  v_accvgpr_read_b32 v29, a145
  v_accvgpr_read_b32 v30, a146
  v_accvgpr_read_b32 v31, a147
  v_accvgpr_read_b32 v32, a148
  v_accvgpr_read_b32 v33, a149
  v_accvgpr_read_b32 v34, a150
  v_accvgpr_read_b32 v35, a151
  v_accvgpr_read_b32 v36, a152
  v_accvgpr_read_b32 v37, a153
  v_accvgpr_read_b32 v38, a154
  v_accvgpr_read_b32 v39, a155
  v_accvgpr_read_b32 v40, a156
  v_accvgpr_read_b32 v41, a157
  v_accvgpr_read_b32 v42, a158
  v_accvgpr_read_b32 v43, a159
  v_accvgpr_read_b32 v44, a160
  v_accvgpr_read_b32 v45, a161
  v_accvgpr_read_b32 v46, a162
  v_accvgpr_read_b32 v47, a163
  v_lshlrev_b32 v52, 16, v48
  v_and_b32 v53, 0xffff0000, v48
  v_lshlrev_b32 v54, 16, v49
  v_and_b32 v55, 0xffff0000, v49
  v_lshlrev_b32 v56, 16, v50
  v_and_b32 v57, 0xffff0000, v50
  v_lshlrev_b32 v58, 16, v51
  v_and_b32 v59, 0xffff0000, v51
  v_mul_f32 v68, 0xbfb8aa3b, v52
  v_mul_f32 v69, 0xbfb8aa3b, v53
  v_mul_f32 v70, 0xbfb8aa3b, v54
  v_mul_f32 v71, 0xbfb8aa3b, v55
  v_mul_f32 v72, 0xbfb8aa3b, v56
  v_mul_f32 v73, 0xbfb8aa3b, v57
  v_mul_f32 v74, 0xbfb8aa3b, v58
  v_mul_f32 v75, 0xbfb8aa3b, v59
  v_exp_f32 v68, v68
  v_exp_f32 v69, v69
  v_exp_f32 v70, v70
  v_exp_f32 v71, v71
  v_exp_f32 v72, v72
  v_exp_f32 v73, v73
  v_exp_f32 v74, v74
  v_exp_f32 v75, v75
  v_add_f32 v68, 1.0, v68
  v_add_f32 v69, 1.0, v69
  v_add_f32 v70, 1.0, v70
  v_add_f32 v71, 1.0, v71
  v_add_f32 v72, 1.0, v72
  v_add_f32 v73, 1.0, v73
  v_add_f32 v74, 1.0, v74
  v_add_f32 v75, 1.0, v75
  v_rcp_f32 v68, v68
  v_rcp_f32 v69, v69
  v_rcp_f32 v70, v70
  v_rcp_f32 v71, v71
  v_rcp_f32 v72, v72
  v_rcp_f32 v73, v73
  v_rcp_f32 v74, v74
  v_rcp_f32 v75, v75
  v_mul_f32 v52, v52, v68
  v_mul_f32 v53, v53, v69
  v_mul_f32 v54, v54, v70
  v_mul_f32 v55, v55, v71
  v_mul_f32 v56, v56, v72
  v_mul_f32 v57, v57, v73
  v_mul_f32 v58, v58, v74
  v_mul_f32 v59, v59, v75
  v_cvt_pk_bf16_f32 v68, v52, v53
  v_cvt_pk_bf16_f32 v69, v54, v55
  v_cvt_pk_bf16_f32 v70, v56, v57
  v_cvt_pk_bf16_f32 v71, v58, v59
  v_lshlrev_b32 v52, 16, v68
  v_and_b32 v53, 0xffff0000, v68
  v_lshlrev_b32 v54, 16, v69
  v_and_b32 v55, 0xffff0000, v69
  v_lshlrev_b32 v56, 16, v70
  v_and_b32 v57, 0xffff0000, v70
  v_lshlrev_b32 v58, 16, v71
  v_and_b32 v59, 0xffff0000, v71
  v_mov_b32 v60, 0
  v_mov_b32 v61, 0
  v_mov_b32 v62, 0
  v_mov_b32 v63, 0
  v_mov_b32 v64, 0
  v_mov_b32 v65, 0
  v_mov_b32 v66, 0
  v_mov_b32 v67, 0
  v_lshlrev_b32 v68, 16, v16
  v_and_b32 v69, 0xffff0000, v16
  v_lshlrev_b32 v70, 16, v17
  v_and_b32 v71, 0xffff0000, v17
  v_lshlrev_b32 v72, 16, v18
  v_and_b32 v73, 0xffff0000, v18
  v_lshlrev_b32 v74, 16, v19
  v_and_b32 v75, 0xffff0000, v19
  v_pk_fma_f32 v[60:61], v[68:69], v[52:53], v[60:61] op_sel:[0,0,0] op_sel_hi:[1,0,1]
  v_pk_fma_f32 v[62:63], v[70:71], v[52:53], v[62:63] op_sel:[0,0,0] op_sel_hi:[1,0,1]
  v_pk_fma_f32 v[64:65], v[72:73], v[52:53], v[64:65] op_sel:[0,0,0] op_sel_hi:[1,0,1]
  v_pk_fma_f32 v[66:67], v[74:75], v[52:53], v[66:67] op_sel:[0,0,0] op_sel_hi:[1,0,1]
  v_lshlrev_b32 v68, 16, v20
  v_and_b32 v69, 0xffff0000, v20
  v_lshlrev_b32 v70, 16, v21
  v_and_b32 v71, 0xffff0000, v21
  v_lshlrev_b32 v72, 16, v22
  v_and_b32 v73, 0xffff0000, v22
  v_lshlrev_b32 v74, 16, v23
  v_and_b32 v75, 0xffff0000, v23
  v_pk_fma_f32 v[60:61], v[68:69], v[52:53], v[60:61] op_sel:[0,1,0] op_sel_hi:[1,1,1]
  v_pk_fma_f32 v[62:63], v[70:71], v[52:53], v[62:63] op_sel:[0,1,0] op_sel_hi:[1,1,1]
  v_pk_fma_f32 v[64:65], v[72:73], v[52:53], v[64:65] op_sel:[0,1,0] op_sel_hi:[1,1,1]
  v_pk_fma_f32 v[66:67], v[74:75], v[52:53], v[66:67] op_sel:[0,1,0] op_sel_hi:[1,1,1]
  v_lshlrev_b32 v68, 16, v24
  v_and_b32 v69, 0xffff0000, v24
  v_lshlrev_b32 v70, 16, v25
  v_and_b32 v71, 0xffff0000, v25
  v_lshlrev_b32 v72, 16, v26
  v_and_b32 v73, 0xffff0000, v26
  v_lshlrev_b32 v74, 16, v27
  v_and_b32 v75, 0xffff0000, v27
  v_pk_fma_f32 v[60:61], v[68:69], v[54:55], v[60:61] op_sel:[0,0,0] op_sel_hi:[1,0,1]
  v_pk_fma_f32 v[62:63], v[70:71], v[54:55], v[62:63] op_sel:[0,0,0] op_sel_hi:[1,0,1]
  v_pk_fma_f32 v[64:65], v[72:73], v[54:55], v[64:65] op_sel:[0,0,0] op_sel_hi:[1,0,1]
  v_pk_fma_f32 v[66:67], v[74:75], v[54:55], v[66:67] op_sel:[0,0,0] op_sel_hi:[1,0,1]
  v_lshlrev_b32 v68, 16, v28
  v_and_b32 v69, 0xffff0000, v28
  v_lshlrev_b32 v70, 16, v29
  v_and_b32 v71, 0xffff0000, v29
  v_lshlrev_b32 v72, 16, v30
  v_and_b32 v73, 0xffff0000, v30
  v_lshlrev_b32 v74, 16, v31
  v_and_b32 v75, 0xffff0000, v31
  v_pk_fma_f32 v[60:61], v[68:69], v[54:55], v[60:61] op_sel:[0,1,0] op_sel_hi:[1,1,1]
  v_pk_fma_f32 v[62:63], v[70:71], v[54:55], v[62:63] op_sel:[0,1,0] op_sel_hi:[1,1,1]
  v_pk_fma_f32 v[64:65], v[72:73], v[54:55], v[64:65] op_sel:[0,1,0] op_sel_hi:[1,1,1]
  v_pk_fma_f32 v[66:67], v[74:75], v[54:55], v[66:67] op_sel:[0,1,0] op_sel_hi:[1,1,1]
  v_lshlrev_b32 v68, 16, v32
  v_and_b32 v69, 0xffff0000, v32
  v_lshlrev_b32 v70, 16, v33
  v_and_b32 v71, 0xffff0000, v33
  v_lshlrev_b32 v72, 16, v34
  v_and_b32 v73, 0xffff0000, v34
  v_lshlrev_b32 v74, 16, v35
  v_and_b32 v75, 0xffff0000, v35
  v_pk_fma_f32 v[60:61], v[68:69], v[56:57], v[60:61] op_sel:[0,0,0] op_sel_hi:[1,0,1]
  v_pk_fma_f32 v[62:63], v[70:71], v[56:57], v[62:63] op_sel:[0,0,0] op_sel_hi:[1,0,1]
  v_pk_fma_f32 v[64:65], v[72:73], v[56:57], v[64:65] op_sel:[0,0,0] op_sel_hi:[1,0,1]
  v_pk_fma_f32 v[66:67], v[74:75], v[56:57], v[66:67] op_sel:[0,0,0] op_sel_hi:[1,0,1]
  v_lshlrev_b32 v68, 16, v36
  v_and_b32 v69, 0xffff0000, v36
  v_lshlrev_b32 v70, 16, v37
  v_and_b32 v71, 0xffff0000, v37
  v_lshlrev_b32 v72, 16, v38
  v_and_b32 v73, 0xffff0000, v38
  v_lshlrev_b32 v74, 16, v39
  v_and_b32 v75, 0xffff0000, v39
  v_pk_fma_f32 v[60:61], v[68:69], v[56:57], v[60:61] op_sel:[0,1,0] op_sel_hi:[1,1,1]
  v_pk_fma_f32 v[62:63], v[70:71], v[56:57], v[62:63] op_sel:[0,1,0] op_sel_hi:[1,1,1]
  v_pk_fma_f32 v[64:65], v[72:73], v[56:57], v[64:65] op_sel:[0,1,0] op_sel_hi:[1,1,1]
  v_pk_fma_f32 v[66:67], v[74:75], v[56:57], v[66:67] op_sel:[0,1,0] op_sel_hi:[1,1,1]
  v_lshlrev_b32 v68, 16, v40
  v_and_b32 v69, 0xffff0000, v40
  v_lshlrev_b32 v70, 16, v41
  v_and_b32 v71, 0xffff0000, v41
  v_lshlrev_b32 v72, 16, v42
  v_and_b32 v73, 0xffff0000, v42
  v_lshlrev_b32 v74, 16, v43
  v_and_b32 v75, 0xffff0000, v43
  v_pk_fma_f32 v[60:61], v[68:69], v[58:59], v[60:61] op_sel:[0,0,0] op_sel_hi:[1,0,1]
  v_pk_fma_f32 v[62:63], v[70:71], v[58:59], v[62:63] op_sel:[0,0,0] op_sel_hi:[1,0,1]
  v_pk_fma_f32 v[64:65], v[72:73], v[58:59], v[64:65] op_sel:[0,0,0] op_sel_hi:[1,0,1]
  v_pk_fma_f32 v[66:67], v[74:75], v[58:59], v[66:67] op_sel:[0,0,0] op_sel_hi:[1,0,1]
  v_lshlrev_b32 v68, 16, v44
  v_and_b32 v69, 0xffff0000, v44
  v_lshlrev_b32 v70, 16, v45
  v_and_b32 v71, 0xffff0000, v45
  v_lshlrev_b32 v72, 16, v46
  v_and_b32 v73, 0xffff0000, v46
  v_lshlrev_b32 v74, 16, v47
  v_and_b32 v75, 0xffff0000, v47
  v_pk_fma_f32 v[60:61], v[68:69], v[58:59], v[60:61] op_sel:[0,1,0] op_sel_hi:[1,1,1]
  v_pk_fma_f32 v[62:63], v[70:71], v[58:59], v[62:63] op_sel:[0,1,0] op_sel_hi:[1,1,1]
  v_pk_fma_f32 v[64:65], v[72:73], v[58:59], v[64:65] op_sel:[0,1,0] op_sel_hi:[1,1,1]
  v_pk_fma_f32 v[66:67], v[74:75], v[58:59], v[66:67] op_sel:[0,1,0] op_sel_hi:[1,1,1]
  s_nop 1
  v_add_f32_dpp v60, v60, v60 row_ror:4 row_mask:0xf bank_mask:0xf
  v_add_f32_dpp v61, v61, v61 row_ror:4 row_mask:0xf bank_mask:0xf
  v_add_f32_dpp v62, v62, v62 row_ror:4 row_mask:0xf bank_mask:0xf
  v_add_f32_dpp v63, v63, v63 row_ror:4 row_mask:0xf bank_mask:0xf
  v_add_f32_dpp v64, v64, v64 row_ror:4 row_mask:0xf bank_mask:0xf
  v_add_f32_dpp v65, v65, v65 row_ror:4 row_mask:0xf bank_mask:0xf
  v_add_f32_dpp v66, v66, v66 row_ror:4 row_mask:0xf bank_mask:0xf
  v_add_f32_dpp v67, v67, v67 row_ror:4 row_mask:0xf bank_mask:0xf
  v_add_f32_dpp v60, v60, v60 row_ror:8 row_mask:0xf bank_mask:0xf
  v_add_f32_dpp v61, v61, v61 row_ror:8 row_mask:0xf bank_mask:0xf
  v_add_f32_dpp v62, v62, v62 row_ror:8 row_mask:0xf bank_mask:0xf
  v_add_f32_dpp v63, v63, v63 row_ror:8 row_mask:0xf bank_mask:0xf
  v_add_f32_dpp v64, v64, v64 row_ror:8 row_mask:0xf bank_mask:0xf
  v_add_f32_dpp v65, v65, v65 row_ror:8 row_mask:0xf bank_mask:0xf
  v_add_f32_dpp v66, v66, v66 row_ror:8 row_mask:0xf bank_mask:0xf
  v_add_f32_dpp v67, v67, v67 row_ror:8 row_mask:0xf bank_mask:0xf
  v_lshrrev_b32 v10, 4, v0
  v_lshlrev_b32 v10, 7, v10
  v_lshl_add_u32 v10, v9, 5, v10
  v_add_u32 v10, 65536, v10
  ds_write_b128 v10, v[60:63]
  ds_write_b128 v10, v[64:67] offset:16
  s_waitcnt lgkmcnt(0)
  s_barrier
  s_cmp_lg_u32 s32, 0
  s_cbranch_scc1 L_modnw0_33
  v_and_b32 v9, 31, v1
  v_lshlrev_b32 v10, 2, v9
  v_add_u32 v11, 65536, v10
  ds_read_b32 v16, v11 offset:0
  ds_read_b32 v17, v11 offset:128
  ds_read_b32 v18, v11 offset:256
  ds_read_b32 v19, v11 offset:384
  ds_read_b32 v20, v11 offset:512
  ds_read_b32 v21, v11 offset:640
  ds_read_b32 v22, v11 offset:768
  ds_read_b32 v23, v11 offset:896
  ds_read_b32 v24, v11 offset:1024
  ds_read_b32 v25, v11 offset:1152
  ds_read_b32 v26, v11 offset:1280
  ds_read_b32 v27, v11 offset:1408
  ds_read_b32 v28, v11 offset:1536
  ds_read_b32 v29, v11 offset:1664
  ds_read_b32 v30, v11 offset:1792
  ds_read_b32 v31, v11 offset:1920
  s_waitcnt lgkmcnt(0)
  v_add_f32 v16, v16, v24
  v_add_f32 v17, v17, v25
  v_add_f32 v18, v18, v26
  v_add_f32 v19, v19, v27
  v_add_f32 v20, v20, v28
  v_add_f32 v21, v21, v29
  v_add_f32 v22, v22, v30
  v_add_f32 v23, v23, v31
  v_add_f32 v16, v16, v20
  v_add_f32 v17, v17, v21
  v_add_f32 v18, v18, v22
  v_add_f32 v19, v19, v23
  v_add_f32 v16, v16, v18
  v_add_f32 v17, v17, v19
  v_add_f32 v16, v16, v17
  v_cvt_pk_bf16_f32 v16, v16, v16
  v_lshlrev_b32 v16, 16, v16
  s_lshl_b32 s40, s76, 2
  s_add_u32 s40, s40, 32768
  v_add_u32 v10, s40, v10
  global_store_dword v10, v16, s[30:31] sc1
  s_lshr_b32 s40, s76, 9
  s_sub_u32 s41, s40, 3
  s_cmp_gt_u32 s41, 1
  s_cbranch_scc1 L_modb_35
  s_xor_b32 s41, s41, 1
  s_cmp_eq_u32 s41, 0
  s_cselect_b32 s42, 1.0, 0
  v_add_f32 v11, s42, v16
  v_cvt_pk_bf16_f32 v11, v11, v11
  s_and_b32 s42, s76, 511
  v_add_u32 v12, s42, v9
  v_lshrrev_b32 v13, 4, v12
  v_lshlrev_b32 v13, 5, v13
  v_bfe_u32 v14, v12, 2, 1
  v_lshl_add_u32 v13, v14, 4, v13
  v_and_b32 v14, 3, v12
  v_lshl_add_u32 v13, v14, 1, v13
  v_bfe_u32 v14, v12, 3, 1
  v_lshl_add_u32 v13, v14, 3, v13
  s_lshl_b32 s41, s41, 10
  s_add_u32 s41, s41, 50176
  v_add_u32 v13, s41, v13
  global_store_short v13, v11, s[30:31] sc1
L_modb_35:
L_modnw0_33:
L_nomod_32:
  s_barrier
  v_and_b32 v8, 15, v0
  v_cmp_eq_u32 vcc, 0, v8
  v_mov_b32 v9, 0x3f803f80
  v_lshlrev_b32 v3, 4, v0
  v_cndmask_b32 v4, 0, v9, vcc
  v_add_u32 v3, 131072, v3
  v_mov_b32 v5, v4
  v_mov_b32 v6, v4
  v_mov_b32 v7, v4
  ds_write_b128 v3, v[4:7]
  v_cmp_gt_u32 vcc, 128, v0
  s_and_saveexec_b64 s[40:41], vcc
  ds_write_b128 v3, v[4:7] offset:4096
  s_mov_b64 exec, -1
  s_lshl_b32 s39, s2, 2
  s_add_u32 s39, s39, s32
  v_lshrrev_b32 v8, 2, v1
  v_and_b32 v9, 3, v1
  v_lshlrev_b32 v165, 10, v8
  v_lshl_add_u32 v165, v9, 4, v165
  v_mul_u32_u24 v164, 3584, v8
  v_lshl_add_u32 v164, v9, 4, v164
  s_cmp_ge_u32 s39, 896
  s_cbranch_scc1 L_two_36
  s_mul_i32 s40, s39, 2341
  s_lshr_b32 s40, s40, 16
  s_mul_i32 s41, s40, 28
  s_sub_u32 s41, s39, s41
  s_mul_i32 s42, s40, 57344
  s_lshl_b32 s43, s41, 7
  s_add_u32 s42, s42, s43
  s_add_u32 s52, s16, s42
  s_addc_u32 s53, s17, 0
  s_add_u32 s54, s18, s42
  s_addc_u32 s55, s19, 0
  s_add_u32 s56, s52, 64
  s_addc_u32 s57, s53, 0
  s_add_u32 s58, s54, 64
  s_addc_u32 s59, s55, 0
  s_lshl_b32 s41, s41, 7
  s_add_u32 s41, s41, s40
  s_lshl_b32 s41, s41, 10
  s_add_u32 s44, s41, 7340032
  s_add_u32 s45, s44, 32768
  s_add_u32 s46, s44, 65536
  s_add_u32 s47, s44, 98304
  s_lshr_b32 s40, s39, 3
  s_and_b32 s41, s39, 7
  s_lshl_b32 s42, s40, 14
  s_lshl_b32 s43, s41, 7
  s_add_u32 s42, s42, s43
  s_add_u32 s60, s20, s42
  s_addc_u32 s61, s21, 0
  s_add_u32 s62, s60, 64
  s_addc_u32 s63, s61, 0
  s_mul_i32 s41, s41, 224
  s_add_u32 s41, s41, s40
  s_lshl_b32 s41, s41, 10
  s_add_u32 s48, s41, 5242880
  s_add_u32 s49, s48, 114688
  s_mov_b32 s51, 0
  s_branch L_tpd_37
L_two_36:
  s_sub_u32 s40, s39, 896
  s_lshr_b32 s41, s40, 2
  s_and_b32 s40, s40, 3
  s_lshl_b32 s42, s41, 14
  s_lshl_b32 s43, s40, 8
  s_add_u32 s42, s42, s43
  s_add_u32 s52, s12, s42
  s_addc_u32 s53, s13, 0
  s_add_u32 s54, s52, 64
  s_addc_u32 s55, s53, 0
  s_add_u32 s56, s52, 128
  s_addc_u32 s57, s53, 0
  s_add_u32 s58, s52, 192
  s_addc_u32 s59, s53, 0
  s_mov_b32 s60, s52
  s_mov_b32 s61, s53
  s_mov_b32 s62, s52
  s_mov_b32 s63, s53
  v_mov_b32 v164, v165
  s_lshl_b32 s40, s40, 7
  s_add_u32 s40, s40, s41
  s_lshl_b32 s40, s40, 10
  s_add_u32 s44, s40, 524288
  s_add_u32 s45, s44, 32768
  s_add_u32 s46, s44, 65536
  s_add_u32 s47, s44, 98304
  s_mov_b32 s48, 258048
  s_mov_b32 s49, 259072
  s_mov_b32 s51, 1
L_tpd_37:
  s_mul_i32 s50, s32, 6528
  s_add_u32 s50, s50, 137216
  v_and_b32 v8, 15, v1
  v_lshrrev_b32 v200, 2, v8
  v_lshrrev_b32 v10, 5, v1
  v_lshl_add_u32 v200, v10, 2, v200
  v_lshlrev_b32 v200, 6, v200
  v_bfe_u32 v10, v1, 4, 1
  v_lshl_add_u32 v200, v10, 5, v200
  v_and_b32 v10, 3, v8
  v_lshl_add_u32 v200, v10, 3, v200
  v_bfe_u32 v10, v1, 4, 1
  v_mul_u32_u24 v11, 1088, v10
  v_add_u32 v166, v200, v11
  v_add_u32 v200, s50, v200
  v_add_u32 v166, s50, v166
  s_cmp_eq_u32 s51, 0
  s_cbranch_scc1 L_tgu_ok
  v_mov_b32 v166, v200
L_tgu_ok:
  s_waitcnt lgkmcnt(0)
  s_cmp_lg_u32 s32, 0
  s_cbranch_scc1 L_wt_38
  s_lshl_b32 s40, s33, 10
  s_add_u32 s40, s40, 24576
  v_lshlrev_b32 v8, 7, v1
  v_add_u32 v8, s40, v8
  s_mov_b64 exec, 255
  s_mov_b32 s92, 0
L_poll_39:
  global_load_dword v9, v8, s[30:31] sc1
L_pchk_42:
  s_add_u32 s92, s92, 1
  s_cmp_gt_u32 s92, 200000
  s_cbranch_scc1 L_ptm_41
  s_waitcnt vmcnt(0)
  v_cmp_gt_u32 vcc, 16, v9
  s_cbranch_vccnz L_poll_39
  s_branch L_pok_40
L_ptm_41:
  s_waitcnt vmcnt(0)
  v_mov_b32 v8, 32
  v_mov_b32 v9, 2
  s_mov_b64 exec, 1
  global_store_dword v8, v9, s[28:29]
L_pok_40:
  s_mov_b64 exec, -1
L_wt_38:
  s_barrier
  v_lshlrev_b32 v8, 2, v1
  v_add_u32 v8, 49152, v8
  global_load_dword v9, v8, s[30:31] sc1
  s_add_u32 s98, s30, 262144
  s_addc_u32 s99, s31, 0
  s_add_u32 s100, s30, 327680
  s_addc_u32 s101, s31, 0
  s_lshl_b32 s77, s32, 11
  s_add_u32 s77, s77, 0
  v_add_u32 v202, s77, v2
  s_mov_b32 m0, s77
  s_nop 0
  global_load_lds_dwordx4 v202, s[98:99] sc1
  global_load_lds_dwordx4 v202, s[98:99] offset:1024 sc1
  s_add_u32 m0, s77, 65536
  s_nop 0
  global_load_lds_dwordx4 v202, s[100:101] sc1
  global_load_lds_dwordx4 v202, s[100:101] offset:1024 sc1
  s_lshl_b32 s77, s32, 11
  s_add_u32 s77, s77, 8192
  v_add_u32 v202, s77, v2
  s_mov_b32 m0, s77
  s_nop 0
  global_load_lds_dwordx4 v202, s[98:99] sc1
  global_load_lds_dwordx4 v202, s[98:99] offset:1024 sc1
  s_add_u32 m0, s77, 65536
  s_nop 0
  global_load_lds_dwordx4 v202, s[100:101] sc1
  global_load_lds_dwordx4 v202, s[100:101] offset:1024 sc1
  s_lshl_b32 s77, s32, 10
  s_add_u32 s77, s77, 16384
  v_add_u32 v202, s77, v2
  v_mov_b32 v203, v202
  s_add_u32 s82, s77, 65536
  s_mov_b32 s89, 4096
  v_mov_b32 v64, 0
  v_mov_b32 v80, 0
  v_mov_b32 v65, 0
  v_mov_b32 v81, 0
  v_mov_b32 v66, 0
  v_mov_b32 v82, 0
  v_mov_b32 v67, 0
  v_mov_b32 v83, 0
  v_mov_b32 v68, 0
  v_mov_b32 v84, 0
  v_mov_b32 v69, 0
  v_mov_b32 v85, 0
  v_mov_b32 v70, 0
  v_mov_b32 v86, 0
  v_mov_b32 v71, 0
  v_mov_b32 v87, 0
  v_mov_b32 v72, 0
  v_mov_b32 v88, 0
  v_mov_b32 v73, 0
  v_mov_b32 v89, 0
  v_mov_b32 v74, 0
  v_mov_b32 v90, 0
  v_mov_b32 v75, 0
  v_mov_b32 v91, 0
  v_mov_b32 v76, 0
  v_mov_b32 v92, 0
  v_mov_b32 v77, 0
  v_mov_b32 v93, 0
  v_mov_b32 v78, 0
  v_mov_b32 v94, 0
  v_mov_b32 v79, 0
  v_mov_b32 v95, 0
  v_mov_b32 v56, 0
  v_mov_b32 v152, 0
  v_mov_b32 v57, 0
  v_mov_b32 v153, 0
  v_mov_b32 v58, 0
  v_mov_b32 v154, 0
  v_mov_b32 v59, 0
  v_mov_b32 v155, 0
  v_mov_b32 v60, 0
  v_mov_b32 v156, 0
  v_mov_b32 v61, 0
  v_mov_b32 v157, 0
  v_mov_b32 v62, 0
  v_mov_b32 v158, 0
  v_mov_b32 v63, 0
  v_mov_b32 v159, 0
  v_mov_b32 v10, 0
  v_dot2_f32_bf16 v10, v128, v128, v10
  v_dot2_f32_bf16 v10, v129, v129, v10
  v_dot2_f32_bf16 v10, v130, v130, v10
  v_dot2_f32_bf16 v10, v131, v131, v10
  v_mov_b32 v11, 0
  v_dot2_f32_bf16 v11, v132, v132, v11
  v_dot2_f32_bf16 v11, v133, v133, v11
  v_dot2_f32_bf16 v11, v134, v134, v11
  v_dot2_f32_bf16 v11, v135, v135, v11
  v_add_u32 v160, 0, v2
  v_and_b32 v12, 15, v1
  v_lshlrev_b32 v12, 4, v12
  v_lshrrev_b32 v13, 5, v1
  v_lshl_add_u32 v12, v13, 8, v12
  v_and_b32 v13, 16, v1
  v_cmp_ne_u32 vcc, 0, v13
  v_mov_b32 v14, 65536
  v_mov_b32 v15, 131072
  v_cndmask_b32 v14, v14, v15, vcc
  v_add_u32 v161, v12, v14
  v_mov_b32 v14, 1024
  v_mov_b32 v15, 0
  v_cndmask_b32 v162, v14, v15, vcc
  v_mov_b32 v12, v10
  v_mov_b32 v13, v11
  s_nop 1
  v_permlane32_swap_b32 v10, v12
  v_permlane32_swap_b32 v11, v13
  v_add_f32 v10, v10, v12
  v_add_f32 v11, v11, v13
  s_waitcnt vmcnt(8)
  v_max_f32_dpp v9, v9, v9 row_ror:8 row_mask:0xf bank_mask:0xf
  s_nop 1
  v_max_f32_dpp v9, v9, v9 row_ror:4 row_mask:0xf bank_mask:0xf
  s_nop 1
  v_max_f32_dpp v9, v9, v9 row_ror:2 row_mask:0xf bank_mask:0xf
  s_nop 1
  v_max_f32_dpp v9, v9, v9 row_ror:1 row_mask:0xf bank_mask:0xf
  s_nop 1
  v_mov_b32 v12, v9
  s_nop 1
  v_permlane16_swap_b32 v9, v12
  v_max_f32 v9, v9, v12
  v_mov_b32 v12, v9
  s_nop 1
  v_permlane32_swap_b32 v9, v12
  v_max_f32 v9, v9, v12
  v_mul_f32 v10, v10, v9
  v_mul_f32 v11, v11, v9
  v_sqrt_f32 v10, v10
  v_sqrt_f32 v11, v11
  s_nop 0
  v_mul_f32 v10, 0xbf808000, v10
  v_mul_f32 v11, 0xbf808000, v11
  v_mov_b32 v96, v10
  v_mov_b32 v112, v11
  v_mov_b32 v97, v10
  v_mov_b32 v113, v11
  v_mov_b32 v98, v10
  v_mov_b32 v114, v11
  v_mov_b32 v99, v10
  v_mov_b32 v115, v11
  v_mov_b32 v100, v10
  v_mov_b32 v116, v11
  v_mov_b32 v101, v10
  v_mov_b32 v117, v11
  v_mov_b32 v102, v10
  v_mov_b32 v118, v11
  v_mov_b32 v103, v10
  v_mov_b32 v119, v11
  v_mov_b32 v104, v10
  v_mov_b32 v120, v11
  v_mov_b32 v105, v10
  v_mov_b32 v121, v11
  v_mov_b32 v106, v10
  v_mov_b32 v122, v11
  v_mov_b32 v107, v10
  v_mov_b32 v123, v11
  v_mov_b32 v108, v10
  v_mov_b32 v124, v11
  v_mov_b32 v109, v10
  v_mov_b32 v125, v11
  v_mov_b32 v110, v10
  v_mov_b32 v126, v11
  v_mov_b32 v111, v10
  v_mov_b32 v127, v11
  v_min_f32 v10, v10, v11
  v_cmp_gt_f32 vcc, 0xc2400000, v10
  s_lshl_b32 s40, s32, 2
  s_add_u32 s40, s40, 163584
  v_mov_b32 v12, s40
  s_cmp_lg_u64 vcc, 0
  s_cselect_b32 s41, 1, 0
  v_mov_b32 v13, s41
  ds_write_b32 v12, v13
  s_waitcnt vmcnt(4) lgkmcnt(0)
  s_barrier
  v_mov_b32 v12, 163584
  ds_read_b128 v[12:15], v12
  ds_read_b128 v[136:139], v160
  ds_read_b128 v[144:147], v161
  ds_read_b128 v[148:151], v161 offset:512
  s_waitcnt lgkmcnt(3)
  v_or_b32 v12, v12, v13
  v_or_b32 v14, v14, v15
  v_or_b32 v12, v12, v14
  s_nop 0
  v_readfirstlane_b32 s40, v12
  s_cmp_lg_u32 s40, 0
  s_cbranch_scc1 L_slow_43
  s_waitcnt lgkmcnt(2)
  v_mfma_f32_32x32x16_bf16 v[16:31], v[136:139], v[128:131], v[96:111]
  v_lshlrev_b32 v162, 2, v162
  s_nop 7
  s_nop 1
  s_mov_b32 s94, 1
  s_call_b64 s[84:85], L_ATTN_D
  s_waitcnt vmcnt(8)
  s_barrier
  s_mov_b32 s94, 2
  s_call_b64 s[84:85], L_ATTN_D
  s_waitcnt vmcnt(16)
  s_barrier
  s_add_u32 m0, s50, 0
  s_nop 0
  global_load_lds_dwordx4 v164, s[52:53]
  s_lshl_b32 s40, s51, 5
  s_sub_u32 s40, 1120, s40
  s_add_u32 m0, s50, s40
  s_nop 0
  global_load_lds_dwordx4 v164, s[54:55]
  s_add_u32 m0, s50, 2176
  s_nop 0
  global_load_lds_dwordx4 v164, s[56:57]
  s_lshl_b32 s40, s51, 5
  s_sub_u32 s40, 3296, s40
  s_add_u32 m0, s50, s40
  s_nop 0
  global_load_lds_dwordx4 v164, s[58:59]
  s_add_u32 m0, s50, 4352
  s_nop 0
  global_load_lds_dwordx4 v165, s[60:61]
  s_add_u32 m0, s50, 5440
  s_nop 0
  global_load_lds_dwordx4 v165, s[62:63]
  s_mov_b32 s94, 2
  s_call_b64 s[84:85], L_ATTN_P
  s_waitcnt vmcnt(0)
  s_cmp_eq_u32 s51, 0
  s_cselect_b32 s40, 0, 0
  v_add_u32 v167, s40, v166
  ds_read_b64_tr_b16 v[176:177], v167
  ds_read_b64_tr_b16 v[178:179], v167 offset:512
  s_cmp_eq_u32 s51, 0
  s_cselect_b32 s40, 32, 1088
  v_add_u32 v167, s40, v166
  ds_read_b64_tr_b16 v[180:181], v167
  ds_read_b64_tr_b16 v[182:183], v167 offset:512
  s_cmp_eq_u32 s51, 0
  s_cselect_b32 s40, 2176, 2176
  v_add_u32 v167, s40, v166
  ds_read_b64_tr_b16 v[184:185], v167
  ds_read_b64_tr_b16 v[186:187], v167 offset:512
  s_cmp_eq_u32 s51, 0
  s_mov_b32 s41, 3264
  s_cselect_b32 s40, 2208, s41
  v_add_u32 v167, s40, v166
  ds_read_b64_tr_b16 v[188:189], v167
  ds_read_b64_tr_b16 v[190:191], v167 offset:512
  ds_read_b64_tr_b16 v[192:193], v200 offset:4352
  ds_read_b64_tr_b16 v[194:195], v200 offset:4864
  ds_read_b64_tr_b16 v[196:197], v200 offset:5440
  ds_read_b64_tr_b16 v[198:199], v200 offset:5952
  s_waitcnt lgkmcnt(0)
  v_add_u32 v201, s44, v2
  global_store_dwordx4 v201, v[176:179], s[30:31] sc1
  v_add_u32 v201, s45, v2
  global_store_dwordx4 v201, v[180:183], s[30:31] sc1
  v_add_u32 v201, s46, v2
  global_store_dwordx4 v201, v[184:187], s[30:31] sc1
  v_add_u32 v201, s47, v2
  global_store_dwordx4 v201, v[188:191], s[30:31] sc1
  v_add_u32 v201, s48, v2
  global_store_dwordx4 v201, v[192:195], s[30:31] sc1
  v_add_u32 v201, s49, v2
  global_store_dwordx4 v201, v[196:199], s[30:31] sc1
  s_mov_b32 s94, 1
  s_call_b64 s[84:85], L_ATTN_P
  s_waitcnt vmcnt(0)
  s_barrier
  s_cmp_lg_u32 s32, 0
  s_cbranch_scc1 L_nst_45
  s_lshl_b32 s40, s33, 7
  s_add_u32 s40, s40, 4096
  v_mov_b32 v8, s40
  v_mov_b32 v9, 1
  s_mov_b64 exec, 1
  global_atomic_add v8, v9, s[30:31] sc1
  s_mov_b64 exec, -1
  s_sub_u32 s40, s36, 5
  s_cmp_gt_u32 s40, 1
  s_cbranch_scc1 L_s0b_46
  s_mov_b32 s40, 128
  v_mov_b32 v8, s40
  v_mov_b32 v9, 1
  s_mov_b64 exec, 1
  global_atomic_add v8, v9, s[28:29] sc1
  s_mov_b64 exec, -1
L_s0b_46:
L_nst_45:
  s_mov_b32 s94, 2
  s_call_b64 s[84:85], L_ATTN_P
  v_lshlrev_b32 v236, 7, v1
  v_add_u32 v236, 4096, v236
  s_mov_b64 exec, 255
  global_load_dword v237, v236, s[30:31] sc1
  s_mov_b64 exec, -1
  v_lshlrev_b32 v238, 7, v1
  v_add_u32 v238, 128, v238
  s_mov_b64 exec, 1
  global_load_dword v239, v238, s[28:29] sc1
  s_mov_b64 exec, -1
  s_mov_b32 s94, 1
  s_call_b64 s[84:85], L_ATTN_P
  s_mov_b64 exec, 255
  s_mov_b32 s92, 0
  s_branch L_pchk_50
L_poll_47:
  global_load_dword v237, v236, s[30:31] sc1
L_pchk_50:
  s_add_u32 s92, s92, 1
  s_cmp_gt_u32 s92, 200000
  s_cbranch_scc1 L_ptm_49
  s_waitcnt vmcnt(0)
  v_cmp_gt_u32 vcc, 32, v237
  s_cbranch_vccnz L_poll_47
  s_branch L_pok_48
L_ptm_49:
  s_waitcnt vmcnt(0)
  v_mov_b32 v236, 32
  v_mov_b32 v237, 3
  s_mov_b64 exec, 1
  global_store_dword v236, v237, s[28:29]
L_pok_48:
  s_mov_b64 exec, -1
  s_mov_b64 exec, 1
  s_mov_b32 s92, 0
  s_branch L_pchk_54
L_poll_51:
  global_load_dword v239, v238, s[28:29] sc1
L_pchk_54:
  s_add_u32 s92, s92, 1
  s_cmp_gt_u32 s92, 200000
  s_cbranch_scc1 L_ptm_53
  s_waitcnt vmcnt(0)
  v_cmp_gt_u32 vcc, 64, v239
  s_cbranch_vccnz L_poll_51
  s_branch L_pok_52
L_ptm_53:
  s_waitcnt vmcnt(0)
  v_mov_b32 v238, 32
  v_mov_b32 v239, 4
  s_mov_b64 exec, 1
  global_store_dword v238, v239, s[28:29]
L_pok_52:
  s_mov_b64 exec, -1
  s_mul_i32 s40, s38, 7
  s_lshl_b32 s40, s40, 15
  s_add_u32 s40, s40, 7340032
  s_add_u32 s98, s30, s40
  s_addc_u32 s99, s31, 0
  s_add_u32 s100, s98, 32768
  s_addc_u32 s101, s99, 0
  s_lshl_b32 s40, s32, 13
  v_add_u32 v202, s40, v2
  v_mov_b32 v203, v202
  s_add_u32 s77, s40, 0
  s_add_u32 s82, s40, 65536
  s_mov_b32 s89, 1024
  v_exp_f32 v16, v16
  v_exp_f32 v17, v17
  v_exp_f32 v18, v18
  v_cvt_pk_bf16_f32 v48, v16, v17
  v_mfma_f32_32x32x16_bf16 v[80:95], v[156:159], v[60:63], v[80:95]
  ds_read_b128 v[140:143], v160 offset:1024
  v_exp_f32 v19, v19
  v_exp_f32 v20, v20
  s_lshl_b32 s39, s2, 2
  s_add_u32 s39, s39, s32
  s_cmp_ge_u32 s39, 896
  s_cbranch_scc1 L_uvi_55
  s_lshl_b32 s40, s39, 12
  s_add_u32 s40, s40, 7340032
  v_add_u32 v8, s40, v2
  global_load_dwordx4 v[164:167], v8, s[30:31] offset:0 sc1
  global_load_dwordx4 v[168:171], v8, s[30:31] offset:1024 sc1
  global_load_dwordx4 v[172:175], v8, s[30:31] offset:2048 sc1
  global_load_dwordx4 v[176:179], v8, s[30:31] offset:3072 sc1
  v_mov_b32 v180, 0
  v_mov_b32 v181, 0
  v_mov_b32 v182, 0
  v_mov_b32 v183, 0
  v_mov_b32 v184, 0
  v_mov_b32 v185, 0
  v_mov_b32 v186, 0
  v_mov_b32 v187, 0
  v_mov_b32 v188, 0
  v_mov_b32 v189, 0
  v_mov_b32 v190, 0
  v_mov_b32 v191, 0
  v_mov_b32 v192, 0
  v_mov_b32 v193, 0
  v_mov_b32 v194, 0
  v_mov_b32 v195, 0
  s_and_b32 s40, s39, 7
  s_lshl_b32 s40, s40, 7
  s_add_u32 s40, s40, 50176
  v_lshrrev_b32 v9, 5, v1
  v_lshlrev_b32 v9, 4, v9
  v_and_b32 v10, 1, v1
  v_lshl_add_u32 v9, v10, 10, v9
  v_add_u32 v9, s40, v9
  s_mov_b32 s42, 3
  s_mov_b32 s43, 3
  s_mov_b64 exec, s[42:43]
  global_load_dwordx4 v[180:183], v9, s[30:31] offset:0 sc1
  global_load_dwordx4 v[184:187], v9, s[30:31] offset:32 sc1
  global_load_dwordx4 v[188:191], v9, s[30:31] offset:64 sc1
  global_load_dwordx4 v[192:195], v9, s[30:31] offset:96 sc1
  s_mov_b64 exec, -1
L_uvi_55:
  v_cvt_pk_bf16_f32 v49, v18, v19
  v_exp_f32 v21, v21
  v_exp_f32 v22, v22
  v_cvt_pk_bf16_f32 v50, v20, v21
  v_mfma_f32_32x32x16_bf16 v[32:47], v[136:139], v[132:135], v[112:127]
  v_exp_f32 v23, v23
  v_exp_f32 v24, v24
  v_cvt_pk_bf16_f32 v51, v22, v23
  v_exp_f32 v25, v25
  v_exp_f32 v26, v26
  v_exp_f32 v27, v27
  s_waitcnt lgkmcnt(1)
  v_mfma_f32_32x32x16_bf16 v[64:79], v[144:147], v[48:51], v[64:79]
  v_cvt_pk_bf16_f32 v52, v24, v25
  v_exp_f32 v28, v28
  v_exp_f32 v29, v29
  v_cvt_pk_bf16_f32 v53, v26, v27
  v_exp_f32 v30, v30
  v_exp_f32 v31, v31
  v_cvt_pk_bf16_f32 v54, v28, v29
  v_cvt_pk_bf16_f32 v55, v30, v31
  v_exp_f32 v32, v32
  v_exp_f32 v33, v33
  v_exp_f32 v34, v34
  v_cvt_pk_bf16_f32 v56, v32, v33
  v_mfma_f32_32x32x16_bf16 v[64:79], v[148:151], v[52:55], v[64:79]
  v_exp_f32 v35, v35
  v_exp_f32 v36, v36
  v_cvt_pk_bf16_f32 v57, v34, v35
  v_exp_f32 v37, v37
  v_exp_f32 v38, v38
  v_cvt_pk_bf16_f32 v58, v36, v37
  s_waitcnt lgkmcnt(0)
  v_mfma_f32_32x32x16_bf16 v[16:31], v[140:143], v[128:131], v[96:111]
  ds_read_b128 v[152:155], v161 offset:1024
  ds_read_b128 v[156:159], v161 offset:1536
  v_exp_f32 v39, v39
  v_exp_f32 v40, v40
  v_cvt_pk_bf16_f32 v59, v38, v39
  v_exp_f32 v41, v41
  v_exp_f32 v42, v42
  v_exp_f32 v43, v43
  v_mfma_f32_32x32x16_bf16 v[80:95], v[144:147], v[56:59], v[80:95]
  v_cvt_pk_bf16_f32 v60, v40, v41
  v_exp_f32 v44, v44
  v_exp_f32 v45, v45
  v_cvt_pk_bf16_f32 v61, v42, v43
  v_exp_f32 v46, v46
  v_exp_f32 v47, v47
  v_cvt_pk_bf16_f32 v62, v44, v45
  v_cvt_pk_bf16_f32 v63, v46, v47
  v_exp_f32 v16, v16
  v_exp_f32 v17, v17
  v_exp_f32 v18, v18
  v_cvt_pk_bf16_f32 v48, v16, v17
  v_mfma_f32_32x32x16_bf16 v[80:95], v[148:151], v[60:63], v[80:95]
  ds_read_b128 v[136:139], v160 offset:2048
  v_exp_f32 v19, v19
  v_exp_f32 v20, v20
  v_cvt_pk_bf16_f32 v49, v18, v19
  v_exp_f32 v21, v21
  v_exp_f32 v22, v22
  v_cvt_pk_bf16_f32 v50, v20, v21
  v_mfma_f32_32x32x16_bf16 v[32:47], v[140:143], v[132:135], v[112:127]
  v_exp_f32 v23, v23
  v_exp_f32 v24, v24
  v_cvt_pk_bf16_f32 v51, v22, v23
  v_exp_f32 v25, v25
  v_exp_f32 v26, v26
  v_exp_f32 v27, v27
  s_waitcnt lgkmcnt(1)
  v_mfma_f32_32x32x16_bf16 v[64:79], v[152:155], v[48:51], v[64:79]
  v_cvt_pk_bf16_f32 v52, v24, v25
  v_exp_f32 v28, v28
  v_exp_f32 v29, v29
  v_cvt_pk_bf16_f32 v53, v26, v27
  v_exp_f32 v30, v30
  v_exp_f32 v31, v31
  v_cvt_pk_bf16_f32 v54, v28, v29
  v_cvt_pk_bf16_f32 v55, v30, v31
  v_exp_f32 v32, v32
  v_exp_f32 v33, v33
  v_exp_f32 v34, v34
  v_cvt_pk_bf16_f32 v56, v32, v33
  v_mfma_f32_32x32x16_bf16 v[64:79], v[156:159], v[52:55], v[64:79]
  v_exp_f32 v35, v35
  v_exp_f32 v36, v36
  v_cvt_pk_bf16_f32 v57, v34, v35
  v_exp_f32 v37, v37
  v_exp_f32 v38, v38
  v_cvt_pk_bf16_f32 v58, v36, v37
  s_waitcnt lgkmcnt(0)
  v_mfma_f32_32x32x16_bf16 v[16:31], v[136:139], v[128:131], v[96:111]
  ds_read_b128 v[144:147], v161 offset:2048
  ds_read_b128 v[148:151], v161 offset:2560
  v_exp_f32 v39, v39
  v_exp_f32 v40, v40
  v_cvt_pk_bf16_f32 v59, v38, v39
  v_exp_f32 v41, v41
  v_exp_f32 v42, v42
  v_exp_f32 v43, v43
  v_mfma_f32_32x32x16_bf16 v[80:95], v[152:155], v[56:59], v[80:95]
  v_cvt_pk_bf16_f32 v60, v40, v41
  v_exp_f32 v44, v44
  v_exp_f32 v45, v45
  v_cvt_pk_bf16_f32 v61, v42, v43
  v_exp_f32 v46, v46
  v_exp_f32 v47, v47
  v_cvt_pk_bf16_f32 v62, v44, v45
  v_cvt_pk_bf16_f32 v63, v46, v47
  v_exp_f32 v16, v16
  v_exp_f32 v17, v17
  v_exp_f32 v18, v18
  v_cvt_pk_bf16_f32 v48, v16, v17
  v_mfma_f32_32x32x16_bf16 v[80:95], v[156:159], v[60:63], v[80:95]
  ds_read_b128 v[140:143], v160 offset:3072
  v_exp_f32 v19, v19
  v_exp_f32 v20, v20
  v_cvt_pk_bf16_f32 v49, v18, v19
  v_exp_f32 v21, v21
  v_exp_f32 v22, v22
  v_cvt_pk_bf16_f32 v50, v20, v21
  v_mfma_f32_32x32x16_bf16 v[32:47], v[136:139], v[132:135], v[112:127]
  v_exp_f32 v23, v23
  v_exp_f32 v24, v24
  v_cvt_pk_bf16_f32 v51, v22, v23
  v_exp_f32 v25, v25
  v_exp_f32 v26, v26
  v_exp_f32 v27, v27
  s_waitcnt lgkmcnt(1)
  v_mfma_f32_32x32x16_bf16 v[64:79], v[144:147], v[48:51], v[64:79]
  v_cvt_pk_bf16_f32 v52, v24, v25
  v_exp_f32 v28, v28
  v_exp_f32 v29, v29
  v_cvt_pk_bf16_f32 v53, v26, v27
  v_exp_f32 v30, v30
  v_exp_f32 v31, v31
  v_cvt_pk_bf16_f32 v54, v28, v29
  v_cvt_pk_bf16_f32 v55, v30, v31
  v_exp_f32 v32, v32
  v_exp_f32 v33, v33
  v_exp_f32 v34, v34
  v_cvt_pk_bf16_f32 v56, v32, v33
  v_mfma_f32_32x32x16_bf16 v[64:79], v[148:151], v[52:55], v[64:79]
  v_exp_f32 v35, v35
  v_exp_f32 v36, v36
  v_cvt_pk_bf16_f32 v57, v34, v35
  v_exp_f32 v37, v37
  v_exp_f32 v38, v38
  v_cvt_pk_bf16_f32 v58, v36, v37
  s_waitcnt lgkmcnt(0)
  v_mfma_f32_32x32x16_bf16 v[16:31], v[140:143], v[128:131], v[96:111]
  ds_read_b128 v[152:155], v161 offset:3072
  ds_read_b128 v[156:159], v161 offset:3584
  v_exp_f32 v39, v39
  v_exp_f32 v40, v40
  v_cvt_pk_bf16_f32 v59, v38, v39
  v_exp_f32 v41, v41
  v_exp_f32 v42, v42
  v_exp_f32 v43, v43
  v_mfma_f32_32x32x16_bf16 v[80:95], v[144:147], v[56:59], v[80:95]
  v_cvt_pk_bf16_f32 v60, v40, v41
  v_exp_f32 v44, v44
  v_exp_f32 v45, v45
  v_cvt_pk_bf16_f32 v61, v42, v43
  v_exp_f32 v46, v46
  v_exp_f32 v47, v47
  v_cvt_pk_bf16_f32 v62, v44, v45
  v_cvt_pk_bf16_f32 v63, v46, v47
  v_exp_f32 v16, v16
  v_exp_f32 v17, v17
  v_exp_f32 v18, v18
  v_cvt_pk_bf16_f32 v48, v16, v17
  v_mfma_f32_32x32x16_bf16 v[80:95], v[148:151], v[60:63], v[80:95]
  ds_read_b128 v[136:139], v160 offset:4096
  v_exp_f32 v19, v19
  v_exp_f32 v20, v20
  s_cmp_ge_u32 s39, 896
  s_cbranch_scc1 L_uvc_56
  s_waitcnt vmcnt(0)
  v_mfma_f32_32x32x16_bf16 v[212:227], v[164:167], v[180:183], 0
  v_mfma_f32_32x32x16_bf16 v[212:227], v[168:171], v[184:187], v[212:227]
  v_mfma_f32_32x32x16_bf16 v[212:227], v[172:175], v[188:191], v[212:227]
  v_mfma_f32_32x32x16_bf16 v[212:227], v[176:179], v[192:195], v[212:227]
  s_lshl_b32 s40, s39, 8
  s_add_u32 s40, s40, 18874368
  v_and_b32 v9, 1, v1
  v_lshlrev_b32 v9, 7, v9
  v_lshrrev_b32 v10, 5, v1
  v_lshl_add_u32 v9, v10, 6, v9
  v_add_u32 v9, s40, v9
  s_mov_b32 s42, 3
  s_mov_b32 s43, 3
  s_nop 7
  s_mov_b64 exec, s[42:43]
  global_store_dwordx4 v9, v[212:215], s[30:31] offset:0 sc1
  global_store_dwordx4 v9, v[216:219], s[30:31] offset:16 sc1
  global_store_dwordx4 v9, v[220:223], s[30:31] offset:32 sc1
  global_store_dwordx4 v9, v[224:227], s[30:31] offset:48 sc1
  s_mov_b64 exec, -1
L_uvc_56:
  v_cvt_pk_bf16_f32 v49, v18, v19
  v_exp_f32 v21, v21
  v_exp_f32 v22, v22
  v_cvt_pk_bf16_f32 v50, v20, v21
  v_mfma_f32_32x32x16_bf16 v[32:47], v[140:143], v[132:135], v[112:127]
  v_exp_f32 v23, v23
  v_exp_f32 v24, v24
  v_cvt_pk_bf16_f32 v51, v22, v23
  v_exp_f32 v25, v25
  v_exp_f32 v26, v26
  v_exp_f32 v27, v27
  s_waitcnt lgkmcnt(1)
  v_mfma_f32_32x32x16_bf16 v[64:79], v[152:155], v[48:51], v[64:79]
  v_cvt_pk_bf16_f32 v52, v24, v25
  v_exp_f32 v28, v28
  v_exp_f32 v29, v29
  v_cvt_pk_bf16_f32 v53, v26, v27
  v_exp_f32 v30, v30
  v_exp_f32 v31, v31
  v_cvt_pk_bf16_f32 v54, v28, v29
  v_cvt_pk_bf16_f32 v55, v30, v31
  v_exp_f32 v32, v32
  v_exp_f32 v33, v33
  v_exp_f32 v34, v34
  v_cvt_pk_bf16_f32 v56, v32, v33
  v_mfma_f32_32x32x16_bf16 v[64:79], v[156:159], v[52:55], v[64:79]
  v_exp_f32 v35, v35
  v_exp_f32 v36, v36
  s_lshl_b32 s40, s36, 6
  s_lshl_b32 s41, s32, 3
  s_add_u32 s40, s40, s41
  s_lshl_b32 s40, s40, 10
  s_add_u32 s40, s40, 524288
  s_add_u32 s78, s30, s40
  s_addc_u32 s79, s31, 0
  global_load_dwordx4 a[192:195], v2, s[78:79] offset:0 sc1
  v_cvt_pk_bf16_f32 v57, v34, v35
  v_exp_f32 v37, v37
  v_exp_f32 v38, v38
  v_cvt_pk_bf16_f32 v58, v36, v37
  s_waitcnt lgkmcnt(0)
  v_mfma_f32_32x32x16_bf16 v[16:31], v[136:139], v[128:131], v[96:111]
  v_add_u32 v161, v161, v162
  ds_read_b128 v[144:147], v161 offset:0
  ds_read_b128 v[148:151], v161 offset:512
  v_exp_f32 v39, v39
  v_exp_f32 v40, v40
  v_cvt_pk_bf16_f32 v59, v38, v39
  v_exp_f32 v41, v41
  v_exp_f32 v42, v42
  v_exp_f32 v43, v43
  v_mfma_f32_32x32x16_bf16 v[80:95], v[152:155], v[56:59], v[80:95]
  v_cvt_pk_bf16_f32 v60, v40, v41
  v_exp_f32 v44, v44
  v_exp_f32 v45, v45
  global_load_dwordx4 a[196:199], v2, s[78:79] offset:1024 sc1
  v_cvt_pk_bf16_f32 v61, v42, v43
  v_exp_f32 v46, v46
  v_exp_f32 v47, v47
  v_cvt_pk_bf16_f32 v62, v44, v45
  v_cvt_pk_bf16_f32 v63, v46, v47
  v_exp_f32 v16, v16
  v_exp_f32 v17, v17
  v_exp_f32 v18, v18
  v_cvt_pk_bf16_f32 v48, v16, v17
  v_mfma_f32_32x32x16_bf16 v[80:95], v[156:159], v[60:63], v[80:95]
  ds_read_b128 v[140:143], v160 offset:5120
  v_exp_f32 v19, v19
  v_exp_f32 v20, v20
  s_barrier
  v_cvt_pk_bf16_f32 v49, v18, v19
  v_exp_f32 v21, v21
  v_exp_f32 v22, v22
  v_cvt_pk_bf16_f32 v50, v20, v21
  v_mfma_f32_32x32x16_bf16 v[32:47], v[136:139], v[132:135], v[112:127]
  v_exp_f32 v23, v23
  v_exp_f32 v24, v24
  v_cvt_pk_bf16_f32 v51, v22, v23
  v_exp_f32 v25, v25
  v_exp_f32 v26, v26
  v_exp_f32 v27, v27
  s_waitcnt lgkmcnt(1)
  v_mfma_f32_32x32x16_bf16 v[64:79], v[144:147], v[48:51], v[64:79]
  v_cvt_pk_bf16_f32 v52, v24, v25
  v_exp_f32 v28, v28
  v_exp_f32 v29, v29
  v_cvt_pk_bf16_f32 v53, v26, v27
  v_exp_f32 v30, v30
  v_exp_f32 v31, v31
  v_cvt_pk_bf16_f32 v54, v28, v29
  v_cvt_pk_bf16_f32 v55, v30, v31
  v_exp_f32 v32, v32
  v_exp_f32 v33, v33
  v_exp_f32 v34, v34
  v_cvt_pk_bf16_f32 v56, v32, v33
  v_mfma_f32_32x32x16_bf16 v[64:79], v[148:151], v[52:55], v[64:79]
  v_exp_f32 v35, v35
  v_exp_f32 v36, v36
  global_load_dwordx4 a[200:203], v2, s[78:79] offset:2048 sc1
  v_cvt_pk_bf16_f32 v57, v34, v35
  v_exp_f32 v37, v37
  v_exp_f32 v38, v38
  v_cvt_pk_bf16_f32 v58, v36, v37
  s_waitcnt lgkmcnt(0)
  v_mfma_f32_32x32x16_bf16 v[16:31], v[140:143], v[128:131], v[96:111]
  ds_read_b128 v[152:155], v161 offset:1024
  ds_read_b128 v[156:159], v161 offset:1536
  v_exp_f32 v39, v39
  v_exp_f32 v40, v40
  v_cvt_pk_bf16_f32 v59, v38, v39
  v_exp_f32 v41, v41
  v_exp_f32 v42, v42
  v_exp_f32 v43, v43
  v_mfma_f32_32x32x16_bf16 v[80:95], v[144:147], v[56:59], v[80:95]
  v_cvt_pk_bf16_f32 v60, v40, v41
  v_exp_f32 v44, v44
  v_exp_f32 v45, v45
  global_load_dwordx4 a[204:207], v2, s[78:79] offset:3072 sc1
  s_add_u32 s78, s78, 4096
  s_addc_u32 s79, s79, 0
  v_cvt_pk_bf16_f32 v61, v42, v43
  v_exp_f32 v46, v46
  v_exp_f32 v47, v47
  v_cvt_pk_bf16_f32 v62, v44, v45
  v_cvt_pk_bf16_f32 v63, v46, v47
  v_exp_f32 v16, v16
  v_exp_f32 v17, v17
  v_exp_f32 v18, v18
  v_cvt_pk_bf16_f32 v48, v16, v17
  v_mfma_f32_32x32x16_bf16 v[80:95], v[148:151], v[60:63], v[80:95]
  ds_read_b128 v[136:139], v160 offset:6144
  v_exp_f32 v19, v19
  v_exp_f32 v20, v20
  global_load_dwordx4 a[208:211], v2, s[78:79] offset:0 sc1
  v_cvt_pk_bf16_f32 v49, v18, v19
  v_exp_f32 v21, v21
  v_exp_f32 v22, v22
  v_cvt_pk_bf16_f32 v50, v20, v21
  v_mfma_f32_32x32x16_bf16 v[32:47], v[140:143], v[132:135], v[112:127]
  v_exp_f32 v23, v23
  v_exp_f32 v24, v24
  v_cvt_pk_bf16_f32 v51, v22, v23
  v_exp_f32 v25, v25
  v_exp_f32 v26, v26
  v_exp_f32 v27, v27
  s_waitcnt lgkmcnt(1)
  v_mfma_f32_32x32x16_bf16 v[64:79], v[152:155], v[48:51], v[64:79]
  v_cvt_pk_bf16_f32 v52, v24, v25
  v_exp_f32 v28, v28
  v_exp_f32 v29, v29
  global_load_dwordx4 a[212:215], v2, s[78:79] offset:1024 sc1
  v_cvt_pk_bf16_f32 v53, v26, v27
  v_exp_f32 v30, v30
  v_exp_f32 v31, v31
  v_cvt_pk_bf16_f32 v54, v28, v29
  v_cvt_pk_bf16_f32 v55, v30, v31
  v_exp_f32 v32, v32
  v_exp_f32 v33, v33
  v_exp_f32 v34, v34
  v_cvt_pk_bf16_f32 v56, v32, v33
  v_mfma_f32_32x32x16_bf16 v[64:79], v[156:159], v[52:55], v[64:79]
  v_exp_f32 v35, v35
  v_exp_f32 v36, v36
  global_load_dwordx4 a[216:219], v2, s[78:79] offset:2048 sc1
  v_cvt_pk_bf16_f32 v57, v34, v35
  v_exp_f32 v37, v37
  v_exp_f32 v38, v38
  v_cvt_pk_bf16_f32 v58, v36, v37
  s_waitcnt lgkmcnt(0)
  v_mfma_f32_32x32x16_bf16 v[16:31], v[136:139], v[128:131], v[96:111]
  ds_read_b128 v[144:147], v161 offset:2048
  ds_read_b128 v[148:151], v161 offset:2560
  v_exp_f32 v39, v39
  v_exp_f32 v40, v40
  v_cvt_pk_bf16_f32 v59, v38, v39
  v_exp_f32 v41, v41
  v_exp_f32 v42, v42
  v_exp_f32 v43, v43
  v_mfma_f32_32x32x16_bf16 v[80:95], v[152:155], v[56:59], v[80:95]
  v_cvt_pk_bf16_f32 v60, v40, v41
  v_exp_f32 v44, v44
  v_exp_f32 v45, v45
  s_mul_i32 s40, s38, 7
  s_add_u32 s40, s40, 0
  s_lshl_b32 s40, s40, 15
  s_lshl_b32 s41, s32, 13
  s_add_u32 s40, s40, s41
  s_add_u32 s40, s40, 7340032
  s_add_u32 s100, s30, s40
  s_addc_u32 s101, s31, 0
  s_add_u32 s76, s41, 0
  s_mov_b32 m0, s76
  s_nop 0
  global_load_lds_dwordx4 v2, s[100:101] offset:0 sc1
  v_cvt_pk_bf16_f32 v61, v42, v43
  v_exp_f32 v46, v46
  v_exp_f32 v47, v47
  v_cvt_pk_bf16_f32 v62, v44, v45
  v_cvt_pk_bf16_f32 v63, v46, v47
  v_exp_f32 v16, v16
  v_exp_f32 v17, v17
  v_exp_f32 v18, v18
  v_cvt_pk_bf16_f32 v48, v16, v17
  v_mfma_f32_32x32x16_bf16 v[80:95], v[156:159], v[60:63], v[80:95]
  ds_read_b128 v[140:143], v160 offset:7168
  v_exp_f32 v19, v19
  v_exp_f32 v20, v20
  global_load_dwordx4 a[220:223], v2, s[78:79] offset:3072 sc1
  s_add_u32 s78, s78, 28672
  s_addc_u32 s79, s79, 0
  v_cvt_pk_bf16_f32 v49, v18, v19
  v_exp_f32 v21, v21
  v_exp_f32 v22, v22
  v_cvt_pk_bf16_f32 v50, v20, v21
  v_mfma_f32_32x32x16_bf16 v[32:47], v[136:139], v[132:135], v[112:127]
  v_exp_f32 v23, v23
  v_exp_f32 v24, v24
  v_cvt_pk_bf16_f32 v51, v22, v23
  v_exp_f32 v25, v25
  v_exp_f32 v26, v26
  v_exp_f32 v27, v27
  s_waitcnt lgkmcnt(1)
  v_mfma_f32_32x32x16_bf16 v[64:79], v[144:147], v[48:51], v[64:79]
  v_cvt_pk_bf16_f32 v52, v24, v25
  v_exp_f32 v28, v28
  v_exp_f32 v29, v29
  global_load_dwordx4 a[224:227], v2, s[78:79] offset:0 sc1
  v_cvt_pk_bf16_f32 v53, v26, v27
  v_exp_f32 v30, v30
  v_exp_f32 v31, v31
  v_cvt_pk_bf16_f32 v54, v28, v29
  v_cvt_pk_bf16_f32 v55, v30, v31
  v_exp_f32 v32, v32
  v_exp_f32 v33, v33
  v_exp_f32 v34, v34
  v_cvt_pk_bf16_f32 v56, v32, v33
  v_mfma_f32_32x32x16_bf16 v[64:79], v[148:151], v[52:55], v[64:79]
  v_exp_f32 v35, v35
  v_exp_f32 v36, v36
  global_load_dwordx4 a[228:231], v2, s[78:79] offset:1024 sc1
  v_cvt_pk_bf16_f32 v57, v34, v35
  v_exp_f32 v37, v37
  v_exp_f32 v38, v38
  v_cvt_pk_bf16_f32 v58, v36, v37
  s_waitcnt lgkmcnt(0)
  v_mfma_f32_32x32x16_bf16 v[16:31], v[140:143], v[128:131], v[96:111]
  ds_read_b128 v[152:155], v161 offset:3072
  ds_read_b128 v[156:159], v161 offset:3584
  v_exp_f32 v39, v39
  v_exp_f32 v40, v40
  v_cvt_pk_bf16_f32 v59, v38, v39
  v_exp_f32 v41, v41
  v_exp_f32 v42, v42
  v_exp_f32 v43, v43
  v_mfma_f32_32x32x16_bf16 v[80:95], v[144:147], v[56:59], v[80:95]
  v_cvt_pk_bf16_f32 v60, v40, v41
  v_exp_f32 v44, v44
  v_exp_f32 v45, v45
  global_load_lds_dwordx4 v2, s[100:101] offset:1024 sc1
  v_cvt_pk_bf16_f32 v61, v42, v43
  v_exp_f32 v46, v46
  v_exp_f32 v47, v47
  v_cvt_pk_bf16_f32 v62, v44, v45
  v_cvt_pk_bf16_f32 v63, v46, v47
  v_exp_f32 v16, v16
  v_exp_f32 v17, v17
  v_exp_f32 v18, v18
  v_cvt_pk_bf16_f32 v48, v16, v17
  v_mfma_f32_32x32x16_bf16 v[80:95], v[148:151], v[60:63], v[80:95]
  ds_read_b128 v[136:139], v160 offset:8192
  v_exp_f32 v19, v19
  v_exp_f32 v20, v20
  global_load_dwordx4 a[232:235], v2, s[78:79] offset:2048 sc1
  v_cvt_pk_bf16_f32 v49, v18, v19
  v_exp_f32 v21, v21
  v_exp_f32 v22, v22
  v_cvt_pk_bf16_f32 v50, v20, v21
  v_mfma_f32_32x32x16_bf16 v[32:47], v[140:143], v[132:135], v[112:127]
  v_exp_f32 v23, v23
  v_exp_f32 v24, v24
  v_cvt_pk_bf16_f32 v51, v22, v23
  v_exp_f32 v25, v25
  v_exp_f32 v26, v26
  v_exp_f32 v27, v27
  s_waitcnt lgkmcnt(1)
  v_mfma_f32_32x32x16_bf16 v[64:79], v[152:155], v[48:51], v[64:79]
  v_cvt_pk_bf16_f32 v52, v24, v25
  v_exp_f32 v28, v28
  v_exp_f32 v29, v29
  global_load_dwordx4 a[236:239], v2, s[78:79] offset:3072 sc1
  s_add_u32 s78, s78, 4096
  s_addc_u32 s79, s79, 0
  v_cvt_pk_bf16_f32 v53, v26, v27
  v_exp_f32 v30, v30
  v_exp_f32 v31, v31
  v_cvt_pk_bf16_f32 v54, v28, v29
  v_cvt_pk_bf16_f32 v55, v30, v31
  v_exp_f32 v32, v32
  v_exp_f32 v33, v33
  v_exp_f32 v34, v34
  v_cvt_pk_bf16_f32 v56, v32, v33
  v_mfma_f32_32x32x16_bf16 v[64:79], v[156:159], v[52:55], v[64:79]
  v_exp_f32 v35, v35
  v_exp_f32 v36, v36
  v_lshrrev_b32 v8, 2, v0
  s_lshl_b32 s40, s35, 6
  v_add_u32 v8, s40, v8
  v_lshlrev_b32 v8, 10, v8
  v_and_b32 v9, 3, v0
  v_lshl_add_u32 v8, v9, 5, v8
  s_lshl_b32 s40, s36, 7
  v_add_u32 v8, s40, v8
  global_load_dwordx4 v[164:167], v8, s[4:5]
  v_cvt_pk_bf16_f32 v57, v34, v35
  v_exp_f32 v37, v37
  v_exp_f32 v38, v38
  v_cvt_pk_bf16_f32 v58, v36, v37
  s_waitcnt lgkmcnt(0)
  v_mfma_f32_32x32x16_bf16 v[16:31], v[136:139], v[128:131], v[96:111]
  v_add_u32 v161, v161, v162
  ds_read_b128 v[144:147], v161 offset:0
  ds_read_b128 v[148:151], v161 offset:512
  v_exp_f32 v39, v39
  v_exp_f32 v40, v40
  v_cvt_pk_bf16_f32 v59, v38, v39
  v_exp_f32 v41, v41
  v_exp_f32 v42, v42
  v_exp_f32 v43, v43
  v_mfma_f32_32x32x16_bf16 v[80:95], v[152:155], v[56:59], v[80:95]
  v_cvt_pk_bf16_f32 v60, v40, v41
  v_exp_f32 v44, v44
  v_exp_f32 v45, v45
  global_load_dwordx4 a[240:243], v2, s[78:79] offset:0 sc1
  v_cvt_pk_bf16_f32 v61, v42, v43
  v_exp_f32 v46, v46
  v_exp_f32 v47, v47
  v_cvt_pk_bf16_f32 v62, v44, v45
  v_cvt_pk_bf16_f32 v63, v46, v47
  v_exp_f32 v16, v16
  v_exp_f32 v17, v17
  v_exp_f32 v18, v18
  v_cvt_pk_bf16_f32 v48, v16, v17
  v_mfma_f32_32x32x16_bf16 v[80:95], v[156:159], v[60:63], v[80:95]
  ds_read_b128 v[140:143], v160 offset:9216
  v_exp_f32 v19, v19
  v_exp_f32 v20, v20
  global_load_lds_dwordx4 v2, s[100:101] offset:2048 sc1
  v_cvt_pk_bf16_f32 v49, v18, v19
  v_exp_f32 v21, v21
  v_exp_f32 v22, v22
  v_cvt_pk_bf16_f32 v50, v20, v21
  v_mfma_f32_32x32x16_bf16 v[32:47], v[136:139], v[132:135], v[112:127]
  v_exp_f32 v23, v23
  v_exp_f32 v24, v24
  v_cvt_pk_bf16_f32 v51, v22, v23
  v_exp_f32 v25, v25
  v_exp_f32 v26, v26
  v_exp_f32 v27, v27
  s_waitcnt lgkmcnt(1)
  v_mfma_f32_32x32x16_bf16 v[64:79], v[144:147], v[48:51], v[64:79]
  v_cvt_pk_bf16_f32 v52, v24, v25
  v_exp_f32 v28, v28
  v_exp_f32 v29, v29
  global_load_dwordx4 a[244:247], v2, s[78:79] offset:1024 sc1
  v_cvt_pk_bf16_f32 v53, v26, v27
  v_exp_f32 v30, v30
  v_exp_f32 v31, v31
  v_cvt_pk_bf16_f32 v54, v28, v29
  v_cvt_pk_bf16_f32 v55, v30, v31
  v_exp_f32 v32, v32
  v_exp_f32 v33, v33
  v_exp_f32 v34, v34
  v_cvt_pk_bf16_f32 v56, v32, v33
  v_mfma_f32_32x32x16_bf16 v[64:79], v[148:151], v[52:55], v[64:79]
  v_exp_f32 v35, v35
  v_exp_f32 v36, v36
  global_load_dwordx4 v[168:171], v8, s[4:5] offset:16
  v_lshlrev_b32 v9, 6, v9
  s_lshl_b32 s40, s36, 8
  s_add_u32 s40, s40, 36864
  v_add_u32 v9, s40, v9
  v_cvt_pk_bf16_f32 v57, v34, v35
  v_exp_f32 v37, v37
  v_exp_f32 v38, v38
  v_cvt_pk_bf16_f32 v58, v36, v37
  s_waitcnt lgkmcnt(0)
  v_mfma_f32_32x32x16_bf16 v[16:31], v[140:143], v[128:131], v[96:111]
  ds_read_b128 v[152:155], v161 offset:1024
  ds_read_b128 v[156:159], v161 offset:1536
  v_exp_f32 v39, v39
  v_exp_f32 v40, v40
  v_cvt_pk_bf16_f32 v59, v38, v39
  v_exp_f32 v41, v41
  v_exp_f32 v42, v42
  v_exp_f32 v43, v43
  v_mfma_f32_32x32x16_bf16 v[80:95], v[144:147], v[56:59], v[80:95]
  v_cvt_pk_bf16_f32 v60, v40, v41
  v_exp_f32 v44, v44
  v_exp_f32 v45, v45
  global_load_dwordx4 a[248:251], v2, s[78:79] offset:2048 sc1
  v_cvt_pk_bf16_f32 v61, v42, v43
  v_exp_f32 v46, v46
  v_exp_f32 v47, v47
  v_cvt_pk_bf16_f32 v62, v44, v45
  v_cvt_pk_bf16_f32 v63, v46, v47
  v_exp_f32 v16, v16
  v_exp_f32 v17, v17
  v_exp_f32 v18, v18
  v_cvt_pk_bf16_f32 v48, v16, v17
  v_mfma_f32_32x32x16_bf16 v[80:95], v[148:151], v[60:63], v[80:95]
  ds_read_b128 v[136:139], v160 offset:10240
  v_exp_f32 v19, v19
  v_exp_f32 v20, v20
  s_waitcnt vmcnt(20)
  s_barrier
  s_cmp_lg_u32 s32, 0
  s_cbranch_scc1 L_sua_57
  s_lshl_b32 s40, s33, 7
  s_add_u32 s40, s40, 12288
  v_mov_b32 v10, s40
  v_mov_b32 v11, 1
  s_mov_b64 exec, 1
  global_atomic_add v10, v11, s[30:31] sc1
  s_mov_b64 exec, -1
L_sua_57:
  v_cvt_pk_bf16_f32 v49, v18, v19
  v_exp_f32 v21, v21
  v_exp_f32 v22, v22
  v_cvt_pk_bf16_f32 v50, v20, v21
  v_mfma_f32_32x32x16_bf16 v[32:47], v[140:143], v[132:135], v[112:127]
  v_exp_f32 v23, v23
  v_exp_f32 v24, v24
  v_cvt_pk_bf16_f32 v51, v22, v23
  v_exp_f32 v25, v25
  v_exp_f32 v26, v26
  v_exp_f32 v27, v27
  s_waitcnt lgkmcnt(1)
  v_mfma_f32_32x32x16_bf16 v[64:79], v[152:155], v[48:51], v[64:79]
  v_cvt_pk_bf16_f32 v52, v24, v25
  v_exp_f32 v28, v28
  v_exp_f32 v29, v29
  v_cvt_pk_bf16_f32 v53, v26, v27
  v_exp_f32 v30, v30
  v_exp_f32 v31, v31
  v_cvt_pk_bf16_f32 v54, v28, v29
  v_cvt_pk_bf16_f32 v55, v30, v31
  v_exp_f32 v32, v32
  v_exp_f32 v33, v33
  v_exp_f32 v34, v34
  v_cvt_pk_bf16_f32 v56, v32, v33
  v_mfma_f32_32x32x16_bf16 v[64:79], v[156:159], v[52:55], v[64:79]
  v_exp_f32 v35, v35
  v_exp_f32 v36, v36
  global_load_dwordx4 a[252:255], v2, s[78:79] offset:3072 sc1
  v_cvt_pk_bf16_f32 v57, v34, v35
  v_exp_f32 v37, v37
  v_exp_f32 v38, v38
  v_cvt_pk_bf16_f32 v58, v36, v37
  s_waitcnt lgkmcnt(0)
  v_mfma_f32_32x32x16_bf16 v[16:31], v[136:139], v[128:131], v[96:111]
  ds_read_b128 v[144:147], v161 offset:2048
  ds_read_b128 v[148:151], v161 offset:2560
  v_exp_f32 v39, v39
  v_exp_f32 v40, v40
  v_cvt_pk_bf16_f32 v59, v38, v39
  v_exp_f32 v41, v41
  v_exp_f32 v42, v42
  v_exp_f32 v43, v43
  v_mfma_f32_32x32x16_bf16 v[80:95], v[152:155], v[56:59], v[80:95]
  v_cvt_pk_bf16_f32 v60, v40, v41
  v_exp_f32 v44, v44
  v_exp_f32 v45, v45
  global_load_lds_dwordx4 v2, s[100:101] offset:3072 sc1
  v_cvt_pk_bf16_f32 v61, v42, v43
  v_exp_f32 v46, v46
  v_exp_f32 v47, v47
  v_cvt_pk_bf16_f32 v62, v44, v45
  v_cvt_pk_bf16_f32 v63, v46, v47
  v_exp_f32 v16, v16
  v_exp_f32 v17, v17
  v_exp_f32 v18, v18
  v_cvt_pk_bf16_f32 v48, v16, v17
  v_mfma_f32_32x32x16_bf16 v[80:95], v[156:159], v[60:63], v[80:95]
  ds_read_b128 v[140:143], v160 offset:11264
  v_exp_f32 v19, v19
  v_exp_f32 v20, v20
  s_mul_i32 s40, s36, 224
  s_mul_i32 s41, s32, 28
  s_add_u32 s40, s40, s41
  s_lshl_b32 s40, s40, 10
  s_add_u32 s40, s40, 5242880
  s_add_u32 s78, s30, s40
  s_addc_u32 s79, s31, 0
  s_add_u32 s80, s78, 114688
  s_addc_u32 s81, s79, 0
  global_load_dwordx4 a[0:3], v2, s[78:79] offset:0 sc1
  v_cvt_pk_bf16_f32 v49, v18, v19
  v_exp_f32 v21, v21
  v_exp_f32 v22, v22
  v_cvt_pk_bf16_f32 v50, v20, v21
  v_mfma_f32_32x32x16_bf16 v[32:47], v[136:139], v[132:135], v[112:127]
  v_exp_f32 v23, v23
  v_exp_f32 v24, v24
  v_cvt_pk_bf16_f32 v51, v22, v23
  v_exp_f32 v25, v25
  v_exp_f32 v26, v26
  v_exp_f32 v27, v27
  s_waitcnt lgkmcnt(1)
  v_mfma_f32_32x32x16_bf16 v[64:79], v[144:147], v[48:51], v[64:79]
  v_cvt_pk_bf16_f32 v52, v24, v25
  v_exp_f32 v28, v28
  v_exp_f32 v29, v29
  global_load_dwordx4 v[172:175], v9, s[30:31] offset:0 sc1
  v_cvt_pk_bf16_f32 v53, v26, v27
  v_exp_f32 v30, v30
  v_exp_f32 v31, v31
  v_cvt_pk_bf16_f32 v54, v28, v29
  v_cvt_pk_bf16_f32 v55, v30, v31
  v_exp_f32 v32, v32
  v_exp_f32 v33, v33
  v_exp_f32 v34, v34
  v_cvt_pk_bf16_f32 v56, v32, v33
  v_mfma_f32_32x32x16_bf16 v[64:79], v[148:151], v[52:55], v[64:79]
  v_exp_f32 v35, v35
  v_exp_f32 v36, v36
  global_load_dwordx4 a[4:7], v2, s[80:81] offset:0 sc1
  v_cvt_pk_bf16_f32 v57, v34, v35
  v_exp_f32 v37, v37
  v_exp_f32 v38, v38
  v_cvt_pk_bf16_f32 v58, v36, v37
  s_waitcnt lgkmcnt(0)
  v_mfma_f32_32x32x16_bf16 v[16:31], v[140:143], v[128:131], v[96:111]
  ds_read_b128 v[152:155], v161 offset:3072
  ds_read_b128 v[156:159], v161 offset:3584
  v_exp_f32 v39, v39
  v_exp_f32 v40, v40
  v_cvt_pk_bf16_f32 v59, v38, v39
  v_exp_f32 v41, v41
  v_exp_f32 v42, v42
  v_exp_f32 v43, v43
  v_mfma_f32_32x32x16_bf16 v[80:95], v[144:147], v[56:59], v[80:95]
  v_cvt_pk_bf16_f32 v60, v40, v41
  v_exp_f32 v44, v44
  v_exp_f32 v45, v45
  global_load_dwordx4 a[8:11], v2, s[78:79] offset:1024 sc1
  v_cvt_pk_bf16_f32 v61, v42, v43
  v_exp_f32 v46, v46
  v_exp_f32 v47, v47
  v_cvt_pk_bf16_f32 v62, v44, v45
  v_cvt_pk_bf16_f32 v63, v46, v47
  v_exp_f32 v16, v16
  v_exp_f32 v17, v17
  v_exp_f32 v18, v18
  v_cvt_pk_bf16_f32 v48, v16, v17
  v_mfma_f32_32x32x16_bf16 v[80:95], v[148:151], v[60:63], v[80:95]
  ds_read_b128 v[136:139], v160 offset:12288
  v_exp_f32 v19, v19
  v_exp_f32 v20, v20
  s_add_u32 s100, s100, 4096
  s_addc_u32 s101, s101, 0
  s_add_u32 m0, s76, 4096
  s_nop 0
  global_load_lds_dwordx4 v2, s[100:101] offset:0 sc1
  v_cvt_pk_bf16_f32 v49, v18, v19
  v_exp_f32 v21, v21
  v_exp_f32 v22, v22
  v_cvt_pk_bf16_f32 v50, v20, v21
  v_mfma_f32_32x32x16_bf16 v[32:47], v[140:143], v[132:135], v[112:127]
  v_exp_f32 v23, v23
  v_exp_f32 v24, v24
  v_cvt_pk_bf16_f32 v51, v22, v23
  v_exp_f32 v25, v25
  v_exp_f32 v26, v26
  v_exp_f32 v27, v27
  s_waitcnt lgkmcnt(1)
  v_mfma_f32_32x32x16_bf16 v[64:79], v[152:155], v[48:51], v[64:79]
  v_cvt_pk_bf16_f32 v52, v24, v25
  v_exp_f32 v28, v28
  v_exp_f32 v29, v29
  global_load_dwordx4 a[12:15], v2, s[80:81] offset:1024 sc1
  v_cvt_pk_bf16_f32 v53, v26, v27
  v_exp_f32 v30, v30
  v_exp_f32 v31, v31
  v_cvt_pk_bf16_f32 v54, v28, v29
  v_cvt_pk_bf16_f32 v55, v30, v31
  v_exp_f32 v32, v32
  v_exp_f32 v33, v33
  v_exp_f32 v34, v34
  v_cvt_pk_bf16_f32 v56, v32, v33
  v_mfma_f32_32x32x16_bf16 v[64:79], v[156:159], v[52:55], v[64:79]
  v_exp_f32 v35, v35
  v_exp_f32 v36, v36
  global_load_dwordx4 v[176:179], v9, s[30:31] offset:16 sc1
  v_cvt_pk_bf16_f32 v57, v34, v35
  v_exp_f32 v37, v37
  v_exp_f32 v38, v38
  v_cvt_pk_bf16_f32 v58, v36, v37
  s_waitcnt lgkmcnt(0)
  v_mfma_f32_32x32x16_bf16 v[16:31], v[136:139], v[128:131], v[96:111]
  v_add_u32 v161, v161, v162
  ds_read_b128 v[144:147], v161 offset:0
  ds_read_b128 v[148:151], v161 offset:512
  v_exp_f32 v39, v39
  v_exp_f32 v40, v40
  v_cvt_pk_bf16_f32 v59, v38, v39
  v_exp_f32 v41, v41
  v_exp_f32 v42, v42
  v_exp_f32 v43, v43
  v_mfma_f32_32x32x16_bf16 v[80:95], v[152:155], v[56:59], v[80:95]
  v_cvt_pk_bf16_f32 v60, v40, v41
  v_exp_f32 v44, v44
  v_exp_f32 v45, v45
  global_load_dwordx4 a[16:19], v2, s[78:79] offset:2048 sc1
  v_cvt_pk_bf16_f32 v61, v42, v43
  v_exp_f32 v46, v46
  v_exp_f32 v47, v47
  v_cvt_pk_bf16_f32 v62, v44, v45
  v_cvt_pk_bf16_f32 v63, v46, v47
  v_exp_f32 v16, v16
  v_exp_f32 v17, v17
  v_exp_f32 v18, v18
  v_cvt_pk_bf16_f32 v48, v16, v17
  v_mfma_f32_32x32x16_bf16 v[80:95], v[156:159], v[60:63], v[80:95]
  ds_read_b128 v[140:143], v160 offset:13312
  v_exp_f32 v19, v19
  v_exp_f32 v20, v20
  global_load_lds_dwordx4 v2, s[100:101] offset:1024 sc1
  v_cvt_pk_bf16_f32 v49, v18, v19
  v_exp_f32 v21, v21
  v_exp_f32 v22, v22
  v_cvt_pk_bf16_f32 v50, v20, v21
  v_mfma_f32_32x32x16_bf16 v[32:47], v[136:139], v[132:135], v[112:127]
  v_exp_f32 v23, v23
  v_exp_f32 v24, v24
  v_cvt_pk_bf16_f32 v51, v22, v23
  v_exp_f32 v25, v25
  v_exp_f32 v26, v26
  v_exp_f32 v27, v27
  s_waitcnt lgkmcnt(1)
  v_mfma_f32_32x32x16_bf16 v[64:79], v[144:147], v[48:51], v[64:79]
  v_cvt_pk_bf16_f32 v52, v24, v25
  v_exp_f32 v28, v28
  v_exp_f32 v29, v29
  global_load_dwordx4 a[20:23], v2, s[80:81] offset:2048 sc1
  v_cvt_pk_bf16_f32 v53, v26, v27
  v_exp_f32 v30, v30
  v_exp_f32 v31, v31
  v_cvt_pk_bf16_f32 v54, v28, v29
  v_cvt_pk_bf16_f32 v55, v30, v31
  v_exp_f32 v32, v32
  v_exp_f32 v33, v33
  v_exp_f32 v34, v34
  v_cvt_pk_bf16_f32 v56, v32, v33
  v_mfma_f32_32x32x16_bf16 v[64:79], v[148:151], v[52:55], v[64:79]
  v_exp_f32 v35, v35
  v_exp_f32 v36, v36
  global_load_dwordx4 a[24:27], v2, s[78:79] offset:3072 sc1
  v_cvt_pk_bf16_f32 v57, v34, v35
  v_exp_f32 v37, v37
  v_exp_f32 v38, v38
  v_cvt_pk_bf16_f32 v58, v36, v37
  s_waitcnt lgkmcnt(0)
  v_mfma_f32_32x32x16_bf16 v[16:31], v[140:143], v[128:131], v[96:111]
  ds_read_b128 v[152:155], v161 offset:1024
  ds_read_b128 v[156:159], v161 offset:1536
  v_exp_f32 v39, v39
  v_exp_f32 v40, v40
  v_cvt_pk_bf16_f32 v59, v38, v39
  v_exp_f32 v41, v41
  v_exp_f32 v42, v42
  v_exp_f32 v43, v43
  v_mfma_f32_32x32x16_bf16 v[80:95], v[144:147], v[56:59], v[80:95]
  v_cvt_pk_bf16_f32 v60, v40, v41
  v_exp_f32 v44, v44
  v_exp_f32 v45, v45
  global_load_dwordx4 v[180:183], v9, s[30:31] offset:32 sc1
  v_cvt_pk_bf16_f32 v61, v42, v43
  v_exp_f32 v46, v46
  v_exp_f32 v47, v47
  v_cvt_pk_bf16_f32 v62, v44, v45
  v_cvt_pk_bf16_f32 v63, v46, v47
  v_exp_f32 v16, v16
  v_exp_f32 v17, v17
  v_exp_f32 v18, v18
  v_cvt_pk_bf16_f32 v48, v16, v17
  v_mfma_f32_32x32x16_bf16 v[80:95], v[148:151], v[60:63], v[80:95]
  ds_read_b128 v[136:139], v160 offset:14336
  v_exp_f32 v19, v19
  v_exp_f32 v20, v20
  global_load_dwordx4 a[28:31], v2, s[80:81] offset:3072 sc1
  s_add_u32 s78, s78, 4096
  s_addc_u32 s79, s79, 0
  s_add_u32 s80, s80, 4096
  s_addc_u32 s81, s81, 0
  v_cvt_pk_bf16_f32 v49, v18, v19
  v_exp_f32 v21, v21
  v_exp_f32 v22, v22
  v_cvt_pk_bf16_f32 v50, v20, v21
  v_mfma_f32_32x32x16_bf16 v[32:47], v[140:143], v[132:135], v[112:127]
  v_exp_f32 v23, v23
  v_exp_f32 v24, v24
  v_cvt_pk_bf16_f32 v51, v22, v23
  v_exp_f32 v25, v25
  v_exp_f32 v26, v26
  v_exp_f32 v27, v27
  s_waitcnt lgkmcnt(1)
  v_mfma_f32_32x32x16_bf16 v[64:79], v[152:155], v[48:51], v[64:79]
  v_cvt_pk_bf16_f32 v52, v24, v25
  v_exp_f32 v28, v28
  v_exp_f32 v29, v29
  global_load_lds_dwordx4 v2, s[100:101] offset:2048 sc1
  v_cvt_pk_bf16_f32 v53, v26, v27
  v_exp_f32 v30, v30
  v_exp_f32 v31, v31
  v_cvt_pk_bf16_f32 v54, v28, v29
  v_cvt_pk_bf16_f32 v55, v30, v31
  v_exp_f32 v32, v32
  v_exp_f32 v33, v33
  v_exp_f32 v34, v34
  v_cvt_pk_bf16_f32 v56, v32, v33
  v_mfma_f32_32x32x16_bf16 v[64:79], v[156:159], v[52:55], v[64:79]
  v_exp_f32 v35, v35
  v_exp_f32 v36, v36
  global_load_dwordx4 a[32:35], v2, s[78:79] offset:0 sc1
  v_cvt_pk_bf16_f32 v57, v34, v35
  v_exp_f32 v37, v37
  v_exp_f32 v38, v38
  v_cvt_pk_bf16_f32 v58, v36, v37
  s_waitcnt lgkmcnt(0)
  v_mfma_f32_32x32x16_bf16 v[16:31], v[136:139], v[128:131], v[96:111]
  ds_read_b128 v[144:147], v161 offset:2048
  ds_read_b128 v[148:151], v161 offset:2560
  v_exp_f32 v39, v39
  v_exp_f32 v40, v40
  v_cvt_pk_bf16_f32 v59, v38, v39
  v_exp_f32 v41, v41
  v_exp_f32 v42, v42
  v_exp_f32 v43, v43
  v_mfma_f32_32x32x16_bf16 v[80:95], v[152:155], v[56:59], v[80:95]
  v_cvt_pk_bf16_f32 v60, v40, v41
  v_exp_f32 v44, v44
  v_exp_f32 v45, v45
  global_load_dwordx4 a[36:39], v2, s[80:81] offset:0 sc1
  v_cvt_pk_bf16_f32 v61, v42, v43
  v_exp_f32 v46, v46
  v_exp_f32 v47, v47
  v_cvt_pk_bf16_f32 v62, v44, v45
  v_cvt_pk_bf16_f32 v63, v46, v47
  v_exp_f32 v16, v16
  v_exp_f32 v17, v17
  v_exp_f32 v18, v18
  v_cvt_pk_bf16_f32 v48, v16, v17
  v_mfma_f32_32x32x16_bf16 v[80:95], v[156:159], v[60:63], v[80:95]
  ds_read_b128 v[140:143], v160 offset:15360
  v_exp_f32 v19, v19
  v_exp_f32 v20, v20
  global_load_dwordx4 v[184:187], v9, s[30:31] offset:48 sc1
  v_add_u32 v9, 4096, v9
  v_cvt_pk_bf16_f32 v49, v18, v19
  v_exp_f32 v21, v21
  v_exp_f32 v22, v22
  v_cvt_pk_bf16_f32 v50, v20, v21
  v_mfma_f32_32x32x16_bf16 v[32:47], v[136:139], v[132:135], v[112:127]
  v_exp_f32 v23, v23
  v_exp_f32 v24, v24
  v_cvt_pk_bf16_f32 v51, v22, v23
  v_exp_f32 v25, v25
  v_exp_f32 v26, v26
  v_exp_f32 v27, v27
  s_waitcnt lgkmcnt(1)
  v_mfma_f32_32x32x16_bf16 v[64:79], v[144:147], v[48:51], v[64:79]
  v_cvt_pk_bf16_f32 v52, v24, v25
  v_exp_f32 v28, v28
  v_exp_f32 v29, v29
  global_load_dwordx4 a[40:43], v2, s[78:79] offset:1024 sc1
  v_cvt_pk_bf16_f32 v53, v26, v27
  v_exp_f32 v30, v30
  v_exp_f32 v31, v31
  v_cvt_pk_bf16_f32 v54, v28, v29
  v_cvt_pk_bf16_f32 v55, v30, v31
  v_exp_f32 v32, v32
  v_exp_f32 v33, v33
  v_exp_f32 v34, v34
  v_cvt_pk_bf16_f32 v56, v32, v33
  v_mfma_f32_32x32x16_bf16 v[64:79], v[148:151], v[52:55], v[64:79]
  v_exp_f32 v35, v35
  v_exp_f32 v36, v36
  global_load_lds_dwordx4 v2, s[100:101] offset:3072 sc1
  v_cvt_pk_bf16_f32 v57, v34, v35
  v_exp_f32 v37, v37
  v_exp_f32 v38, v38
  v_cvt_pk_bf16_f32 v58, v36, v37
  s_waitcnt lgkmcnt(0)
  v_mfma_f32_32x32x16_bf16 v[16:31], v[140:143], v[128:131], v[96:111]
  ds_read_b128 v[152:155], v161 offset:3072
  ds_read_b128 v[156:159], v161 offset:3584
  v_exp_f32 v39, v39
  v_exp_f32 v40, v40
  v_cvt_pk_bf16_f32 v59, v38, v39
  v_exp_f32 v41, v41
  v_exp_f32 v42, v42
  v_exp_f32 v43, v43
  v_mfma_f32_32x32x16_bf16 v[80:95], v[144:147], v[56:59], v[80:95]
  v_cvt_pk_bf16_f32 v60, v40, v41
  v_exp_f32 v44, v44
  v_exp_f32 v45, v45
  global_load_dwordx4 a[44:47], v2, s[80:81] offset:1024 sc1
  v_cvt_pk_bf16_f32 v61, v42, v43
  v_exp_f32 v46, v46
  v_exp_f32 v47, v47
  v_cvt_pk_bf16_f32 v62, v44, v45
  v_cvt_pk_bf16_f32 v63, v46, v47
  v_exp_f32 v16, v16
  v_exp_f32 v17, v17
  v_exp_f32 v18, v18
  v_cvt_pk_bf16_f32 v48, v16, v17
  v_mfma_f32_32x32x16_bf16 v[80:95], v[148:151], v[60:63], v[80:95]
  ds_read_b128 v[136:139], v160 offset:16384
  v_exp_f32 v19, v19
  v_exp_f32 v20, v20
  global_load_dwordx4 v[188:191], v9, s[30:31] offset:0 sc1
  v_cvt_pk_bf16_f32 v49, v18, v19
  v_exp_f32 v21, v21
  v_exp_f32 v22, v22
  v_cvt_pk_bf16_f32 v50, v20, v21
  v_mfma_f32_32x32x16_bf16 v[32:47], v[140:143], v[132:135], v[112:127]
  v_exp_f32 v23, v23
  v_exp_f32 v24, v24
  v_cvt_pk_bf16_f32 v51, v22, v23
  v_exp_f32 v25, v25
  v_exp_f32 v26, v26
  v_exp_f32 v27, v27
  s_waitcnt lgkmcnt(1)
  v_mfma_f32_32x32x16_bf16 v[64:79], v[152:155], v[48:51], v[64:79]
  v_cvt_pk_bf16_f32 v52, v24, v25
  v_exp_f32 v28, v28
  v_exp_f32 v29, v29
  global_load_dwordx4 a[48:51], v2, s[78:79] offset:2048 sc1
  v_cvt_pk_bf16_f32 v53, v26, v27
  v_exp_f32 v30, v30
  v_exp_f32 v31, v31
  v_cvt_pk_bf16_f32 v54, v28, v29
  v_cvt_pk_bf16_f32 v55, v30, v31
  v_exp_f32 v32, v32
  v_exp_f32 v33, v33
  v_exp_f32 v34, v34
  v_cvt_pk_bf16_f32 v56, v32, v33
  v_mfma_f32_32x32x16_bf16 v[64:79], v[156:159], v[52:55], v[64:79]
  v_exp_f32 v35, v35
  v_exp_f32 v36, v36
  global_load_dwordx4 a[52:55], v2, s[80:81] offset:2048 sc1
  v_cvt_pk_bf16_f32 v57, v34, v35
  v_exp_f32 v37, v37
  v_exp_f32 v38, v38
  v_cvt_pk_bf16_f32 v58, v36, v37
  s_waitcnt lgkmcnt(0)
  v_mfma_f32_32x32x16_bf16 v[16:31], v[136:139], v[128:131], v[96:111]
  v_add_u32 v161, v161, v162
  ds_read_b128 v[144:147], v161 offset:0
  ds_read_b128 v[148:151], v161 offset:512
  v_exp_f32 v39, v39
  v_exp_f32 v40, v40
  v_cvt_pk_bf16_f32 v59, v38, v39
  v_exp_f32 v41, v41
  v_exp_f32 v42, v42
  v_exp_f32 v43, v43
  v_mfma_f32_32x32x16_bf16 v[80:95], v[152:155], v[56:59], v[80:95]
  v_cvt_pk_bf16_f32 v60, v40, v41
  v_exp_f32 v44, v44
  v_exp_f32 v45, v45
  s_mul_i32 s40, s38, 7
  s_add_u32 s40, s40, 1
  s_lshl_b32 s40, s40, 15
  s_lshl_b32 s41, s32, 13
  s_add_u32 s40, s40, s41
  s_add_u32 s40, s40, 7340032
  s_add_u32 s100, s30, s40
  s_addc_u32 s101, s31, 0
  s_add_u32 s76, s41, 65536
  s_mov_b32 m0, s76
  s_nop 0
  global_load_lds_dwordx4 v2, s[100:101] offset:0 sc1
  v_cvt_pk_bf16_f32 v61, v42, v43
  v_exp_f32 v46, v46
  v_exp_f32 v47, v47
  v_cvt_pk_bf16_f32 v62, v44, v45
  v_cvt_pk_bf16_f32 v63, v46, v47
  v_exp_f32 v16, v16
  v_exp_f32 v17, v17
  v_exp_f32 v18, v18
  v_cvt_pk_bf16_f32 v48, v16, v17
  v_mfma_f32_32x32x16_bf16 v[80:95], v[156:159], v[60:63], v[80:95]
  ds_read_b128 v[140:143], v160 offset:17408
  v_exp_f32 v19, v19
  v_exp_f32 v20, v20
  global_load_dwordx4 a[56:59], v2, s[78:79] offset:3072 sc1
  v_cvt_pk_bf16_f32 v49, v18, v19
  v_exp_f32 v21, v21
  v_exp_f32 v22, v22
  v_cvt_pk_bf16_f32 v50, v20, v21
  v_mfma_f32_32x32x16_bf16 v[32:47], v[136:139], v[132:135], v[112:127]
  v_exp_f32 v23, v23
  v_exp_f32 v24, v24
  v_cvt_pk_bf16_f32 v51, v22, v23
  v_exp_f32 v25, v25
  v_exp_f32 v26, v26
  v_exp_f32 v27, v27
  s_waitcnt lgkmcnt(1)
  v_mfma_f32_32x32x16_bf16 v[64:79], v[144:147], v[48:51], v[64:79]
  v_cvt_pk_bf16_f32 v52, v24, v25
  v_exp_f32 v28, v28
  v_exp_f32 v29, v29
  global_load_dwordx4 v[192:195], v9, s[30:31] offset:16 sc1
  v_cvt_pk_bf16_f32 v53, v26, v27
  v_exp_f32 v30, v30
  v_exp_f32 v31, v31
  v_cvt_pk_bf16_f32 v54, v28, v29
  v_cvt_pk_bf16_f32 v55, v30, v31
  v_exp_f32 v32, v32
  v_exp_f32 v33, v33
  v_exp_f32 v34, v34
  v_cvt_pk_bf16_f32 v56, v32, v33
  v_mfma_f32_32x32x16_bf16 v[64:79], v[148:151], v[52:55], v[64:79]
  v_exp_f32 v35, v35
  v_exp_f32 v36, v36
  global_load_dwordx4 a[60:63], v2, s[80:81] offset:3072 sc1
  s_add_u32 s78, s78, 4096
  s_addc_u32 s79, s79, 0
  s_add_u32 s80, s80, 4096
  s_addc_u32 s81, s81, 0
  v_cvt_pk_bf16_f32 v57, v34, v35
  v_exp_f32 v37, v37
  v_exp_f32 v38, v38
  v_cvt_pk_bf16_f32 v58, v36, v37
  s_waitcnt lgkmcnt(0)
  v_mfma_f32_32x32x16_bf16 v[16:31], v[140:143], v[128:131], v[96:111]
  ds_read_b128 v[152:155], v161 offset:1024
  ds_read_b128 v[156:159], v161 offset:1536
  v_exp_f32 v39, v39
  v_exp_f32 v40, v40
  v_cvt_pk_bf16_f32 v59, v38, v39
  v_exp_f32 v41, v41
  v_exp_f32 v42, v42
  v_exp_f32 v43, v43
  v_mfma_f32_32x32x16_bf16 v[80:95], v[144:147], v[56:59], v[80:95]
  v_cvt_pk_bf16_f32 v60, v40, v41
  v_exp_f32 v44, v44
  v_exp_f32 v45, v45
  global_load_lds_dwordx4 v2, s[100:101] offset:1024 sc1
  v_cvt_pk_bf16_f32 v61, v42, v43
  v_exp_f32 v46, v46
  v_exp_f32 v47, v47
  v_cvt_pk_bf16_f32 v62, v44, v45
  v_cvt_pk_bf16_f32 v63, v46, v47
  v_exp_f32 v16, v16
  v_exp_f32 v17, v17
  v_exp_f32 v18, v18
  v_cvt_pk_bf16_f32 v48, v16, v17
  v_mfma_f32_32x32x16_bf16 v[80:95], v[148:151], v[60:63], v[80:95]
  ds_read_b128 v[136:139], v160 offset:18432
  v_exp_f32 v19, v19
  v_exp_f32 v20, v20
  global_load_dwordx4 a[64:67], v2, s[78:79] offset:0 sc1
  v_cvt_pk_bf16_f32 v49, v18, v19
  v_exp_f32 v21, v21
  v_exp_f32 v22, v22
  v_cvt_pk_bf16_f32 v50, v20, v21
  v_mfma_f32_32x32x16_bf16 v[32:47], v[140:143], v[132:135], v[112:127]
  v_exp_f32 v23, v23
  v_exp_f32 v24, v24
  v_cvt_pk_bf16_f32 v51, v22, v23
  v_exp_f32 v25, v25
  v_exp_f32 v26, v26
  v_exp_f32 v27, v27
  s_waitcnt lgkmcnt(1)
  v_mfma_f32_32x32x16_bf16 v[64:79], v[152:155], v[48:51], v[64:79]
  v_cvt_pk_bf16_f32 v52, v24, v25
  v_exp_f32 v28, v28
  v_exp_f32 v29, v29
  global_load_dwordx4 a[68:71], v2, s[80:81] offset:0 sc1
  v_cvt_pk_bf16_f32 v53, v26, v27
  v_exp_f32 v30, v30
  v_exp_f32 v31, v31
  v_cvt_pk_bf16_f32 v54, v28, v29
  v_cvt_pk_bf16_f32 v55, v30, v31
  v_exp_f32 v32, v32
  v_exp_f32 v33, v33
  v_exp_f32 v34, v34
  v_cvt_pk_bf16_f32 v56, v32, v33
  v_mfma_f32_32x32x16_bf16 v[64:79], v[156:159], v[52:55], v[64:79]
  v_exp_f32 v35, v35
  v_exp_f32 v36, v36
  global_load_dwordx4 v[196:199], v9, s[30:31] offset:32 sc1
  v_cvt_pk_bf16_f32 v57, v34, v35
  v_exp_f32 v37, v37
  v_exp_f32 v38, v38
  v_cvt_pk_bf16_f32 v58, v36, v37
  s_waitcnt lgkmcnt(0)
  v_mfma_f32_32x32x16_bf16 v[16:31], v[136:139], v[128:131], v[96:111]
  ds_read_b128 v[144:147], v161 offset:2048
  ds_read_b128 v[148:151], v161 offset:2560
  v_exp_f32 v39, v39
  v_exp_f32 v40, v40
  v_cvt_pk_bf16_f32 v59, v38, v39
  v_exp_f32 v41, v41
  v_exp_f32 v42, v42
  v_exp_f32 v43, v43
  v_mfma_f32_32x32x16_bf16 v[80:95], v[152:155], v[56:59], v[80:95]
  v_cvt_pk_bf16_f32 v60, v40, v41
  v_exp_f32 v44, v44
  v_exp_f32 v45, v45
  global_load_dwordx4 a[72:75], v2, s[78:79] offset:1024 sc1
  v_cvt_pk_bf16_f32 v61, v42, v43
  v_exp_f32 v46, v46
  v_exp_f32 v47, v47
  v_cvt_pk_bf16_f32 v62, v44, v45
  v_cvt_pk_bf16_f32 v63, v46, v47
  v_exp_f32 v16, v16
  v_exp_f32 v17, v17
  v_exp_f32 v18, v18
  v_cvt_pk_bf16_f32 v48, v16, v17
  v_mfma_f32_32x32x16_bf16 v[80:95], v[156:159], v[60:63], v[80:95]
  ds_read_b128 v[140:143], v160 offset:19456
  v_exp_f32 v19, v19
  v_exp_f32 v20, v20
  global_load_lds_dwordx4 v2, s[100:101] offset:2048 sc1
  v_cvt_pk_bf16_f32 v49, v18, v19
  v_exp_f32 v21, v21
  v_exp_f32 v22, v22
  v_cvt_pk_bf16_f32 v50, v20, v21
  v_mfma_f32_32x32x16_bf16 v[32:47], v[136:139], v[132:135], v[112:127]
  v_exp_f32 v23, v23
  v_exp_f32 v24, v24
  v_cvt_pk_bf16_f32 v51, v22, v23
  v_exp_f32 v25, v25
  v_exp_f32 v26, v26
  v_exp_f32 v27, v27
  s_waitcnt lgkmcnt(1)
  v_mfma_f32_32x32x16_bf16 v[64:79], v[144:147], v[48:51], v[64:79]
  v_cvt_pk_bf16_f32 v52, v24, v25
  v_exp_f32 v28, v28
  v_exp_f32 v29, v29
  global_load_dwordx4 a[76:79], v2, s[80:81] offset:1024 sc1
  v_cvt_pk_bf16_f32 v53, v26, v27
  v_exp_f32 v30, v30
  v_exp_f32 v31, v31
  v_cvt_pk_bf16_f32 v54, v28, v29
  v_cvt_pk_bf16_f32 v55, v30, v31
  v_exp_f32 v32, v32
  v_exp_f32 v33, v33
  v_exp_f32 v34, v34
  v_cvt_pk_bf16_f32 v56, v32, v33
  v_mfma_f32_32x32x16_bf16 v[64:79], v[148:151], v[52:55], v[64:79]
  v_exp_f32 v35, v35
  v_exp_f32 v36, v36
  global_load_dwordx4 a[80:83], v2, s[78:79] offset:2048 sc1
  v_cvt_pk_bf16_f32 v57, v34, v35
  v_exp_f32 v37, v37
  v_exp_f32 v38, v38
  v_cvt_pk_bf16_f32 v58, v36, v37
  s_waitcnt lgkmcnt(0)
  v_mfma_f32_32x32x16_bf16 v[16:31], v[140:143], v[128:131], v[96:111]
  ds_read_b128 v[152:155], v161 offset:3072
  ds_read_b128 v[156:159], v161 offset:3584
  v_exp_f32 v39, v39
  v_exp_f32 v40, v40
  v_cvt_pk_bf16_f32 v59, v38, v39
  v_exp_f32 v41, v41
  v_exp_f32 v42, v42
  v_exp_f32 v43, v43
  v_mfma_f32_32x32x16_bf16 v[80:95], v[144:147], v[56:59], v[80:95]
  v_cvt_pk_bf16_f32 v60, v40, v41
  v_exp_f32 v44, v44
  v_exp_f32 v45, v45
  global_load_dwordx4 v[200:203], v9, s[30:31] offset:48 sc1
  v_cvt_pk_bf16_f32 v61, v42, v43
  v_exp_f32 v46, v46
  v_exp_f32 v47, v47
  v_cvt_pk_bf16_f32 v62, v44, v45
  v_cvt_pk_bf16_f32 v63, v46, v47
  v_exp_f32 v16, v16
  v_exp_f32 v17, v17
  v_exp_f32 v18, v18
  v_cvt_pk_bf16_f32 v48, v16, v17
  v_mfma_f32_32x32x16_bf16 v[80:95], v[148:151], v[60:63], v[80:95]
  ds_read_b128 v[136:139], v160 offset:20480
  v_exp_f32 v19, v19
  v_exp_f32 v20, v20
  global_load_dwordx4 a[84:87], v2, s[80:81] offset:2048 sc1
  v_cvt_pk_bf16_f32 v49, v18, v19
  v_exp_f32 v21, v21
  v_exp_f32 v22, v22
  v_cvt_pk_bf16_f32 v50, v20, v21
  v_mfma_f32_32x32x16_bf16 v[32:47], v[140:143], v[132:135], v[112:127]
  v_exp_f32 v23, v23
  v_exp_f32 v24, v24
  v_cvt_pk_bf16_f32 v51, v22, v23
  v_exp_f32 v25, v25
  v_exp_f32 v26, v26
  v_exp_f32 v27, v27
  s_waitcnt lgkmcnt(1)
  v_mfma_f32_32x32x16_bf16 v[64:79], v[152:155], v[48:51], v[64:79]
  v_cvt_pk_bf16_f32 v52, v24, v25
  v_exp_f32 v28, v28
  v_exp_f32 v29, v29
  global_load_lds_dwordx4 v2, s[100:101] offset:3072 sc1
  v_cvt_pk_bf16_f32 v53, v26, v27
  v_exp_f32 v30, v30
  v_exp_f32 v31, v31
  v_cvt_pk_bf16_f32 v54, v28, v29
  v_cvt_pk_bf16_f32 v55, v30, v31
  v_exp_f32 v32, v32
  v_exp_f32 v33, v33
  v_exp_f32 v34, v34
  v_cvt_pk_bf16_f32 v56, v32, v33
  v_mfma_f32_32x32x16_bf16 v[64:79], v[156:159], v[52:55], v[64:79]
  v_exp_f32 v35, v35
  v_exp_f32 v36, v36
  global_load_dwordx4 a[88:91], v2, s[78:79] offset:3072 sc1
  v_cvt_pk_bf16_f32 v57, v34, v35
  v_exp_f32 v37, v37
  v_exp_f32 v38, v38
  v_cvt_pk_bf16_f32 v58, v36, v37
  s_waitcnt lgkmcnt(0)
  v_mfma_f32_32x32x16_bf16 v[16:31], v[136:139], v[128:131], v[96:111]
  v_add_u32 v161, v161, v162
  ds_read_b128 v[144:147], v161 offset:0
  ds_read_b128 v[148:151], v161 offset:512
  v_exp_f32 v39, v39
  v_exp_f32 v40, v40
  v_cvt_pk_bf16_f32 v59, v38, v39
  v_exp_f32 v41, v41
  v_exp_f32 v42, v42
  v_exp_f32 v43, v43
  v_mfma_f32_32x32x16_bf16 v[80:95], v[152:155], v[56:59], v[80:95]
  v_cvt_pk_bf16_f32 v60, v40, v41
  v_exp_f32 v44, v44
  v_exp_f32 v45, v45
  global_load_dwordx4 a[92:95], v2, s[80:81] offset:3072 sc1
  s_add_u32 s78, s78, 4096
  s_addc_u32 s79, s79, 0
  s_add_u32 s80, s80, 4096
  s_addc_u32 s81, s81, 0
  v_cvt_pk_bf16_f32 v61, v42, v43
  v_exp_f32 v46, v46
  v_exp_f32 v47, v47
  v_cvt_pk_bf16_f32 v62, v44, v45
  v_cvt_pk_bf16_f32 v63, v46, v47
  v_exp_f32 v16, v16
  v_exp_f32 v17, v17
  v_exp_f32 v18, v18
  v_cvt_pk_bf16_f32 v48, v16, v17
  v_mfma_f32_32x32x16_bf16 v[80:95], v[156:159], v[60:63], v[80:95]
  ds_read_b128 v[140:143], v160 offset:21504
  v_exp_f32 v19, v19
  v_exp_f32 v20, v20
  global_load_dwordx4 a[96:99], v2, s[78:79] offset:0 sc1
  v_cvt_pk_bf16_f32 v49, v18, v19
  v_exp_f32 v21, v21
  v_exp_f32 v22, v22
  v_cvt_pk_bf16_f32 v50, v20, v21
  v_mfma_f32_32x32x16_bf16 v[32:47], v[136:139], v[132:135], v[112:127]
  v_exp_f32 v23, v23
  v_exp_f32 v24, v24
  v_cvt_pk_bf16_f32 v51, v22, v23
  v_exp_f32 v25, v25
  v_exp_f32 v26, v26
  v_exp_f32 v27, v27
  s_waitcnt lgkmcnt(1)
  v_mfma_f32_32x32x16_bf16 v[64:79], v[144:147], v[48:51], v[64:79]
  v_cvt_pk_bf16_f32 v52, v24, v25
  v_exp_f32 v28, v28
  v_exp_f32 v29, v29
  s_add_u32 s100, s100, 4096
  s_addc_u32 s101, s101, 0
  s_add_u32 m0, s76, 4096
  s_nop 0
  global_load_lds_dwordx4 v2, s[100:101] offset:0 sc1
  v_cvt_pk_bf16_f32 v53, v26, v27
  v_exp_f32 v30, v30
  v_exp_f32 v31, v31
  v_cvt_pk_bf16_f32 v54, v28, v29
  v_cvt_pk_bf16_f32 v55, v30, v31
  v_exp_f32 v32, v32
  v_exp_f32 v33, v33
  v_exp_f32 v34, v34
  v_cvt_pk_bf16_f32 v56, v32, v33
  v_mfma_f32_32x32x16_bf16 v[64:79], v[148:151], v[52:55], v[64:79]
  v_exp_f32 v35, v35
  v_exp_f32 v36, v36
  global_load_dwordx4 a[100:103], v2, s[80:81] offset:0 sc1
  v_cvt_pk_bf16_f32 v57, v34, v35
  v_exp_f32 v37, v37
  v_exp_f32 v38, v38
  v_cvt_pk_bf16_f32 v58, v36, v37
  s_waitcnt lgkmcnt(0)
  v_mfma_f32_32x32x16_bf16 v[16:31], v[140:143], v[128:131], v[96:111]
  ds_read_b128 v[152:155], v161 offset:1024
  ds_read_b128 v[156:159], v161 offset:1536
  v_exp_f32 v39, v39
  v_exp_f32 v40, v40
  v_cvt_pk_bf16_f32 v59, v38, v39
  v_exp_f32 v41, v41
  v_exp_f32 v42, v42
  v_exp_f32 v43, v43
  v_mfma_f32_32x32x16_bf16 v[80:95], v[144:147], v[56:59], v[80:95]
  v_cvt_pk_bf16_f32 v60, v40, v41
  v_exp_f32 v44, v44
  v_exp_f32 v45, v45
  global_load_dwordx4 a[104:107], v2, s[78:79] offset:1024 sc1
  v_cvt_pk_bf16_f32 v61, v42, v43
  v_exp_f32 v46, v46
  v_exp_f32 v47, v47
  v_cvt_pk_bf16_f32 v62, v44, v45
  v_cvt_pk_bf16_f32 v63, v46, v47
  v_exp_f32 v16, v16
  v_exp_f32 v17, v17
  v_exp_f32 v18, v18
  v_cvt_pk_bf16_f32 v48, v16, v17
  v_mfma_f32_32x32x16_bf16 v[80:95], v[148:151], v[60:63], v[80:95]
  ds_read_b128 v[136:139], v160 offset:22528
  v_exp_f32 v19, v19
  v_exp_f32 v20, v20
  global_load_dwordx4 a[108:111], v2, s[80:81] offset:1024 sc1
  v_cvt_pk_bf16_f32 v49, v18, v19
  v_exp_f32 v21, v21
  v_exp_f32 v22, v22
  v_cvt_pk_bf16_f32 v50, v20, v21
  v_mfma_f32_32x32x16_bf16 v[32:47], v[140:143], v[132:135], v[112:127]
  v_exp_f32 v23, v23
  v_exp_f32 v24, v24
  v_cvt_pk_bf16_f32 v51, v22, v23
  v_exp_f32 v25, v25
  v_exp_f32 v26, v26
  v_exp_f32 v27, v27
  s_waitcnt lgkmcnt(1)
  v_mfma_f32_32x32x16_bf16 v[64:79], v[152:155], v[48:51], v[64:79]
  v_cvt_pk_bf16_f32 v52, v24, v25
  v_exp_f32 v28, v28
  v_exp_f32 v29, v29
  global_load_lds_dwordx4 v2, s[100:101] offset:1024 sc1
  v_cvt_pk_bf16_f32 v53, v26, v27
  v_exp_f32 v30, v30
  v_exp_f32 v31, v31
  v_cvt_pk_bf16_f32 v54, v28, v29
  v_cvt_pk_bf16_f32 v55, v30, v31
  v_exp_f32 v32, v32
  v_exp_f32 v33, v33
  v_exp_f32 v34, v34
  v_cvt_pk_bf16_f32 v56, v32, v33
  v_mfma_f32_32x32x16_bf16 v[64:79], v[156:159], v[52:55], v[64:79]
  v_exp_f32 v35, v35
  v_exp_f32 v36, v36
  global_load_dwordx4 a[112:115], v2, s[78:79] offset:2048 sc1
  v_cvt_pk_bf16_f32 v57, v34, v35
  v_exp_f32 v37, v37
  v_exp_f32 v38, v38
  v_cvt_pk_bf16_f32 v58, v36, v37
  s_waitcnt lgkmcnt(0)
  v_mfma_f32_32x32x16_bf16 v[16:31], v[136:139], v[128:131], v[96:111]
  ds_read_b128 v[144:147], v161 offset:2048
  ds_read_b128 v[148:151], v161 offset:2560
  v_exp_f32 v39, v39
  v_exp_f32 v40, v40
  v_cvt_pk_bf16_f32 v59, v38, v39
  v_exp_f32 v41, v41
  v_exp_f32 v42, v42
  v_exp_f32 v43, v43
  v_mfma_f32_32x32x16_bf16 v[80:95], v[152:155], v[56:59], v[80:95]
  v_cvt_pk_bf16_f32 v60, v40, v41
  v_exp_f32 v44, v44
  v_exp_f32 v45, v45
  global_load_dwordx4 a[116:119], v2, s[80:81] offset:2048 sc1
  v_cvt_pk_bf16_f32 v61, v42, v43
  v_exp_f32 v46, v46
  v_exp_f32 v47, v47
  v_cvt_pk_bf16_f32 v62, v44, v45
  v_cvt_pk_bf16_f32 v63, v46, v47
  v_exp_f32 v16, v16
  v_exp_f32 v17, v17
  v_exp_f32 v18, v18
  v_cvt_pk_bf16_f32 v48, v16, v17
  v_mfma_f32_32x32x16_bf16 v[80:95], v[156:159], v[60:63], v[80:95]
  ds_read_b128 v[140:143], v160 offset:23552
  v_exp_f32 v19, v19
  v_exp_f32 v20, v20
  global_load_lds_dwordx4 v2, s[100:101] offset:2048 sc1
  v_cvt_pk_bf16_f32 v49, v18, v19
  v_exp_f32 v21, v21
  v_exp_f32 v22, v22
  v_cvt_pk_bf16_f32 v50, v20, v21
  v_mfma_f32_32x32x16_bf16 v[32:47], v[136:139], v[132:135], v[112:127]
  v_exp_f32 v23, v23
  v_exp_f32 v24, v24
  v_cvt_pk_bf16_f32 v51, v22, v23
  v_exp_f32 v25, v25
  v_exp_f32 v26, v26
  v_exp_f32 v27, v27
  s_waitcnt lgkmcnt(1)
  v_mfma_f32_32x32x16_bf16 v[64:79], v[144:147], v[48:51], v[64:79]
  v_cvt_pk_bf16_f32 v52, v24, v25
  v_exp_f32 v28, v28
  v_exp_f32 v29, v29
  global_load_dwordx4 a[120:123], v2, s[78:79] offset:3072 sc1
  v_cvt_pk_bf16_f32 v53, v26, v27
  v_exp_f32 v30, v30
  v_exp_f32 v31, v31
  v_cvt_pk_bf16_f32 v54, v28, v29
  v_cvt_pk_bf16_f32 v55, v30, v31
  v_exp_f32 v32, v32
  v_exp_f32 v33, v33
  v_exp_f32 v34, v34
  v_cvt_pk_bf16_f32 v56, v32, v33
  v_mfma_f32_32x32x16_bf16 v[64:79], v[148:151], v[52:55], v[64:79]
  v_exp_f32 v35, v35
  v_exp_f32 v36, v36
  global_load_dwordx4 a[124:127], v2, s[80:81] offset:3072 sc1
  s_add_u32 s78, s78, 4096
  s_addc_u32 s79, s79, 0
  s_add_u32 s80, s80, 4096
  s_addc_u32 s81, s81, 0
  v_cvt_pk_bf16_f32 v57, v34, v35
  v_exp_f32 v37, v37
  v_exp_f32 v38, v38
  v_cvt_pk_bf16_f32 v58, v36, v37
  s_waitcnt lgkmcnt(0)
  v_mfma_f32_32x32x16_bf16 v[16:31], v[140:143], v[128:131], v[96:111]
  ds_read_b128 v[152:155], v161 offset:3072
  ds_read_b128 v[156:159], v161 offset:3584
  v_exp_f32 v39, v39
  v_exp_f32 v40, v40
  v_cvt_pk_bf16_f32 v59, v38, v39
  v_exp_f32 v41, v41
  v_exp_f32 v42, v42
  v_exp_f32 v43, v43
  v_mfma_f32_32x32x16_bf16 v[80:95], v[144:147], v[56:59], v[80:95]
  v_cvt_pk_bf16_f32 v60, v40, v41
  v_exp_f32 v44, v44
  v_exp_f32 v45, v45
  global_load_dwordx4 a[128:131], v2, s[78:79] offset:0 sc1
  v_cvt_pk_bf16_f32 v61, v42, v43
  v_exp_f32 v46, v46
  v_exp_f32 v47, v47
  v_cvt_pk_bf16_f32 v62, v44, v45
  v_cvt_pk_bf16_f32 v63, v46, v47
  v_exp_f32 v16, v16
  v_exp_f32 v17, v17
  v_exp_f32 v18, v18
  v_cvt_pk_bf16_f32 v48, v16, v17
  v_mfma_f32_32x32x16_bf16 v[80:95], v[148:151], v[60:63], v[80:95]
  ds_read_b128 v[136:139], v160 offset:24576
  v_exp_f32 v19, v19
  v_exp_f32 v20, v20
  global_load_lds_dwordx4 v2, s[100:101] offset:3072 sc1
  v_cvt_pk_bf16_f32 v49, v18, v19
  v_exp_f32 v21, v21
  v_exp_f32 v22, v22
  v_cvt_pk_bf16_f32 v50, v20, v21
  v_mfma_f32_32x32x16_bf16 v[32:47], v[140:143], v[132:135], v[112:127]
  v_exp_f32 v23, v23
  v_exp_f32 v24, v24
  v_cvt_pk_bf16_f32 v51, v22, v23
  v_exp_f32 v25, v25
  v_exp_f32 v26, v26
  v_exp_f32 v27, v27
  s_waitcnt lgkmcnt(1)
  v_mfma_f32_32x32x16_bf16 v[64:79], v[152:155], v[48:51], v[64:79]
  v_cvt_pk_bf16_f32 v52, v24, v25
  v_exp_f32 v28, v28
  v_exp_f32 v29, v29
  global_load_dwordx4 a[132:135], v2, s[80:81] offset:0 sc1
  v_cvt_pk_bf16_f32 v53, v26, v27
  v_exp_f32 v30, v30
  v_exp_f32 v31, v31
  v_cvt_pk_bf16_f32 v54, v28, v29
  v_cvt_pk_bf16_f32 v55, v30, v31
  v_exp_f32 v32, v32
  v_exp_f32 v33, v33
  v_exp_f32 v34, v34
  v_cvt_pk_bf16_f32 v56, v32, v33
  v_mfma_f32_32x32x16_bf16 v[64:79], v[156:159], v[52:55], v[64:79]
  v_exp_f32 v35, v35
  v_exp_f32 v36, v36
  global_load_dwordx4 a[136:139], v2, s[78:79] offset:1024 sc1
  v_cvt_pk_bf16_f32 v57, v34, v35
  v_exp_f32 v37, v37
  v_exp_f32 v38, v38
  v_cvt_pk_bf16_f32 v58, v36, v37
  s_waitcnt lgkmcnt(0)
  v_mfma_f32_32x32x16_bf16 v[16:31], v[136:139], v[128:131], v[96:111]
  v_add_u32 v161, v161, v162
  ds_read_b128 v[144:147], v161 offset:0
  ds_read_b128 v[148:151], v161 offset:512
  v_exp_f32 v39, v39
  v_exp_f32 v40, v40
  v_cvt_pk_bf16_f32 v59, v38, v39
  v_exp_f32 v41, v41
  v_exp_f32 v42, v42
  v_exp_f32 v43, v43
  v_mfma_f32_32x32x16_bf16 v[80:95], v[152:155], v[56:59], v[80:95]
  v_cvt_pk_bf16_f32 v60, v40, v41
  v_exp_f32 v44, v44
  v_exp_f32 v45, v45
  global_load_dwordx4 a[140:143], v2, s[80:81] offset:1024 sc1
  v_cvt_pk_bf16_f32 v61, v42, v43
  v_exp_f32 v46, v46
  v_exp_f32 v47, v47
  v_cvt_pk_bf16_f32 v62, v44, v45
  v_cvt_pk_bf16_f32 v63, v46, v47
  v_exp_f32 v16, v16
  v_exp_f32 v17, v17
  v_exp_f32 v18, v18
  v_cvt_pk_bf16_f32 v48, v16, v17
  v_mfma_f32_32x32x16_bf16 v[80:95], v[156:159], v[60:63], v[80:95]
  ds_read_b128 v[140:143], v160 offset:25600
  v_exp_f32 v19, v19
  v_exp_f32 v20, v20
  global_load_dwordx4 a[144:147], v2, s[78:79] offset:2048 sc1
  v_cvt_pk_bf16_f32 v49, v18, v19
  v_exp_f32 v21, v21
  v_exp_f32 v22, v22
  v_cvt_pk_bf16_f32 v50, v20, v21
  v_mfma_f32_32x32x16_bf16 v[32:47], v[136:139], v[132:135], v[112:127]
  v_exp_f32 v23, v23
  v_exp_f32 v24, v24
  v_cvt_pk_bf16_f32 v51, v22, v23
  v_exp_f32 v25, v25
  v_exp_f32 v26, v26
  v_exp_f32 v27, v27
  s_waitcnt lgkmcnt(1)
  v_mfma_f32_32x32x16_bf16 v[64:79], v[144:147], v[48:51], v[64:79]
  v_cvt_pk_bf16_f32 v52, v24, v25
  v_exp_f32 v28, v28
  v_exp_f32 v29, v29
  global_load_dwordx4 a[148:151], v2, s[80:81] offset:2048 sc1
  v_cvt_pk_bf16_f32 v53, v26, v27
  v_exp_f32 v30, v30
  v_exp_f32 v31, v31
  v_cvt_pk_bf16_f32 v54, v28, v29
  v_cvt_pk_bf16_f32 v55, v30, v31
  v_exp_f32 v32, v32
  v_exp_f32 v33, v33
  v_exp_f32 v34, v34
  v_cvt_pk_bf16_f32 v56, v32, v33
  v_mfma_f32_32x32x16_bf16 v[64:79], v[148:151], v[52:55], v[64:79]
  v_exp_f32 v35, v35
  v_exp_f32 v36, v36
  global_load_dwordx4 a[152:155], v2, s[78:79] offset:3072 sc1
  v_cvt_pk_bf16_f32 v57, v34, v35
  v_exp_f32 v37, v37
  v_exp_f32 v38, v38
  v_cvt_pk_bf16_f32 v58, v36, v37
  s_waitcnt lgkmcnt(0)
  v_mfma_f32_32x32x16_bf16 v[16:31], v[140:143], v[128:131], v[96:111]
  ds_read_b128 v[152:155], v161 offset:1024
  ds_read_b128 v[156:159], v161 offset:1536
  v_exp_f32 v39, v39
  v_exp_f32 v40, v40
  v_cvt_pk_bf16_f32 v59, v38, v39
  v_exp_f32 v41, v41
  v_exp_f32 v42, v42
  v_exp_f32 v43, v43
  v_mfma_f32_32x32x16_bf16 v[80:95], v[144:147], v[56:59], v[80:95]
  v_cvt_pk_bf16_f32 v60, v40, v41
  v_exp_f32 v44, v44
  v_exp_f32 v45, v45
  global_load_dwordx4 a[156:159], v2, s[80:81] offset:3072 sc1
  s_add_u32 s78, s78, 4096
  s_addc_u32 s79, s79, 0
  s_add_u32 s80, s80, 4096
  s_addc_u32 s81, s81, 0
  v_cvt_pk_bf16_f32 v61, v42, v43
  v_exp_f32 v46, v46
  v_exp_f32 v47, v47
  v_cvt_pk_bf16_f32 v62, v44, v45
  v_cvt_pk_bf16_f32 v63, v46, v47
  v_exp_f32 v16, v16
  v_exp_f32 v17, v17
  v_exp_f32 v18, v18
  v_cvt_pk_bf16_f32 v48, v16, v17
  v_mfma_f32_32x32x16_bf16 v[80:95], v[148:151], v[60:63], v[80:95]
  ds_read_b128 v[136:139], v160 offset:26624
  v_exp_f32 v19, v19
  v_exp_f32 v20, v20
  global_load_dwordx4 a[160:163], v2, s[78:79] offset:0 sc1
  v_cvt_pk_bf16_f32 v49, v18, v19
  v_exp_f32 v21, v21
  v_exp_f32 v22, v22
  v_cvt_pk_bf16_f32 v50, v20, v21
  v_mfma_f32_32x32x16_bf16 v[32:47], v[140:143], v[132:135], v[112:127]
  v_exp_f32 v23, v23
  v_exp_f32 v24, v24
  v_cvt_pk_bf16_f32 v51, v22, v23
  v_exp_f32 v25, v25
  v_exp_f32 v26, v26
  v_exp_f32 v27, v27
  s_waitcnt lgkmcnt(1)
  v_mfma_f32_32x32x16_bf16 v[64:79], v[152:155], v[48:51], v[64:79]
  v_cvt_pk_bf16_f32 v52, v24, v25
  v_exp_f32 v28, v28
  v_exp_f32 v29, v29
  global_load_dwordx4 a[164:167], v2, s[80:81] offset:0 sc1
  v_cvt_pk_bf16_f32 v53, v26, v27
  v_exp_f32 v30, v30
  v_exp_f32 v31, v31
  v_cvt_pk_bf16_f32 v54, v28, v29
  v_cvt_pk_bf16_f32 v55, v30, v31
  v_exp_f32 v32, v32
  v_exp_f32 v33, v33
  v_exp_f32 v34, v34
  v_cvt_pk_bf16_f32 v56, v32, v33
  v_mfma_f32_32x32x16_bf16 v[64:79], v[156:159], v[52:55], v[64:79]
  v_exp_f32 v35, v35
  v_exp_f32 v36, v36
  global_load_dwordx4 a[168:171], v2, s[78:79] offset:1024 sc1
  v_cvt_pk_bf16_f32 v57, v34, v35
  v_exp_f32 v37, v37
  v_exp_f32 v38, v38
  v_cvt_pk_bf16_f32 v58, v36, v37
  s_waitcnt lgkmcnt(0)
  v_mfma_f32_32x32x16_bf16 v[16:31], v[136:139], v[128:131], v[96:111]
  ds_read_b128 v[144:147], v161 offset:2048
  ds_read_b128 v[148:151], v161 offset:2560
  v_exp_f32 v39, v39
  v_exp_f32 v40, v40
  v_cvt_pk_bf16_f32 v59, v38, v39
  v_exp_f32 v41, v41
  v_exp_f32 v42, v42
  v_exp_f32 v43, v43
  v_mfma_f32_32x32x16_bf16 v[80:95], v[152:155], v[56:59], v[80:95]
  v_cvt_pk_bf16_f32 v60, v40, v41
  v_exp_f32 v44, v44
  v_exp_f32 v45, v45
  global_load_dwordx4 a[172:175], v2, s[80:81] offset:1024 sc1
  v_cvt_pk_bf16_f32 v61, v42, v43
  v_exp_f32 v46, v46
  v_exp_f32 v47, v47
  v_cvt_pk_bf16_f32 v62, v44, v45
  v_cvt_pk_bf16_f32 v63, v46, v47
  v_exp_f32 v16, v16
  v_exp_f32 v17, v17
  v_exp_f32 v18, v18
  v_cvt_pk_bf16_f32 v48, v16, v17
  v_mfma_f32_32x32x16_bf16 v[80:95], v[156:159], v[60:63], v[80:95]
  ds_read_b128 v[140:143], v160 offset:27648
  v_exp_f32 v19, v19
  v_exp_f32 v20, v20
  global_load_dwordx4 a[176:179], v2, s[78:79] offset:2048 sc1
  v_cvt_pk_bf16_f32 v49, v18, v19
  v_exp_f32 v21, v21
  v_exp_f32 v22, v22
  v_cvt_pk_bf16_f32 v50, v20, v21
  v_mfma_f32_32x32x16_bf16 v[32:47], v[136:139], v[132:135], v[112:127]
  v_exp_f32 v23, v23
  v_exp_f32 v24, v24
  v_cvt_pk_bf16_f32 v51, v22, v23
  v_exp_f32 v25, v25
  v_exp_f32 v26, v26
  v_exp_f32 v27, v27
  s_waitcnt lgkmcnt(1)
  v_mfma_f32_32x32x16_bf16 v[64:79], v[144:147], v[48:51], v[64:79]
  v_cvt_pk_bf16_f32 v52, v24, v25
  v_exp_f32 v28, v28
  v_exp_f32 v29, v29
  global_load_dwordx4 a[180:183], v2, s[80:81] offset:2048 sc1
  v_cvt_pk_bf16_f32 v53, v26, v27
  v_exp_f32 v30, v30
  v_exp_f32 v31, v31
  v_cvt_pk_bf16_f32 v54, v28, v29
  v_cvt_pk_bf16_f32 v55, v30, v31
  v_exp_f32 v32, v32
  v_exp_f32 v33, v33
  v_exp_f32 v34, v34
  v_cvt_pk_bf16_f32 v56, v32, v33
  v_mfma_f32_32x32x16_bf16 v[64:79], v[148:151], v[52:55], v[64:79]
  v_exp_f32 v35, v35
  v_exp_f32 v36, v36
  global_load_dwordx4 a[184:187], v2, s[78:79] offset:3072 sc1
  v_cvt_pk_bf16_f32 v57, v34, v35
  v_exp_f32 v37, v37
  v_exp_f32 v38, v38
  v_cvt_pk_bf16_f32 v58, v36, v37
  s_waitcnt lgkmcnt(0)
  v_mfma_f32_32x32x16_bf16 v[16:31], v[140:143], v[128:131], v[96:111]
  ds_read_b128 v[152:155], v161 offset:3072
  ds_read_b128 v[156:159], v161 offset:3584
  v_exp_f32 v39, v39
  v_exp_f32 v40, v40
  v_cvt_pk_bf16_f32 v59, v38, v39
  v_exp_f32 v41, v41
  v_exp_f32 v42, v42
  v_exp_f32 v43, v43
  v_mfma_f32_32x32x16_bf16 v[80:95], v[144:147], v[56:59], v[80:95]
  v_cvt_pk_bf16_f32 v60, v40, v41
  v_exp_f32 v44, v44
  v_exp_f32 v45, v45
  global_load_dwordx4 a[188:191], v2, s[80:81] offset:3072 sc1
  s_add_u32 s78, s78, 4096
  s_addc_u32 s79, s79, 0
  s_add_u32 s80, s80, 4096
  s_addc_u32 s81, s81, 0
  v_cvt_pk_bf16_f32 v61, v42, v43
  v_exp_f32 v46, v46
  v_exp_f32 v47, v47
  v_cvt_pk_bf16_f32 v62, v44, v45
  v_cvt_pk_bf16_f32 v63, v46, v47
  v_exp_f32 v16, v16
  v_exp_f32 v17, v17
  v_exp_f32 v18, v18
  v_cvt_pk_bf16_f32 v48, v16, v17
  v_mfma_f32_32x32x16_bf16 v[80:95], v[148:151], v[60:63], v[80:95]
  v_exp_f32 v19, v19
  v_exp_f32 v20, v20
  v_lshlrev_b32 v236, 7, v1
  v_add_u32 v236, 12288, v236
  s_mov_b64 exec, 0xff
  global_load_dword v237, v236, s[30:31] sc1
  s_mov_b64 exec, -1
  v_cvt_pk_bf16_f32 v49, v18, v19
  v_exp_f32 v21, v21
  v_exp_f32 v22, v22
  v_cvt_pk_bf16_f32 v50, v20, v21
  v_mfma_f32_32x32x16_bf16 v[32:47], v[140:143], v[132:135], v[112:127]
  v_exp_f32 v23, v23
  v_exp_f32 v24, v24
  v_cvt_pk_bf16_f32 v51, v22, v23
  v_exp_f32 v25, v25
  v_exp_f32 v26, v26
  v_exp_f32 v27, v27
  s_waitcnt lgkmcnt(0)
  v_mfma_f32_32x32x16_bf16 v[64:79], v[152:155], v[48:51], v[64:79]
  v_cvt_pk_bf16_f32 v52, v24, v25
  v_exp_f32 v28, v28
  v_exp_f32 v29, v29
  v_cvt_pk_bf16_f32 v53, v26, v27
  v_exp_f32 v30, v30
  v_exp_f32 v31, v31
  v_cvt_pk_bf16_f32 v54, v28, v29
  v_cvt_pk_bf16_f32 v55, v30, v31
  v_exp_f32 v32, v32
  v_exp_f32 v33, v33
  v_exp_f32 v34, v34
  v_cvt_pk_bf16_f32 v56, v32, v33
  v_mfma_f32_32x32x16_bf16 v[64:79], v[156:159], v[52:55], v[64:79]
  v_exp_f32 v35, v35
  v_exp_f32 v36, v36
  v_cvt_pk_bf16_f32 v57, v34, v35
  v_exp_f32 v37, v37
  v_exp_f32 v38, v38
  v_cvt_pk_bf16_f32 v58, v36, v37
  v_exp_f32 v39, v39
  v_exp_f32 v40, v40
  v_cvt_pk_bf16_f32 v59, v38, v39
  v_exp_f32 v41, v41
  v_exp_f32 v42, v42
  v_exp_f32 v43, v43
  v_mfma_f32_32x32x16_bf16 v[80:95], v[152:155], v[56:59], v[80:95]
  v_cvt_pk_bf16_f32 v60, v40, v41
  v_exp_f32 v44, v44
  v_exp_f32 v45, v45
  v_cvt_pk_bf16_f32 v61, v42, v43
  v_exp_f32 v46, v46
  v_exp_f32 v47, v47
  v_cvt_pk_bf16_f32 v62, v44, v45
  v_cvt_pk_bf16_f32 v63, v46, v47
  s_nop 1
  v_mfma_f32_32x32x16_bf16 v[80:95], v[156:159], v[60:63], v[80:95]
  s_branch L_attfin_44
L_slow_43:
  s_waitcnt lgkmcnt(0)
  s_mov_b32 m0, s77
  s_nop 0
  global_load_lds_dwordx4 v202, s[98:99] sc1
  s_add_u32 m0, s77, 65536
  s_nop 0
  global_load_lds_dwordx4 v202, s[100:101] sc1
  s_add_u32 s77, s77, 4096
  v_add_u32 v202, 4096, v202
  s_mov_b32 m0, s77
  s_nop 0
  global_load_lds_dwordx4 v202, s[98:99] sc1
  s_add_u32 m0, s77, 65536
  s_nop 0
  global_load_lds_dwordx4 v202, s[100:101] sc1
  s_add_u32 s77, s77, 4096
  v_add_u32 v202, 4096, v202
  s_mov_b32 m0, s77
  s_nop 0
  global_load_lds_dwordx4 v202, s[98:99] sc1
  s_add_u32 m0, s77, 65536
  s_nop 0
  global_load_lds_dwordx4 v202, s[100:101] sc1
  s_add_u32 s77, s77, 4096
  v_add_u32 v202, 4096, v202
  s_mov_b32 m0, s77
  s_nop 0
  global_load_lds_dwordx4 v202, s[98:99] sc1
  s_add_u32 m0, s77, 65536
  s_nop 0
  global_load_lds_dwordx4 v202, s[100:101] sc1
  s_add_u32 s77, s77, 4096
  v_add_u32 v202, 4096, v202
  s_mov_b32 m0, s77
  s_nop 0
  global_load_lds_dwordx4 v202, s[98:99] sc1
  s_add_u32 m0, s77, 65536
  s_nop 0
  global_load_lds_dwordx4 v202, s[100:101] sc1
  s_add_u32 s77, s77, 4096
  v_add_u32 v202, 4096, v202
  s_mov_b32 m0, s77
  s_nop 0
  global_load_lds_dwordx4 v202, s[98:99] sc1
  s_add_u32 m0, s77, 65536
  s_nop 0
  global_load_lds_dwordx4 v202, s[100:101] sc1
  s_add_u32 s77, s77, 4096
  v_add_u32 v202, 4096, v202
  s_mov_b32 m0, s77
  s_nop 0
  global_load_lds_dwordx4 v202, s[98:99] sc1
  s_add_u32 m0, s77, 65536
  s_nop 0
  global_load_lds_dwordx4 v202, s[100:101] sc1
  s_add_u32 s77, s77, 4096
  v_add_u32 v202, 4096, v202
  s_mov_b32 m0, s77
  s_nop 0
  global_load_lds_dwordx4 v202, s[98:99] sc1
  s_add_u32 m0, s77, 65536
  s_nop 0
  global_load_lds_dwordx4 v202, s[100:101] sc1
  s_add_u32 s77, s77, 4096
  v_add_u32 v202, 4096, v202
  s_mov_b32 m0, s77
  s_nop 0
  global_load_lds_dwordx4 v202, s[98:99] sc1
  s_add_u32 m0, s77, 65536
  s_nop 0
  global_load_lds_dwordx4 v202, s[100:101] sc1
  s_add_u32 s77, s77, 4096
  v_add_u32 v202, 4096, v202
  s_mov_b32 m0, s77
  s_nop 0
  global_load_lds_dwordx4 v202, s[98:99] sc1
  s_add_u32 m0, s77, 65536
  s_nop 0
  global_load_lds_dwordx4 v202, s[100:101] sc1
  s_add_u32 s77, s77, 4096
  v_add_u32 v202, 4096, v202
  s_mov_b32 m0, s77
  s_nop 0
  global_load_lds_dwordx4 v202, s[98:99] sc1
  s_add_u32 m0, s77, 65536
  s_nop 0
  global_load_lds_dwordx4 v202, s[100:101] sc1
  s_add_u32 s77, s77, 4096
  v_add_u32 v202, 4096, v202
  s_mov_b32 m0, s77
  s_nop 0
  global_load_lds_dwordx4 v202, s[98:99] sc1
  s_add_u32 m0, s77, 65536
  s_nop 0
  global_load_lds_dwordx4 v202, s[100:101] sc1
  s_add_u32 s77, s77, 4096
  v_add_u32 v202, 4096, v202
  s_add_u32 m0, s50, 0
  s_nop 0
  global_load_lds_dwordx4 v164, s[52:53]
  s_lshl_b32 s40, s51, 5
  s_sub_u32 s40, 1120, s40
  s_add_u32 m0, s50, s40
  s_nop 0
  global_load_lds_dwordx4 v164, s[54:55]
  s_add_u32 m0, s50, 2176
  s_nop 0
  global_load_lds_dwordx4 v164, s[56:57]
  s_lshl_b32 s40, s51, 5
  s_sub_u32 s40, 3296, s40
  s_add_u32 m0, s50, s40
  s_nop 0
  global_load_lds_dwordx4 v164, s[58:59]
  s_add_u32 m0, s50, 4352
  s_nop 0
  global_load_lds_dwordx4 v165, s[60:61]
  s_add_u32 m0, s50, 5440
  s_nop 0
  global_load_lds_dwordx4 v165, s[62:63]
  s_waitcnt vmcnt(0)
  s_barrier
  s_cmp_eq_u32 s51, 0
  s_cselect_b32 s40, 0, 0
  v_add_u32 v167, s40, v166
  ds_read_b64_tr_b16 v[176:177], v167
  ds_read_b64_tr_b16 v[178:179], v167 offset:512
  s_cmp_eq_u32 s51, 0
  s_cselect_b32 s40, 32, 1088
  v_add_u32 v167, s40, v166
  ds_read_b64_tr_b16 v[180:181], v167
  ds_read_b64_tr_b16 v[182:183], v167 offset:512
  s_cmp_eq_u32 s51, 0
  s_cselect_b32 s40, 2176, 2176
  v_add_u32 v167, s40, v166
  ds_read_b64_tr_b16 v[184:185], v167
  ds_read_b64_tr_b16 v[186:187], v167 offset:512
  s_cmp_eq_u32 s51, 0
  s_mov_b32 s41, 3264
  s_cselect_b32 s40, 2208, s41
  v_add_u32 v167, s40, v166
  ds_read_b64_tr_b16 v[188:189], v167
  ds_read_b64_tr_b16 v[190:191], v167 offset:512
  ds_read_b64_tr_b16 v[192:193], v200 offset:4352
  ds_read_b64_tr_b16 v[194:195], v200 offset:4864
  ds_read_b64_tr_b16 v[196:197], v200 offset:5440
  ds_read_b64_tr_b16 v[198:199], v200 offset:5952
  s_waitcnt lgkmcnt(0)
  v_add_u32 v201, s44, v2
  global_store_dwordx4 v201, v[176:179], s[30:31] sc1
  v_add_u32 v201, s45, v2
  global_store_dwordx4 v201, v[180:183], s[30:31] sc1
  v_add_u32 v201, s46, v2
  global_store_dwordx4 v201, v[184:187], s[30:31] sc1
  v_add_u32 v201, s47, v2
  global_store_dwordx4 v201, v[188:191], s[30:31] sc1
  v_add_u32 v201, s48, v2
  global_store_dwordx4 v201, v[192:195], s[30:31] sc1
  v_add_u32 v201, s49, v2
  global_store_dwordx4 v201, v[196:199], s[30:31] sc1
  s_waitcnt vmcnt(0)
  s_barrier
  s_cmp_lg_u32 s32, 0
  s_cbranch_scc1 L_arr_58
  s_lshl_b32 s40, s33, 7
  s_add_u32 s40, s40, 4096
  v_mov_b32 v8, s40
  v_mov_b32 v9, 1
  s_mov_b64 exec, 1
  global_atomic_add v8, v9, s[30:31] sc1
  s_mov_b64 exec, -1
L_arr_58:
  s_cmp_lg_u32 s32, 0
  s_cbranch_scc1 L_s0bw_59
  s_sub_u32 s40, s36, 5
  s_cmp_gt_u32 s40, 1
  s_cbranch_scc1 L_s0b_60
  s_mov_b32 s40, 128
  v_mov_b32 v8, s40
  v_mov_b32 v9, 1
  s_mov_b64 exec, 1
  global_atomic_add v8, v9, s[28:29] sc1
  s_mov_b64 exec, -1
L_s0b_60:
L_s0bw_59:
  v_mov_b32 v163, 0xff800000
  v_mov_b32 v201, 0xff800000
  s_mov_b32 s94, 0
L_slowloop_61:
  ds_read_b128 v[136:139], v160
  ds_read_b128 v[144:147], v161
  ds_read_b128 v[148:151], v161 offset:512
  s_waitcnt lgkmcnt(0)
  v_mfma_f32_32x32x16_bf16 v[16:31], v[136:139], v[128:131], 0
  v_mfma_f32_32x32x16_bf16 v[32:47], v[136:139], v[132:135], 0
  s_nop 11
  v_max3_f32 v8, v16, v17, v18
  v_max3_f32 v8, v8, v19, v20
  v_max3_f32 v8, v8, v21, v22
  v_max3_f32 v8, v8, v23, v24
  v_max3_f32 v8, v8, v25, v26
  v_max3_f32 v8, v8, v27, v28
  v_max3_f32 v8, v8, v29, v30
  v_max_f32 v8, v8, v31
  v_mov_b32 v9, v8
  s_nop 1
  v_permlane32_swap_b32 v8, v9
  v_max_f32 v8, v8, v9
  v_max_f32 v8, v8, v163
  v_sub_f32 v9, v163, v8
  v_exp_f32 v9, v9
  v_mov_b32 v163, v8
  v_sub_f32 v16, v16, v8
  v_sub_f32 v17, v17, v8
  v_sub_f32 v18, v18, v8
  v_sub_f32 v19, v19, v8
  v_sub_f32 v20, v20, v8
  v_sub_f32 v21, v21, v8
  v_sub_f32 v22, v22, v8
  v_sub_f32 v23, v23, v8
  v_sub_f32 v24, v24, v8
  v_sub_f32 v25, v25, v8
  v_sub_f32 v26, v26, v8
  v_sub_f32 v27, v27, v8
  v_sub_f32 v28, v28, v8
  v_sub_f32 v29, v29, v8
  v_sub_f32 v30, v30, v8
  v_sub_f32 v31, v31, v8
  v_exp_f32 v16, v16
  v_exp_f32 v17, v17
  v_exp_f32 v18, v18
  v_exp_f32 v19, v19
  v_exp_f32 v20, v20
  v_exp_f32 v21, v21
  v_exp_f32 v22, v22
  v_exp_f32 v23, v23
  v_exp_f32 v24, v24
  v_exp_f32 v25, v25
  v_exp_f32 v26, v26
  v_exp_f32 v27, v27
  v_exp_f32 v28, v28
  v_exp_f32 v29, v29
  v_exp_f32 v30, v30
  v_exp_f32 v31, v31
  v_mul_f32 v64, v64, v9
  v_mul_f32 v65, v65, v9
  v_mul_f32 v66, v66, v9
  v_mul_f32 v67, v67, v9
  v_mul_f32 v68, v68, v9
  v_mul_f32 v69, v69, v9
  v_mul_f32 v70, v70, v9
  v_mul_f32 v71, v71, v9
  v_mul_f32 v72, v72, v9
  v_mul_f32 v73, v73, v9
  v_mul_f32 v74, v74, v9
  v_mul_f32 v75, v75, v9
  v_mul_f32 v76, v76, v9
  v_mul_f32 v77, v77, v9
  v_mul_f32 v78, v78, v9
  v_mul_f32 v79, v79, v9
  v_cvt_pk_bf16_f32 v48, v16, v17
  v_cvt_pk_bf16_f32 v49, v18, v19
  v_cvt_pk_bf16_f32 v50, v20, v21
  v_cvt_pk_bf16_f32 v51, v22, v23
  v_cvt_pk_bf16_f32 v52, v24, v25
  v_cvt_pk_bf16_f32 v53, v26, v27
  v_cvt_pk_bf16_f32 v54, v28, v29
  v_cvt_pk_bf16_f32 v55, v30, v31
  s_nop 1
  v_mfma_f32_32x32x16_bf16 v[64:79], v[144:147], v[48:51], v[64:79]
  v_mfma_f32_32x32x16_bf16 v[64:79], v[148:151], v[52:55], v[64:79]
  v_max3_f32 v8, v32, v33, v34
  v_max3_f32 v8, v8, v35, v36
  v_max3_f32 v8, v8, v37, v38
  v_max3_f32 v8, v8, v39, v40
  v_max3_f32 v8, v8, v41, v42
  v_max3_f32 v8, v8, v43, v44
  v_max3_f32 v8, v8, v45, v46
  v_max_f32 v8, v8, v47
  v_mov_b32 v9, v8
  s_nop 1
  v_permlane32_swap_b32 v8, v9
  v_max_f32 v8, v8, v9
  v_max_f32 v8, v8, v201
  v_sub_f32 v9, v201, v8
  v_exp_f32 v9, v9
  v_mov_b32 v201, v8
  v_sub_f32 v32, v32, v8
  v_sub_f32 v33, v33, v8
  v_sub_f32 v34, v34, v8
  v_sub_f32 v35, v35, v8
  v_sub_f32 v36, v36, v8
  v_sub_f32 v37, v37, v8
  v_sub_f32 v38, v38, v8
  v_sub_f32 v39, v39, v8
  v_sub_f32 v40, v40, v8
  v_sub_f32 v41, v41, v8
  v_sub_f32 v42, v42, v8
  v_sub_f32 v43, v43, v8
  v_sub_f32 v44, v44, v8
  v_sub_f32 v45, v45, v8
  v_sub_f32 v46, v46, v8
  v_sub_f32 v47, v47, v8
  v_exp_f32 v32, v32
  v_exp_f32 v33, v33
  v_exp_f32 v34, v34
  v_exp_f32 v35, v35
  v_exp_f32 v36, v36
  v_exp_f32 v37, v37
  v_exp_f32 v38, v38
  v_exp_f32 v39, v39
  v_exp_f32 v40, v40
  v_exp_f32 v41, v41
  v_exp_f32 v42, v42
  v_exp_f32 v43, v43
  v_exp_f32 v44, v44
  v_exp_f32 v45, v45
  v_exp_f32 v46, v46
  v_exp_f32 v47, v47
  v_mul_f32 v80, v80, v9
  v_mul_f32 v81, v81, v9
  v_mul_f32 v82, v82, v9
  v_mul_f32 v83, v83, v9
  v_mul_f32 v84, v84, v9
  v_mul_f32 v85, v85, v9
  v_mul_f32 v86, v86, v9
  v_mul_f32 v87, v87, v9
  v_mul_f32 v88, v88, v9
  v_mul_f32 v89, v89, v9
  v_mul_f32 v90, v90, v9
  v_mul_f32 v91, v91, v9
  v_mul_f32 v92, v92, v9
  v_mul_f32 v93, v93, v9
  v_mul_f32 v94, v94, v9
  v_mul_f32 v95, v95, v9
  v_cvt_pk_bf16_f32 v56, v32, v33
  v_cvt_pk_bf16_f32 v57, v34, v35
  v_cvt_pk_bf16_f32 v58, v36, v37
  v_cvt_pk_bf16_f32 v59, v38, v39
  v_cvt_pk_bf16_f32 v60, v40, v41
  v_cvt_pk_bf16_f32 v61, v42, v43
  v_cvt_pk_bf16_f32 v62, v44, v45
  v_cvt_pk_bf16_f32 v63, v46, v47
  s_nop 1
  v_mfma_f32_32x32x16_bf16 v[80:95], v[144:147], v[56:59], v[80:95]
  v_mfma_f32_32x32x16_bf16 v[80:95], v[148:151], v[60:63], v[80:95]
  v_add_u32 v160, 1024, v160
  v_add_u32 v161, v161, v162
  s_add_u32 s94, s94, 1
  s_cmp_lt_u32 s94, 64
  s_nop 7
  s_cbranch_scc1 L_slowloop_61
  v_lshlrev_b32 v236, 7, v1
  v_add_u32 v236, 4096, v236
  s_mov_b64 exec, 255
  global_load_dword v237, v236, s[30:31] sc1
  s_mov_b64 exec, -1
  v_lshlrev_b32 v238, 7, v1
  v_add_u32 v238, 128, v238
  s_mov_b64 exec, 1
  global_load_dword v239, v238, s[28:29] sc1
  s_mov_b64 exec, -1
  s_mov_b64 exec, 255
  s_mov_b32 s92, 0
  s_branch L_pchk_65
L_poll_62:
  global_load_dword v237, v236, s[30:31] sc1
L_pchk_65:
  s_add_u32 s92, s92, 1
  s_cmp_gt_u32 s92, 200000
  s_cbranch_scc1 L_ptm_64
  s_waitcnt vmcnt(0)
  v_cmp_gt_u32 vcc, 32, v237
  s_cbranch_vccnz L_poll_62
  s_branch L_pok_63
L_ptm_64:
  s_waitcnt vmcnt(0)
  v_mov_b32 v236, 32
  v_mov_b32 v237, 3
  s_mov_b64 exec, 1
  global_store_dword v236, v237, s[28:29]
L_pok_63:
  s_mov_b64 exec, -1
  s_mov_b64 exec, 1
  s_mov_b32 s92, 0
  s_branch L_pchk_69
L_poll_66:
  global_load_dword v239, v238, s[28:29] sc1
L_pchk_69:
  s_add_u32 s92, s92, 1
  s_cmp_gt_u32 s92, 200000
  s_cbranch_scc1 L_ptm_68
  s_waitcnt vmcnt(0)
  v_cmp_gt_u32 vcc, 64, v239
  s_cbranch_vccnz L_poll_66
  s_branch L_pok_67
L_ptm_68:
  s_waitcnt vmcnt(0)
  v_mov_b32 v238, 32
  v_mov_b32 v239, 4
  s_mov_b64 exec, 1
  global_store_dword v238, v239, s[28:29]
L_pok_67:
  s_mov_b64 exec, -1
  s_lshl_b32 s39, s2, 2
  s_add_u32 s39, s39, s32
  s_cmp_ge_u32 s39, 896
  s_cbranch_scc1 L_uvi_70
  s_lshl_b32 s40, s39, 12
  s_add_u32 s40, s40, 7340032
  v_add_u32 v8, s40, v2
  global_load_dwordx4 v[164:167], v8, s[30:31] offset:0 sc1
  global_load_dwordx4 v[168:171], v8, s[30:31] offset:1024 sc1
  global_load_dwordx4 v[172:175], v8, s[30:31] offset:2048 sc1
  global_load_dwordx4 v[176:179], v8, s[30:31] offset:3072 sc1
  v_mov_b32 v180, 0
  v_mov_b32 v181, 0
  v_mov_b32 v182, 0
  v_mov_b32 v183, 0
  v_mov_b32 v184, 0
  v_mov_b32 v185, 0
  v_mov_b32 v186, 0
  v_mov_b32 v187, 0
  v_mov_b32 v188, 0
  v_mov_b32 v189, 0
  v_mov_b32 v190, 0
  v_mov_b32 v191, 0
  v_mov_b32 v192, 0
  v_mov_b32 v193, 0
  v_mov_b32 v194, 0
  v_mov_b32 v195, 0
  s_and_b32 s40, s39, 7
  s_lshl_b32 s40, s40, 7
  s_add_u32 s40, s40, 50176
  v_lshrrev_b32 v9, 5, v1
  v_lshlrev_b32 v9, 4, v9
  v_and_b32 v10, 1, v1
  v_lshl_add_u32 v9, v10, 10, v9
  v_add_u32 v9, s40, v9
  s_mov_b32 s42, 3
  s_mov_b32 s43, 3
  s_mov_b64 exec, s[42:43]
  global_load_dwordx4 v[180:183], v9, s[30:31] offset:0 sc1
  global_load_dwordx4 v[184:187], v9, s[30:31] offset:32 sc1
  global_load_dwordx4 v[188:191], v9, s[30:31] offset:64 sc1
  global_load_dwordx4 v[192:195], v9, s[30:31] offset:96 sc1
  s_mov_b64 exec, -1
L_uvi_70:
  s_cmp_ge_u32 s39, 896
  s_cbranch_scc1 L_uvc_71
  s_waitcnt vmcnt(0)
  v_mfma_f32_32x32x16_bf16 v[212:227], v[164:167], v[180:183], 0
  v_mfma_f32_32x32x16_bf16 v[212:227], v[168:171], v[184:187], v[212:227]
  v_mfma_f32_32x32x16_bf16 v[212:227], v[172:175], v[188:191], v[212:227]
  v_mfma_f32_32x32x16_bf16 v[212:227], v[176:179], v[192:195], v[212:227]
  s_lshl_b32 s40, s39, 8
  s_add_u32 s40, s40, 18874368
  v_and_b32 v9, 1, v1
  v_lshlrev_b32 v9, 7, v9
  v_lshrrev_b32 v10, 5, v1
  v_lshl_add_u32 v9, v10, 6, v9
  v_add_u32 v9, s40, v9
  s_mov_b32 s42, 3
  s_mov_b32 s43, 3
  s_nop 7
  s_mov_b64 exec, s[42:43]
  global_store_dwordx4 v9, v[212:215], s[30:31] offset:0 sc1
  global_store_dwordx4 v9, v[216:219], s[30:31] offset:16 sc1
  global_store_dwordx4 v9, v[220:223], s[30:31] offset:32 sc1
  global_store_dwordx4 v9, v[224:227], s[30:31] offset:48 sc1
  s_mov_b64 exec, -1
L_uvc_71:
  s_waitcnt vmcnt(0)
  s_barrier
  s_cmp_lg_u32 s32, 0
  s_cbranch_scc1 L_arr_72
  s_lshl_b32 s40, s33, 7
  s_add_u32 s40, s40, 12288
  v_mov_b32 v10, s40
  v_mov_b32 v11, 1
  s_mov_b64 exec, 1
  global_atomic_add v10, v11, s[30:31] sc1
  s_mov_b64 exec, -1
L_arr_72:
  v_lshlrev_b32 v236, 7, v1
  v_add_u32 v236, 12288, v236
  s_mov_b64 exec, 255
  global_load_dword v237, v236, s[30:31] sc1
  s_mov_b64 exec, -1
  s_lshl_b32 s40, s36, 6
  s_lshl_b32 s41, s32, 3
  s_add_u32 s40, s40, s41
  s_lshl_b32 s40, s40, 10
  s_add_u32 s40, s40, 524288
  s_add_u32 s78, s30, s40
  s_addc_u32 s79, s31, 0
  global_load_dwordx4 a[192:195], v2, s[78:79] offset:0 sc1
  global_load_dwordx4 a[196:199], v2, s[78:79] offset:1024 sc1
  global_load_dwordx4 a[200:203], v2, s[78:79] offset:2048 sc1
  global_load_dwordx4 a[204:207], v2, s[78:79] offset:3072 sc1
  s_add_u32 s78, s78, 4096
  s_addc_u32 s79, s79, 0
  global_load_dwordx4 a[208:211], v2, s[78:79] offset:0 sc1
  global_load_dwordx4 a[212:215], v2, s[78:79] offset:1024 sc1
  global_load_dwordx4 a[216:219], v2, s[78:79] offset:2048 sc1
  global_load_dwordx4 a[220:223], v2, s[78:79] offset:3072 sc1
  s_add_u32 s78, s78, 28672
  s_addc_u32 s79, s79, 0
  global_load_dwordx4 a[224:227], v2, s[78:79] offset:0 sc1
  global_load_dwordx4 a[228:231], v2, s[78:79] offset:1024 sc1
  global_load_dwordx4 a[232:235], v2, s[78:79] offset:2048 sc1
  global_load_dwordx4 a[236:239], v2, s[78:79] offset:3072 sc1
  s_add_u32 s78, s78, 4096
  s_addc_u32 s79, s79, 0
  global_load_dwordx4 a[240:243], v2, s[78:79] offset:0 sc1
  global_load_dwordx4 a[244:247], v2, s[78:79] offset:1024 sc1
  global_load_dwordx4 a[248:251], v2, s[78:79] offset:2048 sc1
  global_load_dwordx4 a[252:255], v2, s[78:79] offset:3072 sc1
  v_lshrrev_b32 v8, 2, v0
  s_lshl_b32 s40, s35, 6
  v_add_u32 v8, s40, v8
  v_lshlrev_b32 v8, 10, v8
  v_and_b32 v9, 3, v0
  v_lshl_add_u32 v8, v9, 5, v8
  s_lshl_b32 s40, s36, 7
  v_add_u32 v8, s40, v8
  global_load_dwordx4 v[164:167], v8, s[4:5]
  global_load_dwordx4 v[168:171], v8, s[4:5] offset:16
  v_lshlrev_b32 v9, 6, v9
  s_lshl_b32 s40, s36, 8
  s_add_u32 s40, s40, 36864
  v_add_u32 v9, s40, v9
  global_load_dwordx4 v[172:175], v9, s[30:31] offset:0 sc1
  global_load_dwordx4 v[176:179], v9, s[30:31] offset:16 sc1
  global_load_dwordx4 v[180:183], v9, s[30:31] offset:32 sc1
  global_load_dwordx4 v[184:187], v9, s[30:31] offset:48 sc1
  v_add_u32 v9, 4096, v9
  global_load_dwordx4 v[188:191], v9, s[30:31] offset:0 sc1
  global_load_dwordx4 v[192:195], v9, s[30:31] offset:16 sc1
  global_load_dwordx4 v[196:199], v9, s[30:31] offset:32 sc1
  global_load_dwordx4 v[200:203], v9, s[30:31] offset:48 sc1
  s_mul_i32 s40, s36, 224
  s_mul_i32 s41, s32, 28
  s_add_u32 s40, s40, s41
  s_lshl_b32 s40, s40, 10
  s_add_u32 s40, s40, 5242880
  s_add_u32 s78, s30, s40
  s_addc_u32 s79, s31, 0
  s_add_u32 s80, s78, 114688
  s_addc_u32 s81, s79, 0
  global_load_dwordx4 a[0:3], v2, s[78:79] offset:0 sc1
  global_load_dwordx4 a[4:7], v2, s[80:81] offset:0 sc1
  global_load_dwordx4 a[8:11], v2, s[78:79] offset:1024 sc1
  global_load_dwordx4 a[12:15], v2, s[80:81] offset:1024 sc1
  global_load_dwordx4 a[16:19], v2, s[78:79] offset:2048 sc1
  global_load_dwordx4 a[20:23], v2, s[80:81] offset:2048 sc1
  global_load_dwordx4 a[24:27], v2, s[78:79] offset:3072 sc1
  global_load_dwordx4 a[28:31], v2, s[80:81] offset:3072 sc1
  s_add_u32 s78, s78, 4096
  s_addc_u32 s79, s79, 0
  s_add_u32 s80, s80, 4096
  s_addc_u32 s81, s81, 0
  global_load_dwordx4 a[32:35], v2, s[78:79] offset:0 sc1
  global_load_dwordx4 a[36:39], v2, s[80:81] offset:0 sc1
  global_load_dwordx4 a[40:43], v2, s[78:79] offset:1024 sc1
  global_load_dwordx4 a[44:47], v2, s[80:81] offset:1024 sc1
  global_load_dwordx4 a[48:51], v2, s[78:79] offset:2048 sc1
  global_load_dwordx4 a[52:55], v2, s[80:81] offset:2048 sc1
  global_load_dwordx4 a[56:59], v2, s[78:79] offset:3072 sc1
  global_load_dwordx4 a[60:63], v2, s[80:81] offset:3072 sc1
  s_add_u32 s78, s78, 4096
  s_addc_u32 s79, s79, 0
  s_add_u32 s80, s80, 4096
  s_addc_u32 s81, s81, 0
  global_load_dwordx4 a[64:67], v2, s[78:79] offset:0 sc1
  global_load_dwordx4 a[68:71], v2, s[80:81] offset:0 sc1
  global_load_dwordx4 a[72:75], v2, s[78:79] offset:1024 sc1
  global_load_dwordx4 a[76:79], v2, s[80:81] offset:1024 sc1
  global_load_dwordx4 a[80:83], v2, s[78:79] offset:2048 sc1
  global_load_dwordx4 a[84:87], v2, s[80:81] offset:2048 sc1
  global_load_dwordx4 a[88:91], v2, s[78:79] offset:3072 sc1
  global_load_dwordx4 a[92:95], v2, s[80:81] offset:3072 sc1
  s_add_u32 s78, s78, 4096
  s_addc_u32 s79, s79, 0
  s_add_u32 s80, s80, 4096
  s_addc_u32 s81, s81, 0
  global_load_dwordx4 a[96:99], v2, s[78:79] offset:0 sc1
  global_load_dwordx4 a[100:103], v2, s[80:81] offset:0 sc1
  global_load_dwordx4 a[104:107], v2, s[78:79] offset:1024 sc1
  global_load_dwordx4 a[108:111], v2, s[80:81] offset:1024 sc1
  global_load_dwordx4 a[112:115], v2, s[78:79] offset:2048 sc1
  global_load_dwordx4 a[116:119], v2, s[80:81] offset:2048 sc1
  global_load_dwordx4 a[120:123], v2, s[78:79] offset:3072 sc1
  global_load_dwordx4 a[124:127], v2, s[80:81] offset:3072 sc1
  s_add_u32 s78, s78, 4096
  s_addc_u32 s79, s79, 0
  s_add_u32 s80, s80, 4096
  s_addc_u32 s81, s81, 0
  global_load_dwordx4 a[128:131], v2, s[78:79] offset:0 sc1
  global_load_dwordx4 a[132:135], v2, s[80:81] offset:0 sc1
  global_load_dwordx4 a[136:139], v2, s[78:79] offset:1024 sc1
  global_load_dwordx4 a[140:143], v2, s[80:81] offset:1024 sc1
  global_load_dwordx4 a[144:147], v2, s[78:79] offset:2048 sc1
  global_load_dwordx4 a[148:151], v2, s[80:81] offset:2048 sc1
  global_load_dwordx4 a[152:155], v2, s[78:79] offset:3072 sc1
  global_load_dwordx4 a[156:159], v2, s[80:81] offset:3072 sc1
  s_add_u32 s78, s78, 4096
  s_addc_u32 s79, s79, 0
  s_add_u32 s80, s80, 4096
  s_addc_u32 s81, s81, 0
  global_load_dwordx4 a[160:163], v2, s[78:79] offset:0 sc1
  global_load_dwordx4 a[164:167], v2, s[80:81] offset:0 sc1
  global_load_dwordx4 a[168:171], v2, s[78:79] offset:1024 sc1
  global_load_dwordx4 a[172:175], v2, s[80:81] offset:1024 sc1
  global_load_dwordx4 a[176:179], v2, s[78:79] offset:2048 sc1
  global_load_dwordx4 a[180:183], v2, s[80:81] offset:2048 sc1
  global_load_dwordx4 a[184:187], v2, s[78:79] offset:3072 sc1
  global_load_dwordx4 a[188:191], v2, s[80:81] offset:3072 sc1
  s_add_u32 s78, s78, 4096
  s_addc_u32 s79, s79, 0
  s_add_u32 s80, s80, 4096
  s_addc_u32 s81, s81, 0
  s_waitcnt vmcnt(0)
  s_barrier
  s_mul_i32 s40, s38, 7
  s_add_u32 s40, s40, 0
  s_lshl_b32 s40, s40, 15
  s_lshl_b32 s41, s32, 13
  s_add_u32 s40, s40, s41
  s_add_u32 s40, s40, 7340032
  s_add_u32 s100, s30, s40
  s_addc_u32 s101, s31, 0
  s_add_u32 s76, s41, 0
  s_mov_b32 m0, s76
  s_nop 0
  global_load_lds_dwordx4 v2, s[100:101] offset:0 sc1
  global_load_lds_dwordx4 v2, s[100:101] offset:1024 sc1
  global_load_lds_dwordx4 v2, s[100:101] offset:2048 sc1
  global_load_lds_dwordx4 v2, s[100:101] offset:3072 sc1
  s_add_u32 s100, s100, 4096
  s_addc_u32 s101, s101, 0
  s_add_u32 m0, s76, 4096
  s_nop 0
  global_load_lds_dwordx4 v2, s[100:101] offset:0 sc1
  global_load_lds_dwordx4 v2, s[100:101] offset:1024 sc1
  global_load_lds_dwordx4 v2, s[100:101] offset:2048 sc1
  global_load_lds_dwordx4 v2, s[100:101] offset:3072 sc1
  s_mul_i32 s40, s38, 7
  s_add_u32 s40, s40, 1
  s_lshl_b32 s40, s40, 15
  s_lshl_b32 s41, s32, 13
  s_add_u32 s40, s40, s41
  s_add_u32 s40, s40, 7340032
  s_add_u32 s100, s30, s40
  s_addc_u32 s101, s31, 0
  s_add_u32 s76, s41, 65536
  s_mov_b32 m0, s76
  s_nop 0
  global_load_lds_dwordx4 v2, s[100:101] offset:0 sc1
  global_load_lds_dwordx4 v2, s[100:101] offset:1024 sc1
  global_load_lds_dwordx4 v2, s[100:101] offset:2048 sc1
  global_load_lds_dwordx4 v2, s[100:101] offset:3072 sc1
  s_add_u32 s100, s100, 4096
  s_addc_u32 s101, s101, 0
  s_add_u32 m0, s76, 4096
  s_nop 0
  global_load_lds_dwordx4 v2, s[100:101] offset:0 sc1
  global_load_lds_dwordx4 v2, s[100:101] offset:1024 sc1
  global_load_lds_dwordx4 v2, s[100:101] offset:2048 sc1
  global_load_lds_dwordx4 v2, s[100:101] offset:3072 sc1
L_attfin_44:
  s_nop 11
  v_mov_b32 v8, v72
  v_mov_b32 v9, v88
  v_mov_b32 v10, v8
  v_mov_b32 v11, v9
  s_nop 1
  v_permlane32_swap_b32 v8, v10
  v_permlane32_swap_b32 v9, v11
  v_rcp_f32 v8, v8
  v_rcp_f32 v9, v9
  s_nop 0
  v_mul_f32 v64, v64, v8
  v_mul_f32 v80, v80, v9
  v_mul_f32 v65, v65, v8
  v_mul_f32 v81, v81, v9
  v_mul_f32 v66, v66, v8
  v_mul_f32 v82, v82, v9
  v_mul_f32 v67, v67, v8
  v_mul_f32 v83, v83, v9
  v_mul_f32 v68, v68, v8
  v_mul_f32 v84, v84, v9
  v_mul_f32 v69, v69, v8
  v_mul_f32 v85, v85, v9
  v_mul_f32 v70, v70, v8
  v_mul_f32 v86, v86, v9
  v_mul_f32 v71, v71, v8
  v_mul_f32 v87, v87, v9
  v_cvt_pk_bf16_f32 v48, v64, v65
  v_cvt_pk_bf16_f32 v56, v80, v81
  v_cvt_pk_bf16_f32 v49, v66, v67
  v_cvt_pk_bf16_f32 v57, v82, v83
  v_cvt_pk_bf16_f32 v50, v68, v69
  v_cvt_pk_bf16_f32 v58, v84, v85
  v_cvt_pk_bf16_f32 v51, v70, v71
  v_cvt_pk_bf16_f32 v59, v86, v87
  s_lshl_b32 s40, s35, 1
  s_and_b32 s41, s32, 1
  s_add_u32 s40, s40, s41
  s_lshl_b32 s40, s40, 5
  s_lshl_b32 s41, s36, 2
  s_add_u32 s40, s40, s41
  s_lshr_b32 s41, s32, 1
  s_lshl_b32 s41, s41, 1
  s_add_u32 s40, s40, s41
  s_lshl_b32 s40, s40, 10
  s_add_u32 s40, s40, 1048576
  v_add_u32 v8, s40, v2
  global_store_dwordx4 v8, v[48:51], s[30:31] sc1
  global_store_dwordx4 v8, v[56:59], s[30:31] offset:1024 sc1
  s_waitcnt vmcnt(0)
  s_barrier
  s_cmp_lg_u32 s32, 0
  s_cbranch_scc1 L_arr_73
  s_lshl_b32 s40, s35, 7
  s_add_u32 s40, s40, 8192
  v_mov_b32 v8, s40
  v_mov_b32 v9, 1
  s_mov_b64 exec, 1
  global_atomic_add v8, v9, s[30:31] sc1
  s_mov_b64 exec, -1
L_arr_73:
  s_cmp_lt_u32 s32, 2
  s_cbranch_scc1 L_uvt_74
  s_mov_b64 exec, 255
  s_mov_b32 s92, 0
  s_branch L_pchk_78
L_poll_75:
  global_load_dword v237, v236, s[30:31] sc1
L_pchk_78:
  s_add_u32 s92, s92, 1
  s_cmp_gt_u32 s92, 200000
  s_cbranch_scc1 L_ptm_77
  s_waitcnt vmcnt(0)
  v_cmp_gt_u32 vcc, 32, v237
  s_cbranch_vccnz L_poll_75
  s_branch L_pok_76
L_ptm_77:
  s_waitcnt vmcnt(0)
  v_mov_b32 v236, 32
  v_mov_b32 v237, 9
  s_mov_b64 exec, 1
  global_store_dword v236, v237, s[28:29]
L_pok_76:
  s_mov_b64 exec, -1
  v_subrev_u32 v8, 128, v0
  v_min_u32 v8, 111, v8
  v_lshrrev_b32 v9, 4, v8
  v_and_b32 v10, 15, v8
  s_mul_i32 s40, s38, 7
  v_add_u32 v11, s40, v9
  v_lshlrev_b32 v11, 11, v11
  v_lshl_add_u32 v11, v10, 4, v11
  v_add_u32 v11, 18874368, v11
  v_lshlrev_b32 v9, 8, v9
  v_lshl_add_u32 v9, v10, 4, v9
  v_add_u32 v208, 131072, v9
  global_load_dwordx4 v[16:19], v11, s[30:31] offset:0 sc1
  global_load_dwordx4 v[20:23], v11, s[30:31] offset:256 sc1
  global_load_dwordx4 v[24:27], v11, s[30:31] offset:512 sc1
  global_load_dwordx4 v[28:31], v11, s[30:31] offset:768 sc1
  global_load_dwordx4 v[32:35], v11, s[30:31] offset:1024 sc1
  global_load_dwordx4 v[36:39], v11, s[30:31] offset:1280 sc1
  global_load_dwordx4 v[40:43], v11, s[30:31] offset:1536 sc1
  global_load_dwordx4 v[44:47], v11, s[30:31] offset:1792 sc1
  s_waitcnt vmcnt(0)
  v_add_f32 v16, v16, v32
  v_add_f32 v17, v17, v33
  v_add_f32 v18, v18, v34
  v_add_f32 v19, v19, v35
  v_add_f32 v20, v20, v36
  v_add_f32 v21, v21, v37
  v_add_f32 v22, v22, v38
  v_add_f32 v23, v23, v39
  v_add_f32 v24, v24, v40
  v_add_f32 v25, v25, v41
  v_add_f32 v26, v26, v42
  v_add_f32 v27, v27, v43
  v_add_f32 v28, v28, v44
  v_add_f32 v29, v29, v45
  v_add_f32 v30, v30, v46
  v_add_f32 v31, v31, v47
  v_add_f32 v16, v16, v24
  v_add_f32 v17, v17, v25
  v_add_f32 v18, v18, v26
  v_add_f32 v19, v19, v27
  v_add_f32 v20, v20, v28
  v_add_f32 v21, v21, v29
  v_add_f32 v22, v22, v30
  v_add_f32 v23, v23, v31
  v_add_f32 v204, v16, v20
  v_add_f32 v205, v17, v21
  v_add_f32 v206, v18, v22
  v_add_f32 v207, v19, v23
L_uvt_74:
  s_lshl_b32 s40, s35, 6
  s_lshl_b32 s41, s32, 3
  s_add_u32 s40, s40, s41
  s_lshl_b32 s40, s40, 10
  s_add_u32 s40, s40, 1048576
  s_add_u32 s98, s30, s40
  s_addc_u32 s99, s31, 0
  s_add_u32 s100, s98, 32768
  s_addc_u32 s101, s99, 0
  v_and_b32 v8, 31, v1
  v_lshrrev_b32 v9, 5, v1
  v_and_b32 v10, 7, v8
  v_xor_b32 v10, v10, v9
  v_lshlrev_b32 v8, 8, v8
  s_lshl_b32 s40, s32, 14
  s_add_u32 s40, s40, 98304
  v_add_u32 v8, s40, v8
  v_xor_b32 v9, 0, v10
  v_lshl_add_u32 v248, v9, 4, v8
  v_xor_b32 v9, 2, v10
  v_lshl_add_u32 v249, v9, 4, v8
  v_xor_b32 v9, 4, v10
  v_lshl_add_u32 v250, v9, 4, v8
  v_xor_b32 v9, 6, v10
  v_lshl_add_u32 v251, v9, 4, v8
  v_lshrrev_b32 v8, 2, v0
  v_and_b32 v9, 3, v0
  v_lshlrev_b32 v9, 2, v9
  v_and_b32 v10, 7, v8
  v_xor_b32 v9, v9, v10
  v_lshlrev_b32 v8, 8, v8
  v_add_u32 v8, 98304, v8
  v_xor_b32 v10, 0, v9
  v_lshl_add_u32 v216, v10, 4, v8
  v_xor_b32 v10, 1, v9
  v_lshl_add_u32 v217, v10, 4, v8
  v_xor_b32 v10, 2, v9
  v_lshl_add_u32 v218, v10, 4, v8
  v_xor_b32 v10, 3, v9
  v_lshl_add_u32 v219, v10, 4, v8
  v_add_f32 v188, 1.0, v188
  v_add_f32 v189, 1.0, v189
  v_add_f32 v190, 1.0, v190
  v_add_f32 v191, 1.0, v191
  v_add_f32 v192, 1.0, v192
  v_add_f32 v193, 1.0, v193
  v_add_f32 v194, 1.0, v194
  v_add_f32 v195, 1.0, v195
  v_add_f32 v196, 1.0, v196
  v_add_f32 v197, 1.0, v197
  v_add_f32 v198, 1.0, v198
  v_add_f32 v199, 1.0, v199
  v_add_f32 v200, 1.0, v200
  v_add_f32 v201, 1.0, v201
  v_add_f32 v202, 1.0, v202
  v_add_f32 v203, 1.0, v203
  v_lshlrev_b32 v220, 16, v164
  v_and_b32 v221, 0xffff0000, v164
  v_lshlrev_b32 v222, 16, v165
  v_and_b32 v223, 0xffff0000, v165
  v_lshlrev_b32 v224, 16, v166
  v_and_b32 v225, 0xffff0000, v166
  v_lshlrev_b32 v226, 16, v167
  v_and_b32 v227, 0xffff0000, v167
  v_lshlrev_b32 v228, 16, v168
  v_and_b32 v229, 0xffff0000, v168
  v_lshlrev_b32 v230, 16, v169
  v_and_b32 v231, 0xffff0000, v169
  v_lshlrev_b32 v232, 16, v170
  v_and_b32 v233, 0xffff0000, v170
  v_lshlrev_b32 v234, 16, v171
  v_and_b32 v235, 0xffff0000, v171
  v_lshrrev_b32 v8, 2, v0
  s_lshl_b32 s40, s35, 6
  v_add_u32 v237, s40, v8
  v_lshlrev_b32 v237, 6, v237
  s_lshl_b32 s40, s36, 3
  s_add_u32 s40, s40, 65536
  v_add_u32 v237, s40, v237
  v_and_b32 v8, 15, v1
  v_lshlrev_b32 v8, 2, v8
  v_lshrrev_b32 v9, 4, v1
  v_add_u32 v8, v8, v9
  v_lshlrev_b32 v238, 2, v8
  v_and_b32 v8, 15, v1
  s_lshl_b32 s40, s32, 4
  v_add_u32 v8, s40, v8
  v_lshrrev_b32 v9, 5, v8
  v_lshlrev_b32 v9, 15, v9
  v_and_b32 v8, 31, v8
  v_lshl_add_u32 v9, v8, 4, v9
  v_lshrrev_b32 v8, 4, v1
  v_lshl_add_u32 v9, v8, 10, v9
  s_lshl_b32 s40, s35, 16
  s_lshl_b32 s41, s36, 12
  s_add_u32 s40, s40, s41
  s_add_u32 s40, s40, 3145728
  v_add_u32 v236, s40, v9
  s_cmp_lg_u32 s32, 0
  s_cbranch_scc1 L_wt_79
  s_lshl_b32 s40, s35, 7
  s_add_u32 s40, s40, 8192
  v_lshlrev_b32 v10, 7, v1
  v_add_u32 v10, s40, v10
  s_mov_b64 exec, 1
  s_mov_b32 s92, 0
L_poll_80:
  global_load_dword v11, v10, s[30:31] sc1
L_pchk_83:
  s_add_u32 s92, s92, 1
  s_cmp_gt_u32 s92, 200000
  s_cbranch_scc1 L_ptm_82
  s_waitcnt vmcnt(0)
  v_cmp_gt_u32 vcc, 8, v11
  s_cbranch_vccnz L_poll_80
  s_branch L_pok_81
L_ptm_82:
  s_waitcnt vmcnt(0)
  v_mov_b32 v10, 32
  v_mov_b32 v11, 5
  s_mov_b64 exec, 1
  global_store_dword v10, v11, s[28:29]
L_pok_81:
  s_mov_b64 exec, -1
L_wt_79:
  s_barrier
  global_load_dwordx4 v[16:19], v2, s[98:99] offset:0 sc1
  global_load_dwordx4 v[48:51], v2, s[100:101] offset:0 sc1
  global_load_dwordx4 v[20:23], v2, s[98:99] offset:1024 sc1
  global_load_dwordx4 v[52:55], v2, s[100:101] offset:1024 sc1
  global_load_dwordx4 v[24:27], v2, s[98:99] offset:2048 sc1
  global_load_dwordx4 v[56:59], v2, s[100:101] offset:2048 sc1
  global_load_dwordx4 v[28:31], v2, s[98:99] offset:3072 sc1
  global_load_dwordx4 v[60:63], v2, s[100:101] offset:3072 sc1
  s_add_u32 s98, s98, 4096
  s_addc_u32 s99, s99, 0
  s_add_u32 s100, s100, 4096
  s_addc_u32 s101, s101, 0
  global_load_dwordx4 v[32:35], v2, s[98:99] offset:0 sc1
  global_load_dwordx4 v[64:67], v2, s[100:101] offset:0 sc1
  global_load_dwordx4 v[36:39], v2, s[98:99] offset:1024 sc1
  global_load_dwordx4 v[68:71], v2, s[100:101] offset:1024 sc1
  global_load_dwordx4 v[40:43], v2, s[98:99] offset:2048 sc1
  global_load_dwordx4 v[72:75], v2, s[100:101] offset:2048 sc1
  global_load_dwordx4 v[44:47], v2, s[98:99] offset:3072 sc1
  global_load_dwordx4 v[76:79], v2, s[100:101] offset:3072 sc1
  s_waitcnt vmcnt(14)
  v_mfma_f32_32x32x16_bf16 v[80:95], a[192:195], v[16:19], 0
  v_mfma_f32_32x32x16_bf16 v[96:111], a[192:195], v[48:51], 0
  v_mfma_f32_32x32x16_bf16 v[112:127], a[224:227], v[16:19], 0
  v_mfma_f32_32x32x16_bf16 v[128:143], a[224:227], v[48:51], 0
  s_waitcnt vmcnt(12)
  v_mfma_f32_32x32x16_bf16 v[80:95], a[196:199], v[20:23], v[80:95]
  v_mfma_f32_32x32x16_bf16 v[96:111], a[196:199], v[52:55], v[96:111]
  v_mfma_f32_32x32x16_bf16 v[112:127], a[228:231], v[20:23], v[112:127]
  v_mfma_f32_32x32x16_bf16 v[128:143], a[228:231], v[52:55], v[128:143]
  s_waitcnt vmcnt(10)
  v_mfma_f32_32x32x16_bf16 v[80:95], a[200:203], v[24:27], v[80:95]
  v_mfma_f32_32x32x16_bf16 v[96:111], a[200:203], v[56:59], v[96:111]
  v_mfma_f32_32x32x16_bf16 v[112:127], a[232:235], v[24:27], v[112:127]
  v_mfma_f32_32x32x16_bf16 v[128:143], a[232:235], v[56:59], v[128:143]
  s_waitcnt vmcnt(8)
  v_mfma_f32_32x32x16_bf16 v[80:95], a[204:207], v[28:31], v[80:95]
  v_mfma_f32_32x32x16_bf16 v[96:111], a[204:207], v[60:63], v[96:111]
  v_mfma_f32_32x32x16_bf16 v[112:127], a[236:239], v[28:31], v[112:127]
  v_mfma_f32_32x32x16_bf16 v[128:143], a[236:239], v[60:63], v[128:143]
  s_waitcnt vmcnt(6)
  v_mfma_f32_32x32x16_bf16 v[80:95], a[208:211], v[32:35], v[80:95]
  v_mfma_f32_32x32x16_bf16 v[96:111], a[208:211], v[64:67], v[96:111]
  v_mfma_f32_32x32x16_bf16 v[112:127], a[240:243], v[32:35], v[112:127]
  v_mfma_f32_32x32x16_bf16 v[128:143], a[240:243], v[64:67], v[128:143]
  s_waitcnt vmcnt(4)
  v_mfma_f32_32x32x16_bf16 v[80:95], a[212:215], v[36:39], v[80:95]
  v_mfma_f32_32x32x16_bf16 v[96:111], a[212:215], v[68:71], v[96:111]
  v_mfma_f32_32x32x16_bf16 v[112:127], a[244:247], v[36:39], v[112:127]
  v_mfma_f32_32x32x16_bf16 v[128:143], a[244:247], v[68:71], v[128:143]
  s_waitcnt vmcnt(2)
  v_mfma_f32_32x32x16_bf16 v[80:95], a[216:219], v[40:43], v[80:95]
  v_mfma_f32_32x32x16_bf16 v[96:111], a[216:219], v[72:75], v[96:111]
  v_mfma_f32_32x32x16_bf16 v[112:127], a[248:251], v[40:43], v[112:127]
  v_mfma_f32_32x32x16_bf16 v[128:143], a[248:251], v[72:75], v[128:143]
  s_waitcnt vmcnt(0)
  v_mfma_f32_32x32x16_bf16 v[80:95], a[220:223], v[44:47], v[80:95]
  v_mfma_f32_32x32x16_bf16 v[96:111], a[220:223], v[76:79], v[96:111]
  v_mfma_f32_32x32x16_bf16 v[112:127], a[252:255], v[44:47], v[112:127]
  v_mfma_f32_32x32x16_bf16 v[128:143], a[252:255], v[76:79], v[128:143]
  s_nop 11
  ds_write_b128 v248, v[80:83] offset:0
  ds_write_b128 v249, v[84:87] offset:0
  ds_write_b128 v250, v[88:91] offset:0
  ds_write_b128 v251, v[92:95] offset:0
  ds_write_b128 v248, v[96:99] offset:8192
  ds_write_b128 v249, v[100:103] offset:8192
  ds_write_b128 v250, v[104:107] offset:8192
  ds_write_b128 v251, v[108:111] offset:8192
  ds_write_b128 v248, v[112:115] offset:128
  ds_write_b128 v249, v[116:119] offset:128
  ds_write_b128 v250, v[120:123] offset:128
  ds_write_b128 v251, v[124:127] offset:128
  ds_write_b128 v248, v[128:131] offset:8320
  ds_write_b128 v249, v[132:135] offset:8320
  ds_write_b128 v250, v[136:139] offset:8320
  ds_write_b128 v251, v[140:143] offset:8320
  s_waitcnt lgkmcnt(0)
  s_barrier
  ds_read_b128 v[144:147], v216 offset:0
  ds_read_b128 v[148:151], v217 offset:0
  ds_read_b128 v[152:155], v218 offset:0
  ds_read_b128 v[156:159], v219 offset:0
  ds_read_b128 v[16:19], v216 offset:16384
  ds_read_b128 v[20:23], v217 offset:16384
  ds_read_b128 v[24:27], v218 offset:16384
  ds_read_b128 v[28:31], v219 offset:16384
  ds_read_b128 v[32:35], v216 offset:32768
  ds_read_b128 v[36:39], v217 offset:32768
  ds_read_b128 v[40:43], v218 offset:32768
  ds_read_b128 v[44:47], v219 offset:32768
  ds_read_b128 v[48:51], v216 offset:49152
  ds_read_b128 v[52:55], v217 offset:49152
  ds_read_b128 v[56:59], v218 offset:49152
  ds_read_b128 v[60:63], v219 offset:49152
  s_waitcnt lgkmcnt(8)
  v_add_f32 v144, v144, v16
  v_add_f32 v145, v145, v17
  v_add_f32 v146, v146, v18
  s_mul_i32 s40, s38, 7
  s_add_u32 s40, s40, 2
  s_lshl_b32 s40, s40, 15
  s_lshl_b32 s41, s32, 13
  s_add_u32 s40, s40, s41
  s_add_u32 s40, s40, 7340032
  s_add_u32 s100, s30, s40
  s_addc_u32 s101, s31, 0
  s_add_u32 s76, s41, 32768
  s_mov_b32 m0, s76
  s_nop 0
  global_load_lds_dwordx4 v2, s[100:101] offset:0 sc1
  v_add_f32 v147, v147, v19
  v_add_f32 v148, v148, v20
  v_add_f32 v149, v149, v21
  global_load_lds_dwordx4 v2, s[100:101] offset:1024 sc1
  v_add_f32 v150, v150, v22
  v_add_f32 v151, v151, v23
  v_add_f32 v152, v152, v24
  global_load_lds_dwordx4 v2, s[100:101] offset:2048 sc1
  v_add_f32 v153, v153, v25
  v_add_f32 v154, v154, v26
  v_add_f32 v155, v155, v27
  global_load_lds_dwordx4 v2, s[100:101] offset:3072 sc1
  v_add_f32 v156, v156, v28
  v_add_f32 v157, v157, v29
  v_add_f32 v158, v158, v30
  s_add_u32 s100, s100, 4096
  s_addc_u32 s101, s101, 0
  s_add_u32 m0, s76, 4096
  s_nop 0
  global_load_lds_dwordx4 v2, s[100:101] offset:0 sc1
  v_add_f32 v159, v159, v31
  s_waitcnt lgkmcnt(0)
  v_add_f32 v32, v32, v48
  v_add_f32 v33, v33, v49
  v_add_f32 v34, v34, v50
  global_load_lds_dwordx4 v2, s[100:101] offset:1024 sc1
  v_add_f32 v35, v35, v51
  v_add_f32 v36, v36, v52
  v_add_f32 v37, v37, v53
  global_load_lds_dwordx4 v2, s[100:101] offset:2048 sc1
  v_add_f32 v38, v38, v54
  v_add_f32 v39, v39, v55
  v_add_f32 v40, v40, v56
  global_load_lds_dwordx4 v2, s[100:101] offset:3072 sc1
  v_add_f32 v41, v41, v57
  v_add_f32 v42, v42, v58
  v_add_f32 v43, v43, v59
  s_mul_i32 s40, s36, 224
  s_mul_i32 s41, s32, 28
  s_add_u32 s40, s40, s41
  s_add_u32 s40, s40, 24
  s_lshl_b32 s40, s40, 10
  s_add_u32 s40, s40, 5242880
  s_add_u32 s78, s30, s40
  s_addc_u32 s79, s31, 0
  s_add_u32 s80, s78, 114688
  s_addc_u32 s81, s79, 0
  global_load_dwordx4 a[192:195], v2, s[78:79] offset:0 sc1
  v_add_f32 v44, v44, v60
  v_add_f32 v45, v45, v61
  v_add_f32 v46, v46, v62
  global_load_dwordx4 a[196:199], v2, s[80:81] offset:0 sc1
  v_add_f32 v47, v47, v63
  v_add_f32 v144, v144, v32
  v_add_f32 v145, v145, v33
  v_add_f32 v146, v146, v34
  global_load_dwordx4 a[200:203], v2, s[78:79] offset:1024 sc1
  v_add_f32 v147, v147, v35
  v_add_f32 v148, v148, v36
  v_add_f32 v149, v149, v37
  global_load_dwordx4 a[204:207], v2, s[80:81] offset:1024 sc1
  v_add_f32 v150, v150, v38
  v_add_f32 v151, v151, v39
  v_add_f32 v152, v152, v40
  global_load_dwordx4 a[208:211], v2, s[78:79] offset:2048 sc1
  v_add_f32 v153, v153, v41
  v_add_f32 v154, v154, v42
  v_add_f32 v155, v155, v43
  global_load_dwordx4 a[212:215], v2, s[80:81] offset:2048 sc1
  v_add_f32 v156, v156, v44
  v_add_f32 v157, v157, v45
  v_add_f32 v158, v158, v46
  global_load_dwordx4 a[216:219], v2, s[78:79] offset:3072 sc1
  v_add_f32 v159, v159, v47
  v_fma_f32 v144, v172, v144, v220
  v_fma_f32 v145, v173, v145, v221
  v_fma_f32 v146, v174, v146, v222
  global_load_dwordx4 a[220:223], v2, s[80:81] offset:3072 sc1
  s_add_u32 s78, s78, 4096
  s_addc_u32 s79, s79, 0
  s_add_u32 s80, s80, 4096
  s_addc_u32 s81, s81, 0
  v_fma_f32 v147, v175, v147, v223
  v_fma_f32 v148, v176, v148, v224
  v_fma_f32 v149, v177, v149, v225
  v_and_b32 v7, 3, v0
  v_lshlrev_b32 v7, 6, v7
  s_lshl_b32 s40, s36, 8
  s_add_u32 s40, s40, 43008
  v_add_u32 v7, s40, v7
  global_load_dwordx4 a[224:227], v7, s[30:31] offset:0 sc1
  v_fma_f32 v150, v178, v150, v226
  v_fma_f32 v151, v179, v151, v227
  v_fma_f32 v152, v180, v152, v228
  global_load_dwordx4 a[228:231], v7, s[30:31] offset:16 sc1
  v_fma_f32 v153, v181, v153, v229
  v_fma_f32 v154, v182, v154, v230
  v_fma_f32 v155, v183, v155, v231
  global_load_dwordx4 a[232:235], v7, s[30:31] offset:32 sc1
  v_fma_f32 v156, v184, v156, v232
  v_fma_f32 v157, v185, v157, v233
  v_fma_f32 v158, v186, v158, v234
  global_load_dwordx4 a[236:239], v7, s[30:31] offset:48 sc1
  v_fma_f32 v159, v187, v159, v235
  v_cvt_pk_bf16_f32 v240, v144, v145
  v_cvt_pk_bf16_f32 v241, v146, v147
  v_cvt_pk_bf16_f32 v242, v148, v149
  v_cvt_pk_bf16_f32 v243, v150, v151
  v_cvt_pk_bf16_f32 v244, v152, v153
  v_cvt_pk_bf16_f32 v245, v154, v155
  v_cvt_pk_bf16_f32 v246, v156, v157
  v_cvt_pk_bf16_f32 v247, v158, v159
  v_mov_b32 v12, 0x3f803f80
  v_dot2_f32_bf16 v10, v240, v12, 0
  v_dot2_f32_bf16 v11, v240, v240, 0
  v_dot2_f32_bf16 v10, v241, v12, v10
  v_dot2_f32_bf16 v11, v241, v241, v11
  v_dot2_f32_bf16 v10, v242, v12, v10
  v_dot2_f32_bf16 v11, v242, v242, v11
  v_dot2_f32_bf16 v10, v243, v12, v10
  v_dot2_f32_bf16 v11, v243, v243, v11
  v_dot2_f32_bf16 v10, v244, v12, v10
  v_dot2_f32_bf16 v11, v244, v244, v11
  v_dot2_f32_bf16 v10, v245, v12, v10
  v_dot2_f32_bf16 v11, v245, v245, v11
  v_dot2_f32_bf16 v10, v246, v12, v10
  v_dot2_f32_bf16 v11, v246, v246, v11
  v_dot2_f32_bf16 v10, v247, v12, v10
  v_dot2_f32_bf16 v11, v247, v247, v11
  v_lshlrev_b32 v144, 16, v240
  v_and_b32 v145, 0xffff0000, v240
  v_lshlrev_b32 v146, 16, v241
  v_and_b32 v147, 0xffff0000, v241
  v_lshlrev_b32 v148, 16, v242
  v_and_b32 v149, 0xffff0000, v242
  v_lshlrev_b32 v150, 16, v243
  v_and_b32 v151, 0xffff0000, v243
  v_lshlrev_b32 v152, 16, v244
  v_and_b32 v153, 0xffff0000, v244
  v_lshlrev_b32 v154, 16, v245
  v_and_b32 v155, 0xffff0000, v245
  v_lshlrev_b32 v156, 16, v246
  v_and_b32 v157, 0xffff0000, v246
  v_lshlrev_b32 v158, 16, v247
  v_and_b32 v159, 0xffff0000, v247
  v_add_f32_dpp v10, v10, v10 quad_perm:[1,0,3,2] row_mask:0xf bank_mask:0xf
  v_add_f32_dpp v11, v11, v11 quad_perm:[1,0,3,2] row_mask:0xf bank_mask:0xf
  s_nop 0
  v_add_f32_dpp v10, v10, v10 quad_perm:[2,3,0,1] row_mask:0xf bank_mask:0xf
  v_add_f32_dpp v11, v11, v11 quad_perm:[2,3,0,1] row_mask:0xf bank_mask:0xf
  s_nop 0
  v_mul_f32 v144, v144, v188
  v_mul_f32 v145, v145, v189
  v_mul_f32 v146, v146, v190
  v_mul_f32 v147, v147, v191
  v_mul_f32 v148, v148, v192
  v_mul_f32 v149, v149, v193
  v_mul_f32 v150, v150, v194
  v_mul_f32 v151, v151, v195
  v_mul_f32 v152, v152, v196
  v_mul_f32 v153, v153, v197
  v_mul_f32 v154, v154, v198
  v_mul_f32 v155, v155, v199
  v_mul_f32 v156, v156, v200
  v_mul_f32 v157, v157, v201
  v_mul_f32 v158, v158, v202
  v_mul_f32 v159, v159, v203
  v_cvt_pk_bf16_f32 v16, v144, v145
  v_cvt_pk_bf16_f32 v17, v146, v147
  v_cvt_pk_bf16_f32 v18, v152, v153
  v_cvt_pk_bf16_f32 v19, v154, v155
  v_cvt_pk_bf16_f32 v20, v148, v149
  v_cvt_pk_bf16_f32 v21, v150, v151
  v_cvt_pk_bf16_f32 v22, v156, v157
  v_cvt_pk_bf16_f32 v23, v158, v159
  ds_bpermute_b32 v24, v238, v16
  ds_bpermute_b32 v25, v238, v17
  ds_bpermute_b32 v26, v238, v18
  ds_bpermute_b32 v27, v238, v19
  ds_bpermute_b32 v28, v238, v20
  ds_bpermute_b32 v29, v238, v21
  ds_bpermute_b32 v30, v238, v22
  ds_bpermute_b32 v31, v238, v23
  s_mov_b32 s42, 0x11111111
  s_mov_b32 s43, 0x11111111
  s_mov_b64 exec, s[42:43]
  global_store_dwordx2 v237, v[10:11], s[30:31] sc1
  s_mov_b64 exec, -1
  s_waitcnt lgkmcnt(0)
  global_store_dwordx4 v236, v[24:27], s[30:31] sc1
  global_store_dwordx4 v236, v[28:31], s[30:31] offset:512 sc1
  s_waitcnt vmcnt(0)
  s_barrier
  s_cmp_lg_u32 s32, 0
  s_cbranch_scc1 L_arr_84
  s_lshl_b32 s40, s35, 7
  s_add_u32 s40, s40, 16384
  v_mov_b32 v14, s40
  v_mov_b32 v15, 1
  s_mov_b64 exec, 1
  global_atomic_add v14, v15, s[30:31] sc1
  s_mov_b64 exec, -1
L_arr_84:
  s_cmp_lt_u32 s32, 2
  s_cbranch_scc1 L_uvw_85
  v_subrev_u32 v8, 128, v0
  v_min_u32 v8, 111, v8
  v_lshrrev_b32 v9, 4, v8
  v_lshlrev_b32 v9, 10, v9
  v_and_b32 v10, 3, v8
  v_lshl_add_u32 v9, v10, 7, v9
  v_bfe_u32 v10, v8, 2, 1
  v_lshl_add_u32 v9, v10, 6, v9
  v_bfe_u32 v10, v8, 3, 1
  v_lshl_add_u32 v9, v10, 9, v9
  v_add_u32 v9, 131072, v9
  v_cmp_eq_u32 vcc, 0, v10
  v_mov_b32_dpp v16, v204 row_ror:8 row_mask:0xf bank_mask:0xf
  v_mov_b32_dpp v17, v205 row_ror:8 row_mask:0xf bank_mask:0xf
  v_mov_b32_dpp v18, v206 row_ror:8 row_mask:0xf bank_mask:0xf
  v_mov_b32_dpp v19, v207 row_ror:8 row_mask:0xf bank_mask:0xf
  v_cvt_pk_bf16_f32 v20, v204, v16
  v_cvt_pk_bf16_f32 v21, v205, v17
  v_cvt_pk_bf16_f32 v22, v206, v18
  v_cvt_pk_bf16_f32 v23, v207, v19
  v_cndmask_b32 v24, 0, v20, vcc
  v_mov_b32 v25, 0
  v_mov_b32 v26, 0
  v_mov_b32 v27, 0
  v_cndmask_b32 v28, 0, v21, vcc
  v_mov_b32 v29, 0
  v_mov_b32 v30, 0
  v_mov_b32 v31, 0
  v_cndmask_b32 v32, 0, v22, vcc
  v_mov_b32 v33, 0
  v_mov_b32 v34, 0
  v_mov_b32 v35, 0
  v_cndmask_b32 v36, 0, v23, vcc
  v_mov_b32 v37, 0
  v_mov_b32 v38, 0
  v_mov_b32 v39, 0
  ds_write_b128 v9, v[24:27] offset:0
  ds_write_b128 v9, v[28:31] offset:16
  ds_write_b128 v9, v[32:35] offset:32
  ds_write_b128 v9, v[36:39] offset:48
  s_waitcnt lgkmcnt(0)
L_uvw_85:
  s_lshl_b32 s40, s37, 2
  s_add_u32 s83, s40, s32
  s_lshl_b32 s40, s83, 15
  s_add_u32 s40, s40, 3145728
  s_add_u32 s98, s30, s40
  s_addc_u32 s99, s31, 0
  s_lshl_b32 s82, s37, 1
  s_waitcnt vmcnt(0)
  s_cmp_lg_u32 s32, 0
  s_cbranch_scc1 L_wt_86
  s_lshl_b32 s40, s82, 7
  s_add_u32 s40, s40, 16384
  v_lshlrev_b32 v12, 7, v1
  v_add_u32 v12, s40, v12
  s_mov_b64 exec, 3
  s_mov_b32 s92, 0
L_poll_87:
  global_load_dword v13, v12, s[30:31] sc1
L_pchk_90:
  s_add_u32 s92, s92, 1
  s_cmp_gt_u32 s92, 200000
  s_cbranch_scc1 L_ptm_89
  s_waitcnt vmcnt(0)
  v_cmp_gt_u32 vcc, 8, v13
  s_cbranch_vccnz L_poll_87
  s_branch L_pok_88
L_ptm_89:
  s_waitcnt vmcnt(0)
  v_mov_b32 v12, 32
  v_mov_b32 v13, 7
  s_mov_b64 exec, 1
  global_store_dword v12, v13, s[28:29]
L_pok_88:
  s_mov_b64 exec, -1
L_wt_86:
  s_barrier
  global_load_dwordx4 v[16:19], v2, s[98:99] offset:0 sc1
  global_load_dwordx4 v[20:23], v2, s[98:99] offset:1024 sc1
  global_load_dwordx4 v[24:27], v2, s[98:99] offset:2048 sc1
  global_load_dwordx4 v[28:31], v2, s[98:99] offset:3072 sc1
  s_add_u32 s98, s98, 4096
  s_addc_u32 s99, s99, 0
  global_load_dwordx4 v[32:35], v2, s[98:99] offset:0 sc1
  global_load_dwordx4 v[36:39], v2, s[98:99] offset:1024 sc1
  global_load_dwordx4 v[40:43], v2, s[98:99] offset:2048 sc1
  global_load_dwordx4 v[44:47], v2, s[98:99] offset:3072 sc1
  s_add_u32 s98, s98, 4096
  s_addc_u32 s99, s99, 0
  global_load_dwordx4 v[48:51], v2, s[98:99] offset:0 sc1
  global_load_dwordx4 v[52:55], v2, s[98:99] offset:1024 sc1
  global_load_dwordx4 v[56:59], v2, s[98:99] offset:2048 sc1
  global_load_dwordx4 v[60:63], v2, s[98:99] offset:3072 sc1
  s_add_u32 s98, s98, 4096
  s_addc_u32 s99, s99, 0
  s_mul_i32 s40, s83, 112
  s_mul_i32 s41, s38, 7
  s_add_u32 s40, s40, s41
  s_lshl_b32 s40, s40, 10
  s_add_u32 s40, s40, 11534336
  v_add_u32 v236, s40, v2
  v_add_u32 v237, 0, v2
  v_add_u32 v238, 65536, v2
  v_add_u32 v13, 32768, v2
  v_add_u32 v14, 131072, v2
  v_and_b32 v12, 31, v1
  s_lshl_b32 s40, s83, 5
  v_add_u32 v12, s40, v12
  v_lshlrev_b32 v12, 6, v12
  v_add_u32 v12, 65536, v12
  ds_read_b128 v[212:215], v237 offset:0
  ds_read_b128 v[216:219], v238 offset:0
  ds_read_b128 v[220:223], v13 offset:0
  ds_read_b128 v[224:227], v237 offset:1024
  ds_read_b128 v[228:231], v238 offset:1024
  ds_read_b128 v[232:235], v13 offset:1024
  ds_read_b128 v[128:131], v237 offset:2048
  ds_read_b128 v[132:135], v238 offset:2048
  ds_read_b128 v[136:139], v13 offset:2048
  global_load_dwordx4 v[248:251], v12, s[30:31] sc1
  global_load_dwordx4 v[252:255], v12, s[30:31] offset:16 sc1
  global_load_dwordx4 v[4:7], v12, s[30:31] offset:32 sc1
  global_load_dwordx4 v[8:11], v12, s[30:31] offset:48 sc1
  s_waitcnt vmcnt(15) lgkmcnt(6)
  v_mfma_f32_32x32x16_bf16 v[148:163], v[212:215], v[16:19], 0
  v_mfma_f32_32x32x16_bf16 v[164:179], v[216:219], v[16:19], 0
  v_mfma_f32_32x32x16_bf16 v[180:195], v[220:223], v[16:19], 0
  global_load_dwordx4 v[64:67], v2, s[98:99] offset:0 sc1
  ds_read_b128 v[212:215], v237 offset:3072
  ds_read_b128 v[216:219], v238 offset:3072
  ds_read_b128 v[220:223], v13 offset:3072
  s_waitcnt vmcnt(15) lgkmcnt(6)
  v_mfma_f32_32x32x16_bf16 v[148:163], v[224:227], v[20:23], v[148:163]
  v_mfma_f32_32x32x16_bf16 v[164:179], v[228:231], v[20:23], v[164:179]
  v_mfma_f32_32x32x16_bf16 v[180:195], v[232:235], v[20:23], v[180:195]
  global_load_dwordx4 v[68:71], v2, s[98:99] offset:1024 sc1
  ds_read_b128 v[224:227], v237 offset:4096
  ds_read_b128 v[228:231], v238 offset:4096
  ds_read_b128 v[232:235], v13 offset:4096
  s_waitcnt vmcnt(15) lgkmcnt(6)
  v_mfma_f32_32x32x16_bf16 v[148:163], v[128:131], v[24:27], v[148:163]
  v_mfma_f32_32x32x16_bf16 v[164:179], v[132:135], v[24:27], v[164:179]
  v_mfma_f32_32x32x16_bf16 v[180:195], v[136:139], v[24:27], v[180:195]
  global_load_dwordx4 v[72:75], v2, s[98:99] offset:2048 sc1
  ds_read_b128 v[128:131], v237 offset:5120
  ds_read_b128 v[132:135], v238 offset:5120
  ds_read_b128 v[136:139], v13 offset:5120
  s_waitcnt vmcnt(15) lgkmcnt(6)
  v_mfma_f32_32x32x16_bf16 v[148:163], v[212:215], v[28:31], v[148:163]
  v_mfma_f32_32x32x16_bf16 v[164:179], v[216:219], v[28:31], v[164:179]
  v_mfma_f32_32x32x16_bf16 v[180:195], v[220:223], v[28:31], v[180:195]
  global_load_dwordx4 v[76:79], v2, s[98:99] offset:3072 sc1
  s_add_u32 s98, s98, 4096
  s_addc_u32 s99, s99, 0
  ds_read_b128 v[212:215], v237 offset:6144
  ds_read_b128 v[216:219], v238 offset:6144
  ds_read_b128 v[220:223], v13 offset:6144
  s_waitcnt vmcnt(15) lgkmcnt(6)
  v_mfma_f32_32x32x16_bf16 v[148:163], v[224:227], v[32:35], v[148:163]
  v_mfma_f32_32x32x16_bf16 v[164:179], v[228:231], v[32:35], v[164:179]
  v_mfma_f32_32x32x16_bf16 v[180:195], v[232:235], v[32:35], v[180:195]
  global_load_dwordx4 v[80:83], v2, s[98:99] offset:0 sc1
  ds_read_b128 v[224:227], v237 offset:7168
  ds_read_b128 v[228:231], v238 offset:7168
  ds_read_b128 v[232:235], v13 offset:7168
  s_waitcnt vmcnt(15) lgkmcnt(6)
  v_mfma_f32_32x32x16_bf16 v[148:163], v[128:131], v[36:39], v[148:163]
  v_mfma_f32_32x32x16_bf16 v[164:179], v[132:135], v[36:39], v[164:179]
  v_mfma_f32_32x32x16_bf16 v[180:195], v[136:139], v[36:39], v[180:195]
  global_load_dwordx4 v[84:87], v2, s[98:99] offset:1024 sc1
  ds_read_b128 v[128:131], v237 offset:8192
  ds_read_b128 v[132:135], v238 offset:8192
  ds_read_b128 v[136:139], v13 offset:8192
  s_waitcnt vmcnt(15) lgkmcnt(6)
  v_mfma_f32_32x32x16_bf16 v[148:163], v[212:215], v[40:43], v[148:163]
  v_mfma_f32_32x32x16_bf16 v[164:179], v[216:219], v[40:43], v[164:179]
  v_mfma_f32_32x32x16_bf16 v[180:195], v[220:223], v[40:43], v[180:195]
  global_load_dwordx4 v[88:91], v2, s[98:99] offset:2048 sc1
  ds_read_b128 v[212:215], v237 offset:9216
  ds_read_b128 v[216:219], v238 offset:9216
  ds_read_b128 v[220:223], v13 offset:9216
  s_waitcnt vmcnt(15) lgkmcnt(6)
  v_mfma_f32_32x32x16_bf16 v[148:163], v[224:227], v[44:47], v[148:163]
  v_mfma_f32_32x32x16_bf16 v[164:179], v[228:231], v[44:47], v[164:179]
  v_mfma_f32_32x32x16_bf16 v[180:195], v[232:235], v[44:47], v[180:195]
  global_load_dwordx4 v[92:95], v2, s[98:99] offset:3072 sc1
  s_add_u32 s98, s98, 4096
  s_addc_u32 s99, s99, 0
  ds_read_b128 v[224:227], v237 offset:10240
  ds_read_b128 v[228:231], v238 offset:10240
  ds_read_b128 v[232:235], v13 offset:10240
  s_waitcnt vmcnt(15) lgkmcnt(6)
  v_mfma_f32_32x32x16_bf16 v[148:163], v[128:131], v[48:51], v[148:163]
  v_mfma_f32_32x32x16_bf16 v[164:179], v[132:135], v[48:51], v[164:179]
  v_mfma_f32_32x32x16_bf16 v[180:195], v[136:139], v[48:51], v[180:195]
  global_load_dwordx4 v[96:99], v2, s[98:99] offset:0 sc1
  ds_read_b128 v[128:131], v237 offset:11264
  ds_read_b128 v[132:135], v238 offset:11264
  ds_read_b128 v[136:139], v13 offset:11264
  s_waitcnt vmcnt(15) lgkmcnt(6)
  v_mfma_f32_32x32x16_bf16 v[148:163], v[212:215], v[52:55], v[148:163]
  v_mfma_f32_32x32x16_bf16 v[164:179], v[216:219], v[52:55], v[164:179]
  v_mfma_f32_32x32x16_bf16 v[180:195], v[220:223], v[52:55], v[180:195]
  global_load_dwordx4 v[100:103], v2, s[98:99] offset:1024 sc1
  ds_read_b128 v[212:215], v237 offset:12288
  ds_read_b128 v[216:219], v238 offset:12288
  ds_read_b128 v[220:223], v13 offset:12288
  s_waitcnt vmcnt(15) lgkmcnt(6)
  v_mfma_f32_32x32x16_bf16 v[148:163], v[224:227], v[56:59], v[148:163]
  v_mfma_f32_32x32x16_bf16 v[164:179], v[228:231], v[56:59], v[164:179]
  v_mfma_f32_32x32x16_bf16 v[180:195], v[232:235], v[56:59], v[180:195]
  global_load_dwordx4 v[104:107], v2, s[98:99] offset:2048 sc1
  ds_read_b128 v[224:227], v237 offset:13312
  ds_read_b128 v[228:231], v238 offset:13312
  ds_read_b128 v[232:235], v13 offset:13312
  s_waitcnt vmcnt(15) lgkmcnt(6)
  v_mfma_f32_32x32x16_bf16 v[148:163], v[128:131], v[60:63], v[148:163]
  v_mfma_f32_32x32x16_bf16 v[164:179], v[132:135], v[60:63], v[164:179]
  v_mfma_f32_32x32x16_bf16 v[180:195], v[136:139], v[60:63], v[180:195]
  global_load_dwordx4 v[108:111], v2, s[98:99] offset:3072 sc1
  s_add_u32 s98, s98, 4096
  s_addc_u32 s99, s99, 0
  ds_read_b128 v[128:131], v237 offset:14336
  ds_read_b128 v[132:135], v238 offset:14336
  ds_read_b128 v[136:139], v13 offset:14336
  s_waitcnt vmcnt(11) lgkmcnt(6)
  v_mfma_f32_32x32x16_bf16 v[148:163], v[212:215], v[64:67], v[148:163]
  v_mfma_f32_32x32x16_bf16 v[164:179], v[216:219], v[64:67], v[164:179]
  v_mfma_f32_32x32x16_bf16 v[180:195], v[220:223], v[64:67], v[180:195]
  global_load_dwordx4 v[112:115], v2, s[98:99] offset:0 sc1
  ds_read_b128 v[212:215], v237 offset:15360
  ds_read_b128 v[216:219], v238 offset:15360
  ds_read_b128 v[220:223], v13 offset:15360
  s_waitcnt vmcnt(11) lgkmcnt(6)
  v_mfma_f32_32x32x16_bf16 v[148:163], v[224:227], v[68:71], v[148:163]
  v_mfma_f32_32x32x16_bf16 v[164:179], v[228:231], v[68:71], v[164:179]
  v_mfma_f32_32x32x16_bf16 v[180:195], v[232:235], v[68:71], v[180:195]
  global_load_dwordx4 v[116:119], v2, s[98:99] offset:1024 sc1
  ds_read_b128 v[224:227], v237 offset:16384
  ds_read_b128 v[228:231], v238 offset:16384
  ds_read_b128 v[232:235], v13 offset:16384
  v_add_f32 v248, v248, v250
  v_add_f32 v249, v249, v251
  v_add_f32 v252, v252, v254
  s_waitcnt vmcnt(11) lgkmcnt(6)
  v_mfma_f32_32x32x16_bf16 v[148:163], v[128:131], v[72:75], v[148:163]
  v_mfma_f32_32x32x16_bf16 v[164:179], v[132:135], v[72:75], v[164:179]
  v_mfma_f32_32x32x16_bf16 v[180:195], v[136:139], v[72:75], v[180:195]
  global_load_dwordx4 v[120:123], v2, s[98:99] offset:2048 sc1
  ds_read_b128 v[128:131], v237 offset:17408
  ds_read_b128 v[132:135], v238 offset:17408
  ds_read_b128 v[136:139], v13 offset:17408
  v_add_f32 v253, v253, v255
  v_add_f32 v4, v4, v6
  v_add_f32 v5, v5, v7
  s_waitcnt vmcnt(11) lgkmcnt(6)
  v_mfma_f32_32x32x16_bf16 v[148:163], v[212:215], v[76:79], v[148:163]
  v_mfma_f32_32x32x16_bf16 v[164:179], v[216:219], v[76:79], v[164:179]
  v_mfma_f32_32x32x16_bf16 v[180:195], v[220:223], v[76:79], v[180:195]
  global_load_dwordx4 v[124:127], v2, s[98:99] offset:3072 sc1
  s_add_u32 s98, s98, 4096
  s_addc_u32 s99, s99, 0
  ds_read_b128 v[212:215], v237 offset:18432
  ds_read_b128 v[216:219], v238 offset:18432
  ds_read_b128 v[220:223], v13 offset:18432
  v_add_f32 v8, v8, v10
  v_add_f32 v9, v9, v11
  v_add_f32 v248, v248, v252
  s_waitcnt vmcnt(11) lgkmcnt(6)
  v_mfma_f32_32x32x16_bf16 v[148:163], v[224:227], v[80:83], v[148:163]
  v_mfma_f32_32x32x16_bf16 v[164:179], v[228:231], v[80:83], v[164:179]
  v_mfma_f32_32x32x16_bf16 v[180:195], v[232:235], v[80:83], v[180:195]
  global_load_dwordx4 a[240:243], v2, s[98:99] offset:0 sc1
  ds_read_b128 v[224:227], v237 offset:19456
  ds_read_b128 v[228:231], v238 offset:19456
  ds_read_b128 v[232:235], v13 offset:19456
  v_add_f32 v249, v249, v253
  v_add_f32 v4, v4, v8
  v_add_f32 v5, v5, v9
  s_waitcnt vmcnt(11) lgkmcnt(6)
  v_mfma_f32_32x32x16_bf16 v[148:163], v[128:131], v[84:87], v[148:163]
  v_mfma_f32_32x32x16_bf16 v[164:179], v[132:135], v[84:87], v[164:179]
  v_mfma_f32_32x32x16_bf16 v[180:195], v[136:139], v[84:87], v[180:195]
  global_load_dwordx4 a[244:247], v2, s[98:99] offset:1024 sc1
  ds_read_b128 v[128:131], v237 offset:20480
  ds_read_b128 v[132:135], v238 offset:20480
  ds_read_b128 v[136:139], v13 offset:20480
  v_add_f32 v4, v4, v248
  v_add_f32 v5, v5, v249
  v_mul_f32 v4, 0x3b000000, v4
  s_waitcnt vmcnt(11) lgkmcnt(6)
  v_mfma_f32_32x32x16_bf16 v[148:163], v[212:215], v[88:91], v[148:163]
  v_mfma_f32_32x32x16_bf16 v[164:179], v[216:219], v[88:91], v[164:179]
  v_mfma_f32_32x32x16_bf16 v[180:195], v[220:223], v[88:91], v[180:195]
  global_load_dwordx4 a[248:251], v2, s[98:99] offset:2048 sc1
  ds_read_b128 v[212:215], v237 offset:21504
  ds_read_b128 v[216:219], v238 offset:21504
  ds_read_b128 v[220:223], v13 offset:21504
  v_mul_f32 v6, v4, v4
  s_mov_b32 s40, 0x3b000000
  v_fma_f32 v5, v5, s40, -v6
  s_waitcnt vmcnt(11) lgkmcnt(6)
  v_mfma_f32_32x32x16_bf16 v[148:163], v[224:227], v[92:95], v[148:163]
  v_mfma_f32_32x32x16_bf16 v[164:179], v[228:231], v[92:95], v[164:179]
  v_mfma_f32_32x32x16_bf16 v[180:195], v[232:235], v[92:95], v[180:195]
  global_load_dwordx4 a[252:255], v2, s[98:99] offset:3072 sc1
  ds_read_b128 v[224:227], v237 offset:22528
  ds_read_b128 v[228:231], v238 offset:22528
  ds_read_b128 v[232:235], v13 offset:22528
  v_max_f32 v5, 0, v5
  v_add_f32 v5, 0x3727c5ac, v5
  v_rsq_f32 v8, v5
  s_waitcnt vmcnt(11) lgkmcnt(6)
  v_mfma_f32_32x32x16_bf16 v[148:163], v[128:131], v[96:99], v[148:163]
  v_mfma_f32_32x32x16_bf16 v[164:179], v[132:135], v[96:99], v[164:179]
  v_mfma_f32_32x32x16_bf16 v[180:195], v[136:139], v[96:99], v[180:195]
  s_mul_i32 s40, s38, 7
  s_add_u32 s40, s40, 3
  s_lshl_b32 s40, s40, 15
  s_lshl_b32 s41, s32, 13
  s_add_u32 s40, s40, s41
  s_add_u32 s40, s40, 7340032
  s_add_u32 s100, s30, s40
  s_addc_u32 s101, s31, 0
  s_add_u32 s76, s41, 98304
  s_mov_b32 m0, s76
  s_nop 0
  global_load_lds_dwordx4 v2, s[100:101] offset:0 sc1
  ds_read_b128 v[128:131], v237 offset:23552
  ds_read_b128 v[132:135], v238 offset:23552
  ds_read_b128 v[136:139], v13 offset:23552
  v_sqrt_f32 v9, v5
  v_sub_f32 v4, 0, v4
  v_cmp_gt_u32 vcc, 32, v1
  s_waitcnt vmcnt(11) lgkmcnt(6)
  v_mfma_f32_32x32x16_bf16 v[148:163], v[212:215], v[100:103], v[148:163]
  v_mfma_f32_32x32x16_bf16 v[164:179], v[216:219], v[100:103], v[164:179]
  v_mfma_f32_32x32x16_bf16 v[180:195], v[220:223], v[100:103], v[180:195]
  global_load_lds_dwordx4 v2, s[100:101] offset:1024 sc1
  ds_read_b128 v[212:215], v237 offset:24576
  ds_read_b128 v[216:219], v238 offset:24576
  ds_read_b128 v[220:223], v13 offset:24576
  v_mul_f32 v239, 0xbfb8aa3b, v8
  v_mul_f32 v15, v8, v8
  v_cvt_pk_bf16_f32 v4, v4, v9
  s_waitcnt vmcnt(11) lgkmcnt(6)
  v_mfma_f32_32x32x16_bf16 v[148:163], v[224:227], v[104:107], v[148:163]
  v_mfma_f32_32x32x16_bf16 v[164:179], v[228:231], v[104:107], v[164:179]
  v_mfma_f32_32x32x16_bf16 v[180:195], v[232:235], v[104:107], v[180:195]
  global_load_lds_dwordx4 v2, s[100:101] offset:2048 sc1
  ds_read_b128 v[224:227], v237 offset:25600
  ds_read_b128 v[228:231], v238 offset:25600
  ds_read_b128 v[232:235], v13 offset:25600
  v_mov_b32 v5, 0
  v_mov_b32 v6, 0
  v_mov_b32 v7, 0
  s_waitcnt vmcnt(11) lgkmcnt(6)
  v_mfma_f32_32x32x16_bf16 v[148:163], v[128:131], v[108:111], v[148:163]
  v_mfma_f32_32x32x16_bf16 v[164:179], v[132:135], v[108:111], v[164:179]
  v_mfma_f32_32x32x16_bf16 v[180:195], v[136:139], v[108:111], v[180:195]
  global_load_lds_dwordx4 v2, s[100:101] offset:3072 sc1
  ds_read_b128 v[128:131], v237 offset:26624
  ds_read_b128 v[132:135], v238 offset:26624
  ds_read_b128 v[136:139], v13 offset:26624
  v_cndmask_b32 v4, 0, v4, vcc
  s_waitcnt vmcnt(11) lgkmcnt(6)
  v_mfma_f32_32x32x16_bf16 v[148:163], v[212:215], v[112:115], v[148:163]
  v_mfma_f32_32x32x16_bf16 v[164:179], v[216:219], v[112:115], v[164:179]
  v_mfma_f32_32x32x16_bf16 v[180:195], v[220:223], v[112:115], v[180:195]
  s_add_u32 s100, s100, 4096
  s_addc_u32 s101, s101, 0
  s_add_u32 m0, s76, 4096
  s_nop 0
  global_load_lds_dwordx4 v2, s[100:101] offset:0 sc1
  ds_read_b128 v[212:215], v237 offset:27648
  ds_read_b128 v[216:219], v238 offset:27648
  ds_read_b128 v[220:223], v13 offset:27648
  s_waitcnt vmcnt(11) lgkmcnt(6)
  v_mfma_f32_32x32x16_bf16 v[148:163], v[224:227], v[116:119], v[148:163]
  v_mfma_f32_32x32x16_bf16 v[164:179], v[228:231], v[116:119], v[164:179]
  v_mfma_f32_32x32x16_bf16 v[180:195], v[232:235], v[116:119], v[180:195]
  global_load_lds_dwordx4 v2, s[100:101] offset:1024 sc1
  ds_read_b128 v[224:227], v237 offset:28672
  ds_read_b128 v[228:231], v238 offset:28672
  ds_read_b128 v[232:235], v13 offset:28672
  s_waitcnt vmcnt(11) lgkmcnt(6)
  v_mfma_f32_32x32x16_bf16 v[148:163], v[128:131], v[120:123], v[148:163]
  v_mfma_f32_32x32x16_bf16 v[164:179], v[132:135], v[120:123], v[164:179]
  v_mfma_f32_32x32x16_bf16 v[180:195], v[136:139], v[120:123], v[180:195]
  global_load_lds_dwordx4 v2, s[100:101] offset:2048 sc1
  ds_read_b128 v[128:131], v237 offset:29696
  ds_read_b128 v[132:135], v238 offset:29696
  ds_read_b128 v[136:139], v13 offset:29696
  s_waitcnt vmcnt(11) lgkmcnt(6)
  v_mfma_f32_32x32x16_bf16 v[148:163], v[212:215], v[124:127], v[148:163]
  v_mfma_f32_32x32x16_bf16 v[164:179], v[216:219], v[124:127], v[164:179]
  v_mfma_f32_32x32x16_bf16 v[180:195], v[220:223], v[124:127], v[180:195]
  global_load_lds_dwordx4 v2, s[100:101] offset:3072 sc1
  ds_read_b128 v[212:215], v237 offset:30720
  ds_read_b128 v[216:219], v238 offset:30720
  ds_read_b128 v[220:223], v13 offset:30720
  s_waitcnt vmcnt(11) lgkmcnt(6)
  v_mfma_f32_32x32x16_bf16 v[148:163], v[224:227], a[240:243], v[148:163]
  v_mfma_f32_32x32x16_bf16 v[164:179], v[228:231], a[240:243], v[164:179]
  v_mfma_f32_32x32x16_bf16 v[180:195], v[232:235], a[240:243], v[180:195]
  ds_read_b128 v[224:227], v237 offset:31744
  ds_read_b128 v[228:231], v238 offset:31744
  ds_read_b128 v[232:235], v13 offset:31744
  s_waitcnt vmcnt(10) lgkmcnt(6)
  v_mfma_f32_32x32x16_bf16 v[148:163], v[128:131], a[244:247], v[148:163]
  v_mfma_f32_32x32x16_bf16 v[164:179], v[132:135], a[244:247], v[164:179]
  v_mfma_f32_32x32x16_bf16 v[180:195], v[136:139], a[244:247], v[180:195]
  s_waitcnt vmcnt(9) lgkmcnt(3)
  v_mfma_f32_32x32x16_bf16 v[148:163], v[212:215], a[248:251], v[148:163]
  v_mfma_f32_32x32x16_bf16 v[164:179], v[216:219], a[248:251], v[164:179]
  v_mfma_f32_32x32x16_bf16 v[180:195], v[220:223], a[248:251], v[180:195]
  s_waitcnt vmcnt(8) lgkmcnt(0)
  v_mfma_f32_32x32x16_bf16 v[148:163], v[224:227], a[252:255], v[148:163]
  v_mfma_f32_32x32x16_bf16 v[164:179], v[228:231], a[252:255], v[164:179]
  v_mfma_f32_32x32x16_bf16 v[180:195], v[232:235], a[252:255], v[180:195]
  ds_read_b128 v[212:215], v14 offset:0
  ds_read_b128 v[216:219], v14 offset:1024
  ds_read_b128 v[220:223], v14 offset:2048
  s_waitcnt lgkmcnt(0)
  v_mfma_f32_32x32x16_bf16 v[148:163], v[212:215], v[4:7], v[148:163]
  v_mfma_f32_32x32x16_bf16 v[164:179], v[216:219], v[4:7], v[164:179]
  v_mfma_f32_32x32x16_bf16 v[180:195], v[220:223], v[4:7], v[180:195]
  s_waitcnt vmcnt(0)
  s_barrier
  v_add_u32 v237, 98304, v2
  ds_read_b128 v[252:255], v14 offset:3072
  ds_read_b128 v[212:215], v237 offset:0
  ds_read_b128 v[216:219], v237 offset:1024
  ds_read_b128 v[220:223], v237 offset:2048
  ds_read_b128 v[224:227], v237 offset:3072
  ds_read_b128 v[228:231], v237 offset:4096
  ds_read_b128 v[232:235], v237 offset:5120
  s_waitcnt lgkmcnt(4)
  v_mfma_f32_32x32x16_bf16 v[196:211], v[212:215], v[16:19], 0
  ds_read_b128 v[212:215], v237 offset:6144
  v_mfma_f32_32x32x16_bf16 v[196:211], v[216:219], v[20:23], v[196:211]
  ds_read_b128 v[216:219], v237 offset:7168
  s_mul_i32 s40, s38, 7
  s_add_u32 s40, s40, 4
  s_lshl_b32 s40, s40, 15
  s_lshl_b32 s41, s32, 13
  s_add_u32 s40, s40, s41
  s_add_u32 s40, s40, 7340032
  s_add_u32 s100, s30, s40
  s_addc_u32 s101, s31, 0
  s_add_u32 s76, s41, 0
  s_mov_b32 m0, s76
  s_nop 0
  global_load_lds_dwordx4 v2, s[100:101] offset:0 sc1
  v_mul_f32 v128, v239, v148
  v_mul_f32 v129, v239, v149
  v_mul_f32 v130, v239, v150
  v_mul_f32 v131, v239, v151
  s_waitcnt lgkmcnt(4)
  v_mfma_f32_32x32x16_bf16 v[196:211], v[220:223], v[24:27], v[196:211]
  ds_read_b128 v[220:223], v237 offset:8192
  v_mul_f32 v132, v239, v152
  v_mul_f32 v133, v239, v153
  v_mul_f32 v134, v239, v154
  v_mul_f32 v135, v239, v155
  v_mfma_f32_32x32x16_bf16 v[196:211], v[224:227], v[28:31], v[196:211]
  ds_read_b128 v[224:227], v237 offset:9216
  global_load_lds_dwordx4 v2, s[100:101] offset:1024 sc1
  v_exp_f32 v128, v128
  v_exp_f32 v129, v129
  v_exp_f32 v130, v130
  v_exp_f32 v131, v131
  s_waitcnt lgkmcnt(4)
  v_mfma_f32_32x32x16_bf16 v[196:211], v[228:231], v[32:35], v[196:211]
  ds_read_b128 v[228:231], v237 offset:10240
  v_exp_f32 v132, v132
  v_exp_f32 v133, v133
  v_exp_f32 v134, v134
  v_exp_f32 v135, v135
  v_mfma_f32_32x32x16_bf16 v[196:211], v[232:235], v[36:39], v[196:211]
  ds_read_b128 v[232:235], v237 offset:11264
  global_load_lds_dwordx4 v2, s[100:101] offset:2048 sc1
  v_mul_f32 v136, v148, v156
  v_mul_f32 v137, v149, v157
  v_mul_f32 v138, v150, v158
  v_mul_f32 v139, v151, v159
  s_waitcnt lgkmcnt(4)
  v_mfma_f32_32x32x16_bf16 v[196:211], v[212:215], v[40:43], v[196:211]
  ds_read_b128 v[212:215], v237 offset:12288
  v_mul_f32 v140, v152, v160
  v_mul_f32 v141, v153, v161
  v_mul_f32 v142, v154, v162
  v_mul_f32 v143, v155, v163
  v_mfma_f32_32x32x16_bf16 v[196:211], v[216:219], v[44:47], v[196:211]
  ds_read_b128 v[216:219], v237 offset:13312
  global_load_lds_dwordx4 v2, s[100:101] offset:3072 sc1
  v_add_f32 v128, 1.0, v128
  v_add_f32 v129, 1.0, v129
  v_add_f32 v130, 1.0, v130
  v_add_f32 v131, 1.0, v131
  s_waitcnt lgkmcnt(4)
  v_mfma_f32_32x32x16_bf16 v[196:211], v[220:223], v[48:51], v[196:211]
  ds_read_b128 v[220:223], v237 offset:14336
  v_add_f32 v132, 1.0, v132
  v_add_f32 v133, 1.0, v133
  v_add_f32 v134, 1.0, v134
  v_add_f32 v135, 1.0, v135
  v_mfma_f32_32x32x16_bf16 v[196:211], v[224:227], v[52:55], v[196:211]
  ds_read_b128 v[224:227], v237 offset:15360
  s_add_u32 s100, s100, 4096
  s_addc_u32 s101, s101, 0
  s_add_u32 m0, s76, 4096
  s_nop 0
  global_load_lds_dwordx4 v2, s[100:101] offset:0 sc1
  v_rcp_f32 v128, v128
  v_rcp_f32 v129, v129
  v_rcp_f32 v130, v130
  v_rcp_f32 v131, v131
  s_waitcnt lgkmcnt(4)
  v_mfma_f32_32x32x16_bf16 v[196:211], v[228:231], v[56:59], v[196:211]
  ds_read_b128 v[228:231], v237 offset:16384
  v_rcp_f32 v132, v132
  v_rcp_f32 v133, v133
  v_rcp_f32 v134, v134
  v_rcp_f32 v135, v135
  v_mfma_f32_32x32x16_bf16 v[196:211], v[232:235], v[60:63], v[196:211]
  ds_read_b128 v[232:235], v237 offset:17408
  global_load_lds_dwordx4 v2, s[100:101] offset:1024 sc1
  v_mul_f32 v136, v136, v15
  v_mul_f32 v137, v137, v15
  v_mul_f32 v138, v138, v15
  v_mul_f32 v139, v139, v15
  s_waitcnt lgkmcnt(4)
  v_mfma_f32_32x32x16_bf16 v[196:211], v[212:215], v[64:67], v[196:211]
  ds_read_b128 v[212:215], v237 offset:18432
  v_mul_f32 v140, v140, v15
  v_mul_f32 v141, v141, v15
  v_mul_f32 v142, v142, v15
  v_mul_f32 v143, v143, v15
  v_mfma_f32_32x32x16_bf16 v[196:211], v[216:219], v[68:71], v[196:211]
  ds_read_b128 v[216:219], v237 offset:19456
  global_load_lds_dwordx4 v2, s[100:101] offset:2048 sc1
  v_mul_f32 v128, v128, v136
  v_mul_f32 v129, v129, v137
  v_mul_f32 v130, v130, v138
  v_mul_f32 v131, v131, v139
  s_waitcnt lgkmcnt(4)
  v_mfma_f32_32x32x16_bf16 v[196:211], v[220:223], v[72:75], v[196:211]
  ds_read_b128 v[220:223], v237 offset:20480
  v_mul_f32 v132, v132, v140
  v_mul_f32 v133, v133, v141
  v_mul_f32 v134, v134, v142
  v_mul_f32 v135, v135, v143
  v_mfma_f32_32x32x16_bf16 v[196:211], v[224:227], v[76:79], v[196:211]
  ds_read_b128 v[224:227], v237 offset:21504
  global_load_lds_dwordx4 v2, s[100:101] offset:3072 sc1
  v_cvt_pk_bf16_f32 v144, v128, v129
  v_cvt_pk_bf16_f32 v145, v130, v131
  v_cvt_pk_bf16_f32 v146, v132, v133
  v_cvt_pk_bf16_f32 v147, v134, v135
  s_waitcnt lgkmcnt(4)
  v_mfma_f32_32x32x16_bf16 v[196:211], v[228:231], v[80:83], v[196:211]
  ds_read_b128 v[228:231], v237 offset:22528
  global_store_dwordx4 v236, v[144:147], s[30:31] offset:0 sc1
  v_mul_f32 v128, v239, v164
  v_mul_f32 v129, v239, v165
  v_mul_f32 v130, v239, v166
  v_mfma_f32_32x32x16_bf16 v[196:211], v[232:235], v[84:87], v[196:211]
  ds_read_b128 v[232:235], v237 offset:23552
  s_mul_i32 s40, s38, 7
  s_add_u32 s40, s40, 5
  s_lshl_b32 s40, s40, 15
  s_lshl_b32 s41, s32, 13
  s_add_u32 s40, s40, s41
  s_add_u32 s40, s40, 7340032
  s_add_u32 s100, s30, s40
  s_addc_u32 s101, s31, 0
  s_add_u32 s76, s41, 65536
  s_mov_b32 m0, s76
  s_nop 0
  global_load_lds_dwordx4 v2, s[100:101] offset:0 sc1
  v_mul_f32 v131, v239, v167
  v_mul_f32 v132, v239, v168
  v_mul_f32 v133, v239, v169
  v_mul_f32 v134, v239, v170
  s_waitcnt lgkmcnt(4)
  v_mfma_f32_32x32x16_bf16 v[196:211], v[212:215], v[88:91], v[196:211]
  ds_read_b128 v[212:215], v237 offset:24576
  v_mul_f32 v135, v239, v171
  v_exp_f32 v128, v128
  v_exp_f32 v129, v129
  v_exp_f32 v130, v130
  v_mfma_f32_32x32x16_bf16 v[196:211], v[216:219], v[92:95], v[196:211]
  ds_read_b128 v[216:219], v237 offset:25600
  global_load_lds_dwordx4 v2, s[100:101] offset:1024 sc1
  v_exp_f32 v131, v131
  v_exp_f32 v132, v132
  v_exp_f32 v133, v133
  v_exp_f32 v134, v134
  s_waitcnt lgkmcnt(4)
  v_mfma_f32_32x32x16_bf16 v[196:211], v[220:223], v[96:99], v[196:211]
  ds_read_b128 v[220:223], v237 offset:26624
  v_exp_f32 v135, v135
  v_mul_f32 v136, v164, v172
  v_mul_f32 v137, v165, v173
  v_mul_f32 v138, v166, v174
  v_mfma_f32_32x32x16_bf16 v[196:211], v[224:227], v[100:103], v[196:211]
  ds_read_b128 v[224:227], v237 offset:27648
  global_load_lds_dwordx4 v2, s[100:101] offset:2048 sc1
  v_mul_f32 v139, v167, v175
  v_mul_f32 v140, v168, v176
  v_mul_f32 v141, v169, v177
  v_mul_f32 v142, v170, v178
  s_waitcnt lgkmcnt(4)
  v_mfma_f32_32x32x16_bf16 v[196:211], v[228:231], v[104:107], v[196:211]
  ds_read_b128 v[228:231], v237 offset:28672
  v_mul_f32 v143, v171, v179
  v_add_f32 v128, 1.0, v128
  v_add_f32 v129, 1.0, v129
  v_add_f32 v130, 1.0, v130
  v_mfma_f32_32x32x16_bf16 v[196:211], v[232:235], v[108:111], v[196:211]
  ds_read_b128 v[232:235], v237 offset:29696
  global_load_lds_dwordx4 v2, s[100:101] offset:3072 sc1
  v_add_f32 v131, 1.0, v131
  v_add_f32 v132, 1.0, v132
  v_add_f32 v133, 1.0, v133
  v_add_f32 v134, 1.0, v134
  s_waitcnt lgkmcnt(4)
  v_mfma_f32_32x32x16_bf16 v[196:211], v[212:215], v[112:115], v[196:211]
  ds_read_b128 v[212:215], v237 offset:30720
  v_add_f32 v135, 1.0, v135
  v_rcp_f32 v128, v128
  v_rcp_f32 v129, v129
  v_rcp_f32 v130, v130
  v_mfma_f32_32x32x16_bf16 v[196:211], v[216:219], v[116:119], v[196:211]
  ds_read_b128 v[216:219], v237 offset:31744
  s_add_u32 s100, s100, 4096
  s_addc_u32 s101, s101, 0
  s_add_u32 m0, s76, 4096
  s_nop 0
  global_load_lds_dwordx4 v2, s[100:101] offset:0 sc1
  v_rcp_f32 v131, v131
  v_rcp_f32 v132, v132
  v_rcp_f32 v133, v133
  v_rcp_f32 v134, v134
  s_waitcnt lgkmcnt(4)
  v_mfma_f32_32x32x16_bf16 v[196:211], v[220:223], v[120:123], v[196:211]
  v_rcp_f32 v135, v135
  v_mul_f32 v136, v136, v15
  v_mul_f32 v137, v137, v15
  v_mul_f32 v138, v138, v15
  v_mfma_f32_32x32x16_bf16 v[196:211], v[224:227], v[124:127], v[196:211]
  global_load_lds_dwordx4 v2, s[100:101] offset:1024 sc1
  v_mul_f32 v139, v139, v15
  v_mul_f32 v140, v140, v15
  v_mul_f32 v141, v141, v15
  v_mul_f32 v142, v142, v15
  s_waitcnt lgkmcnt(2)
  v_mfma_f32_32x32x16_bf16 v[196:211], v[228:231], a[240:243], v[196:211]
  v_mul_f32 v143, v143, v15
  v_mul_f32 v128, v128, v136
  v_mul_f32 v129, v129, v137
  v_mul_f32 v130, v130, v138
  v_mfma_f32_32x32x16_bf16 v[196:211], v[232:235], a[244:247], v[196:211]
  global_load_lds_dwordx4 v2, s[100:101] offset:2048 sc1
  v_mul_f32 v131, v131, v139
  v_mul_f32 v132, v132, v140
  v_mul_f32 v133, v133, v141
  v_mul_f32 v134, v134, v142
  s_waitcnt lgkmcnt(0)
  v_mfma_f32_32x32x16_bf16 v[196:211], v[212:215], a[248:251], v[196:211]
  v_mul_f32 v135, v135, v143
  v_cvt_pk_bf16_f32 v144, v128, v129
  v_cvt_pk_bf16_f32 v145, v130, v131
  v_mfma_f32_32x32x16_bf16 v[196:211], v[216:219], a[252:255], v[196:211]
  global_load_lds_dwordx4 v2, s[100:101] offset:3072 sc1
  v_cvt_pk_bf16_f32 v146, v132, v133
  v_cvt_pk_bf16_f32 v147, v134, v135
  global_store_dwordx4 v236, v[144:147], s[30:31] offset:1024 sc1
  v_mfma_f32_32x32x16_bf16 v[196:211], v[252:255], v[4:7], v[196:211]
  s_waitcnt vmcnt(10)
  s_barrier
  v_add_u32 v237, 0, v2
  ds_read_b128 v[252:255], v14 offset:4096
  ds_read_b128 v[212:215], v237 offset:0
  ds_read_b128 v[216:219], v237 offset:1024
  ds_read_b128 v[220:223], v237 offset:2048
  ds_read_b128 v[224:227], v237 offset:3072
  ds_read_b128 v[228:231], v237 offset:4096
  ds_read_b128 v[232:235], v237 offset:5120
  s_waitcnt lgkmcnt(4)
  v_mfma_f32_32x32x16_bf16 v[148:163], v[212:215], v[16:19], 0
  ds_read_b128 v[212:215], v237 offset:6144
  v_mfma_f32_32x32x16_bf16 v[148:163], v[216:219], v[20:23], v[148:163]
  ds_read_b128 v[216:219], v237 offset:7168
  s_mul_i32 s40, s38, 7
  s_add_u32 s40, s40, 6
  s_lshl_b32 s40, s40, 15
  s_lshl_b32 s41, s32, 13
  s_add_u32 s40, s40, s41
  s_add_u32 s40, s40, 7340032
  s_add_u32 s100, s30, s40
  s_addc_u32 s101, s31, 0
  s_add_u32 s76, s41, 32768
  s_mov_b32 m0, s76
  s_nop 0
  global_load_lds_dwordx4 v2, s[100:101] offset:0 sc1
  v_mul_f32 v128, v239, v180
  v_mul_f32 v129, v239, v181
  v_mul_f32 v130, v239, v182
  v_mul_f32 v131, v239, v183
  s_waitcnt lgkmcnt(4)
  v_mfma_f32_32x32x16_bf16 v[148:163], v[220:223], v[24:27], v[148:163]
  ds_read_b128 v[220:223], v237 offset:8192
  v_mul_f32 v132, v239, v184
  v_mul_f32 v133, v239, v185
  v_mul_f32 v134, v239, v186
  v_mul_f32 v135, v239, v187
  v_mfma_f32_32x32x16_bf16 v[148:163], v[224:227], v[28:31], v[148:163]
  ds_read_b128 v[224:227], v237 offset:9216
  global_load_lds_dwordx4 v2, s[100:101] offset:1024 sc1
  v_exp_f32 v128, v128
  v_exp_f32 v129, v129
  v_exp_f32 v130, v130
  v_exp_f32 v131, v131
  s_waitcnt lgkmcnt(4)
  v_mfma_f32_32x32x16_bf16 v[148:163], v[228:231], v[32:35], v[148:163]
  ds_read_b128 v[228:231], v237 offset:10240
  v_exp_f32 v132, v132
  v_exp_f32 v133, v133
  v_exp_f32 v134, v134
  v_exp_f32 v135, v135
  v_mfma_f32_32x32x16_bf16 v[148:163], v[232:235], v[36:39], v[148:163]
  ds_read_b128 v[232:235], v237 offset:11264
  global_load_lds_dwordx4 v2, s[100:101] offset:2048 sc1
  v_mul_f32 v136, v180, v188
  v_mul_f32 v137, v181, v189
  v_mul_f32 v138, v182, v190
  v_mul_f32 v139, v183, v191
  s_waitcnt lgkmcnt(4)
  v_mfma_f32_32x32x16_bf16 v[148:163], v[212:215], v[40:43], v[148:163]
  ds_read_b128 v[212:215], v237 offset:12288
  v_mul_f32 v140, v184, v192
  v_mul_f32 v141, v185, v193
  v_mul_f32 v142, v186, v194
  v_mul_f32 v143, v187, v195
  v_mfma_f32_32x32x16_bf16 v[148:163], v[216:219], v[44:47], v[148:163]
  ds_read_b128 v[216:219], v237 offset:13312
  global_load_lds_dwordx4 v2, s[100:101] offset:3072 sc1
  v_add_f32 v128, 1.0, v128
  v_add_f32 v129, 1.0, v129
  v_add_f32 v130, 1.0, v130
  v_add_f32 v131, 1.0, v131
  s_waitcnt lgkmcnt(4)
  v_mfma_f32_32x32x16_bf16 v[148:163], v[220:223], v[48:51], v[148:163]
  ds_read_b128 v[220:223], v237 offset:14336
  v_add_f32 v132, 1.0, v132
  v_add_f32 v133, 1.0, v133
  v_add_f32 v134, 1.0, v134
  v_add_f32 v135, 1.0, v135
  v_mfma_f32_32x32x16_bf16 v[148:163], v[224:227], v[52:55], v[148:163]
  ds_read_b128 v[224:227], v237 offset:15360
  s_add_u32 s100, s100, 4096
  s_addc_u32 s101, s101, 0
  s_add_u32 m0, s76, 4096
  s_nop 0
  global_load_lds_dwordx4 v2, s[100:101] offset:0 sc1
  v_rcp_f32 v128, v128
  v_rcp_f32 v129, v129
  v_rcp_f32 v130, v130
  v_rcp_f32 v131, v131
  s_waitcnt lgkmcnt(4)
  v_mfma_f32_32x32x16_bf16 v[148:163], v[228:231], v[56:59], v[148:163]
  ds_read_b128 v[228:231], v237 offset:16384
  v_rcp_f32 v132, v132
  v_rcp_f32 v133, v133
  v_rcp_f32 v134, v134
  v_rcp_f32 v135, v135
  v_mfma_f32_32x32x16_bf16 v[148:163], v[232:235], v[60:63], v[148:163]
  ds_read_b128 v[232:235], v237 offset:17408
  global_load_lds_dwordx4 v2, s[100:101] offset:1024 sc1
  v_mul_f32 v136, v136, v15
  v_mul_f32 v137, v137, v15
  v_mul_f32 v138, v138, v15
  v_mul_f32 v139, v139, v15
  s_waitcnt lgkmcnt(4)
  v_mfma_f32_32x32x16_bf16 v[148:163], v[212:215], v[64:67], v[148:163]
  ds_read_b128 v[212:215], v237 offset:18432
  v_mul_f32 v140, v140, v15
  v_mul_f32 v141, v141, v15
  v_mul_f32 v142, v142, v15
  v_mul_f32 v143, v143, v15
  v_mfma_f32_32x32x16_bf16 v[148:163], v[216:219], v[68:71], v[148:163]
  ds_read_b128 v[216:219], v237 offset:19456
  global_load_lds_dwordx4 v2, s[100:101] offset:2048 sc1
  v_mul_f32 v128, v128, v136
  v_mul_f32 v129, v129, v137
  v_mul_f32 v130, v130, v138
  v_mul_f32 v131, v131, v139
  s_waitcnt lgkmcnt(4)
  v_mfma_f32_32x32x16_bf16 v[148:163], v[220:223], v[72:75], v[148:163]
  ds_read_b128 v[220:223], v237 offset:20480
  v_mul_f32 v132, v132, v140
  v_mul_f32 v133, v133, v141
  v_mul_f32 v134, v134, v142
  v_mul_f32 v135, v135, v143
  v_mfma_f32_32x32x16_bf16 v[148:163], v[224:227], v[76:79], v[148:163]
  ds_read_b128 v[224:227], v237 offset:21504
  global_load_lds_dwordx4 v2, s[100:101] offset:3072 sc1
  v_cvt_pk_bf16_f32 v144, v128, v129
  v_cvt_pk_bf16_f32 v145, v130, v131
  v_cvt_pk_bf16_f32 v146, v132, v133
  v_cvt_pk_bf16_f32 v147, v134, v135
  s_waitcnt lgkmcnt(4)
  v_mfma_f32_32x32x16_bf16 v[148:163], v[228:231], v[80:83], v[148:163]
  ds_read_b128 v[228:231], v237 offset:22528
  global_store_dwordx4 v236, v[144:147], s[30:31] offset:2048 sc1
  v_mul_f32 v128, v239, v196
  v_mul_f32 v129, v239, v197
  v_mul_f32 v130, v239, v198
  v_mfma_f32_32x32x16_bf16 v[148:163], v[232:235], v[84:87], v[148:163]
  ds_read_b128 v[232:235], v237 offset:23552
  v_mul_f32 v131, v239, v199
  v_mul_f32 v132, v239, v200
  v_mul_f32 v133, v239, v201
  v_mul_f32 v134, v239, v202
  s_waitcnt lgkmcnt(4)
  v_mfma_f32_32x32x16_bf16 v[148:163], v[212:215], v[88:91], v[148:163]
  ds_read_b128 v[212:215], v237 offset:24576
  v_mul_f32 v135, v239, v203
  v_exp_f32 v128, v128
  v_exp_f32 v129, v129
  v_exp_f32 v130, v130
  v_mfma_f32_32x32x16_bf16 v[148:163], v[216:219], v[92:95], v[148:163]
  ds_read_b128 v[216:219], v237 offset:25600
  v_exp_f32 v131, v131
  v_exp_f32 v132, v132
  v_exp_f32 v133, v133
  v_exp_f32 v134, v134
  s_waitcnt lgkmcnt(4)
  v_mfma_f32_32x32x16_bf16 v[148:163], v[220:223], v[96:99], v[148:163]
  ds_read_b128 v[220:223], v237 offset:26624
  v_exp_f32 v135, v135
  v_mul_f32 v136, v196, v204
  v_mul_f32 v137, v197, v205
  v_mul_f32 v138, v198, v206
  v_mfma_f32_32x32x16_bf16 v[148:163], v[224:227], v[100:103], v[148:163]
  ds_read_b128 v[224:227], v237 offset:27648
  v_mul_f32 v139, v199, v207
  v_mul_f32 v140, v200, v208
  v_mul_f32 v141, v201, v209
  v_mul_f32 v142, v202, v210
  s_waitcnt lgkmcnt(4)
  v_mfma_f32_32x32x16_bf16 v[148:163], v[228:231], v[104:107], v[148:163]
  ds_read_b128 v[228:231], v237 offset:28672
  v_mul_f32 v143, v203, v211
  v_add_f32 v128, 1.0, v128
  v_add_f32 v129, 1.0, v129
  v_add_f32 v130, 1.0, v130
  v_mfma_f32_32x32x16_bf16 v[148:163], v[232:235], v[108:111], v[148:163]
  ds_read_b128 v[232:235], v237 offset:29696
  v_add_f32 v131, 1.0, v131
  v_add_f32 v132, 1.0, v132
  v_add_f32 v133, 1.0, v133
  v_add_f32 v134, 1.0, v134
  s_waitcnt lgkmcnt(4)
  v_mfma_f32_32x32x16_bf16 v[148:163], v[212:215], v[112:115], v[148:163]
  ds_read_b128 v[212:215], v237 offset:30720
  v_add_f32 v135, 1.0, v135
  v_rcp_f32 v128, v128
  v_rcp_f32 v129, v129
  v_rcp_f32 v130, v130
  v_mfma_f32_32x32x16_bf16 v[148:163], v[216:219], v[116:119], v[148:163]
  ds_read_b128 v[216:219], v237 offset:31744
  v_rcp_f32 v131, v131
  v_rcp_f32 v132, v132
  v_rcp_f32 v133, v133
  v_rcp_f32 v134, v134
  s_waitcnt lgkmcnt(4)
  v_mfma_f32_32x32x16_bf16 v[148:163], v[220:223], v[120:123], v[148:163]
  v_rcp_f32 v135, v135
  v_mul_f32 v136, v136, v15
  v_mul_f32 v137, v137, v15
  v_mul_f32 v138, v138, v15
  v_mfma_f32_32x32x16_bf16 v[148:163], v[224:227], v[124:127], v[148:163]
  v_mul_f32 v139, v139, v15
  v_mul_f32 v140, v140, v15
  v_mul_f32 v141, v141, v15
  v_mul_f32 v142, v142, v15
  s_waitcnt lgkmcnt(2)
  v_mfma_f32_32x32x16_bf16 v[148:163], v[228:231], a[240:243], v[148:163]
  v_mul_f32 v143, v143, v15
  v_mul_f32 v128, v128, v136
  v_mul_f32 v129, v129, v137
  v_mul_f32 v130, v130, v138
  v_mfma_f32_32x32x16_bf16 v[148:163], v[232:235], a[244:247], v[148:163]
  v_mul_f32 v131, v131, v139
  v_mul_f32 v132, v132, v140
  v_mul_f32 v133, v133, v141
  v_mul_f32 v134, v134, v142
  s_waitcnt lgkmcnt(0)
  v_mfma_f32_32x32x16_bf16 v[148:163], v[212:215], a[248:251], v[148:163]
  v_mul_f32 v135, v135, v143
  v_cvt_pk_bf16_f32 v144, v128, v129
  v_cvt_pk_bf16_f32 v145, v130, v131
  v_cvt_pk_bf16_f32 v146, v132, v133
  v_mfma_f32_32x32x16_bf16 v[148:163], v[216:219], a[252:255], v[148:163]
  v_cvt_pk_bf16_f32 v147, v134, v135
  global_store_dwordx4 v236, v[144:147], s[30:31] offset:3072 sc1
  v_add_u32 v236, 4096, v236
  v_mfma_f32_32x32x16_bf16 v[148:163], v[252:255], v[4:7], v[148:163]
  s_waitcnt vmcnt(11)
  s_barrier
  v_add_u32 v237, 65536, v2
  ds_read_b128 v[252:255], v14 offset:5120
  ds_read_b128 v[212:215], v237 offset:0
  ds_read_b128 v[216:219], v237 offset:1024
  ds_read_b128 v[220:223], v237 offset:2048
  ds_read_b128 v[224:227], v237 offset:3072
  ds_read_b128 v[228:231], v237 offset:4096
  ds_read_b128 v[232:235], v237 offset:5120
  s_waitcnt lgkmcnt(4)
  v_mfma_f32_32x32x16_bf16 v[164:179], v[212:215], v[16:19], 0
  ds_read_b128 v[212:215], v237 offset:6144
  v_mfma_f32_32x32x16_bf16 v[164:179], v[216:219], v[20:23], v[164:179]
  ds_read_b128 v[216:219], v237 offset:7168
  v_mul_f32 v128, v239, v148
  v_mul_f32 v129, v239, v149
  s_waitcnt lgkmcnt(4)
  v_mfma_f32_32x32x16_bf16 v[164:179], v[220:223], v[24:27], v[164:179]
  ds_read_b128 v[220:223], v237 offset:8192
  v_mul_f32 v130, v239, v150
  v_mul_f32 v131, v239, v151
  v_mfma_f32_32x32x16_bf16 v[164:179], v[224:227], v[28:31], v[164:179]
  ds_read_b128 v[224:227], v237 offset:9216
  v_mul_f32 v132, v239, v152
  v_mul_f32 v133, v239, v153
  s_waitcnt lgkmcnt(4)
  v_mfma_f32_32x32x16_bf16 v[164:179], v[228:231], v[32:35], v[164:179]
  ds_read_b128 v[228:231], v237 offset:10240
  v_mul_f32 v134, v239, v154
  v_mul_f32 v135, v239, v155
  v_mfma_f32_32x32x16_bf16 v[164:179], v[232:235], v[36:39], v[164:179]
  ds_read_b128 v[232:235], v237 offset:11264
  v_exp_f32 v128, v128
  v_exp_f32 v129, v129
  s_waitcnt lgkmcnt(4)
  v_mfma_f32_32x32x16_bf16 v[164:179], v[212:215], v[40:43], v[164:179]
  ds_read_b128 v[212:215], v237 offset:12288
  v_exp_f32 v130, v130
  v_exp_f32 v131, v131
  v_mfma_f32_32x32x16_bf16 v[164:179], v[216:219], v[44:47], v[164:179]
  ds_read_b128 v[216:219], v237 offset:13312
  v_exp_f32 v132, v132
  v_exp_f32 v133, v133
  s_waitcnt lgkmcnt(4)
  v_mfma_f32_32x32x16_bf16 v[164:179], v[220:223], v[48:51], v[164:179]
  ds_read_b128 v[220:223], v237 offset:14336
  v_exp_f32 v134, v134
  v_exp_f32 v135, v135
  v_mfma_f32_32x32x16_bf16 v[164:179], v[224:227], v[52:55], v[164:179]
  ds_read_b128 v[224:227], v237 offset:15360
  v_mul_f32 v136, v148, v156
  v_mul_f32 v137, v149, v157
  s_waitcnt lgkmcnt(4)
  v_mfma_f32_32x32x16_bf16 v[164:179], v[228:231], v[56:59], v[164:179]
  ds_read_b128 v[228:231], v237 offset:16384
  v_mul_f32 v138, v150, v158
  v_mul_f32 v139, v151, v159
  v_mfma_f32_32x32x16_bf16 v[164:179], v[232:235], v[60:63], v[164:179]
  ds_read_b128 v[232:235], v237 offset:17408
  v_mul_f32 v140, v152, v160
  v_mul_f32 v141, v153, v161
  s_waitcnt lgkmcnt(4)
  v_mfma_f32_32x32x16_bf16 v[164:179], v[212:215], v[64:67], v[164:179]
  ds_read_b128 v[212:215], v237 offset:18432
  v_mul_f32 v142, v154, v162
  v_mul_f32 v143, v155, v163
  v_mfma_f32_32x32x16_bf16 v[164:179], v[216:219], v[68:71], v[164:179]
  ds_read_b128 v[216:219], v237 offset:19456
  v_add_f32 v128, 1.0, v128
  v_add_f32 v129, 1.0, v129
  s_waitcnt lgkmcnt(4)
  v_mfma_f32_32x32x16_bf16 v[164:179], v[220:223], v[72:75], v[164:179]
  ds_read_b128 v[220:223], v237 offset:20480
  v_add_f32 v130, 1.0, v130
  v_add_f32 v131, 1.0, v131
  v_mfma_f32_32x32x16_bf16 v[164:179], v[224:227], v[76:79], v[164:179]
  ds_read_b128 v[224:227], v237 offset:21504
  v_add_f32 v132, 1.0, v132
  v_add_f32 v133, 1.0, v133
  s_waitcnt lgkmcnt(4)
  v_mfma_f32_32x32x16_bf16 v[164:179], v[228:231], v[80:83], v[164:179]
  ds_read_b128 v[228:231], v237 offset:22528
  v_add_f32 v134, 1.0, v134
  v_add_f32 v135, 1.0, v135
  v_mfma_f32_32x32x16_bf16 v[164:179], v[232:235], v[84:87], v[164:179]
  ds_read_b128 v[232:235], v237 offset:23552
  v_rcp_f32 v128, v128
  v_rcp_f32 v129, v129
  s_waitcnt lgkmcnt(4)
  v_mfma_f32_32x32x16_bf16 v[164:179], v[212:215], v[88:91], v[164:179]
  ds_read_b128 v[212:215], v237 offset:24576
  v_rcp_f32 v130, v130
  v_rcp_f32 v131, v131
  v_mfma_f32_32x32x16_bf16 v[164:179], v[216:219], v[92:95], v[164:179]
  ds_read_b128 v[216:219], v237 offset:25600
  v_rcp_f32 v132, v132
  v_rcp_f32 v133, v133
  s_waitcnt lgkmcnt(4)
  v_mfma_f32_32x32x16_bf16 v[164:179], v[220:223], v[96:99], v[164:179]
  ds_read_b128 v[220:223], v237 offset:26624
  v_rcp_f32 v134, v134
  v_rcp_f32 v135, v135
  v_mfma_f32_32x32x16_bf16 v[164:179], v[224:227], v[100:103], v[164:179]
  ds_read_b128 v[224:227], v237 offset:27648
  v_mul_f32 v136, v136, v15
  v_mul_f32 v137, v137, v15
  s_waitcnt lgkmcnt(4)
  v_mfma_f32_32x32x16_bf16 v[164:179], v[228:231], v[104:107], v[164:179]
  ds_read_b128 v[228:231], v237 offset:28672
  v_mul_f32 v138, v138, v15
  v_mul_f32 v139, v139, v15
  v_mfma_f32_32x32x16_bf16 v[164:179], v[232:235], v[108:111], v[164:179]
  ds_read_b128 v[232:235], v237 offset:29696
  v_mul_f32 v140, v140, v15
  v_mul_f32 v141, v141, v15
  s_waitcnt lgkmcnt(4)
  v_mfma_f32_32x32x16_bf16 v[164:179], v[212:215], v[112:115], v[164:179]
  ds_read_b128 v[212:215], v237 offset:30720
  v_mul_f32 v142, v142, v15
  v_mul_f32 v143, v143, v15
  v_mfma_f32_32x32x16_bf16 v[164:179], v[216:219], v[116:119], v[164:179]
  ds_read_b128 v[216:219], v237 offset:31744
  v_mul_f32 v128, v128, v136
  v_mul_f32 v129, v129, v137
  s_waitcnt lgkmcnt(4)
  v_mfma_f32_32x32x16_bf16 v[164:179], v[220:223], v[120:123], v[164:179]
  v_mul_f32 v130, v130, v138
  v_mul_f32 v131, v131, v139
  v_mfma_f32_32x32x16_bf16 v[164:179], v[224:227], v[124:127], v[164:179]
  v_mul_f32 v132, v132, v140
  v_mul_f32 v133, v133, v141
  s_waitcnt lgkmcnt(2)
  v_mfma_f32_32x32x16_bf16 v[164:179], v[228:231], a[240:243], v[164:179]
  v_mul_f32 v134, v134, v142
  v_mul_f32 v135, v135, v143
  v_mfma_f32_32x32x16_bf16 v[164:179], v[232:235], a[244:247], v[164:179]
  v_cvt_pk_bf16_f32 v144, v128, v129
  v_cvt_pk_bf16_f32 v145, v130, v131
  s_waitcnt lgkmcnt(0)
  v_mfma_f32_32x32x16_bf16 v[164:179], v[212:215], a[248:251], v[164:179]
  v_cvt_pk_bf16_f32 v146, v132, v133
  v_cvt_pk_bf16_f32 v147, v134, v135
  v_mfma_f32_32x32x16_bf16 v[164:179], v[216:219], a[252:255], v[164:179]
  global_store_dwordx4 v236, v[144:147], s[30:31] offset:0 sc1
  v_mfma_f32_32x32x16_bf16 v[164:179], v[252:255], v[4:7], v[164:179]
  s_waitcnt vmcnt(1)
  s_barrier
  s_cmp_lg_u32 s32, 0
  s_cbranch_scc1 L_s4a_91
  s_lshl_b32 s40, s37, 7
  s_add_u32 s40, s40, 0
  v_mov_b32 v8, s40
  v_mov_b32 v9, 1
  s_mov_b64 exec, 1
  global_atomic_add v8, v9, s[30:31] sc1
  s_mov_b64 exec, -1
L_s4a_91:
  v_add_u32 v237, 32768, v2
  ds_read_b128 v[252:255], v14 offset:6144
  ds_read_b128 v[212:215], v237 offset:0
  ds_read_b128 v[216:219], v237 offset:1024
  ds_read_b128 v[220:223], v237 offset:2048
  ds_read_b128 v[224:227], v237 offset:3072
  ds_read_b128 v[228:231], v237 offset:4096
  ds_read_b128 v[232:235], v237 offset:5120
  s_waitcnt lgkmcnt(4)
  v_mfma_f32_32x32x16_bf16 v[180:195], v[212:215], v[16:19], 0
  ds_read_b128 v[212:215], v237 offset:6144
  v_mfma_f32_32x32x16_bf16 v[180:195], v[216:219], v[20:23], v[180:195]
  ds_read_b128 v[216:219], v237 offset:7168
  v_mul_f32 v128, v239, v164
  v_mul_f32 v129, v239, v165
  s_waitcnt lgkmcnt(4)
  v_mfma_f32_32x32x16_bf16 v[180:195], v[220:223], v[24:27], v[180:195]
  ds_read_b128 v[220:223], v237 offset:8192
  v_mul_f32 v130, v239, v166
  v_mul_f32 v131, v239, v167
  v_mfma_f32_32x32x16_bf16 v[180:195], v[224:227], v[28:31], v[180:195]
  ds_read_b128 v[224:227], v237 offset:9216
  v_mul_f32 v132, v239, v168
  v_mul_f32 v133, v239, v169
  s_waitcnt lgkmcnt(4)
  v_mfma_f32_32x32x16_bf16 v[180:195], v[228:231], v[32:35], v[180:195]
  ds_read_b128 v[228:231], v237 offset:10240
  v_mul_f32 v134, v239, v170
  v_mul_f32 v135, v239, v171
  v_mfma_f32_32x32x16_bf16 v[180:195], v[232:235], v[36:39], v[180:195]
  ds_read_b128 v[232:235], v237 offset:11264
  v_exp_f32 v128, v128
  v_exp_f32 v129, v129
  s_waitcnt lgkmcnt(4)
  v_mfma_f32_32x32x16_bf16 v[180:195], v[212:215], v[40:43], v[180:195]
  ds_read_b128 v[212:215], v237 offset:12288
  v_exp_f32 v130, v130
  v_exp_f32 v131, v131
  v_mfma_f32_32x32x16_bf16 v[180:195], v[216:219], v[44:47], v[180:195]
  ds_read_b128 v[216:219], v237 offset:13312
  v_exp_f32 v132, v132
  v_exp_f32 v133, v133
  s_waitcnt lgkmcnt(4)
  v_mfma_f32_32x32x16_bf16 v[180:195], v[220:223], v[48:51], v[180:195]
  ds_read_b128 v[220:223], v237 offset:14336
  v_exp_f32 v134, v134
  v_exp_f32 v135, v135
  v_mfma_f32_32x32x16_bf16 v[180:195], v[224:227], v[52:55], v[180:195]
  ds_read_b128 v[224:227], v237 offset:15360
  v_mul_f32 v136, v164, v172
  v_mul_f32 v137, v165, v173
  s_waitcnt lgkmcnt(4)
  v_mfma_f32_32x32x16_bf16 v[180:195], v[228:231], v[56:59], v[180:195]
  ds_read_b128 v[228:231], v237 offset:16384
  v_mul_f32 v138, v166, v174
  v_mul_f32 v139, v167, v175
  v_mfma_f32_32x32x16_bf16 v[180:195], v[232:235], v[60:63], v[180:195]
  ds_read_b128 v[232:235], v237 offset:17408
  v_mul_f32 v140, v168, v176
  v_mul_f32 v141, v169, v177
  s_waitcnt lgkmcnt(4)
  v_mfma_f32_32x32x16_bf16 v[180:195], v[212:215], v[64:67], v[180:195]
  ds_read_b128 v[212:215], v237 offset:18432
  v_mul_f32 v142, v170, v178
  v_mul_f32 v143, v171, v179
  v_mfma_f32_32x32x16_bf16 v[180:195], v[216:219], v[68:71], v[180:195]
  ds_read_b128 v[216:219], v237 offset:19456
  v_add_f32 v128, 1.0, v128
  v_add_f32 v129, 1.0, v129
  s_waitcnt lgkmcnt(4)
  v_mfma_f32_32x32x16_bf16 v[180:195], v[220:223], v[72:75], v[180:195]
  ds_read_b128 v[220:223], v237 offset:20480
  v_add_f32 v130, 1.0, v130
  v_add_f32 v131, 1.0, v131
  v_mfma_f32_32x32x16_bf16 v[180:195], v[224:227], v[76:79], v[180:195]
  ds_read_b128 v[224:227], v237 offset:21504
  v_add_f32 v132, 1.0, v132
  v_add_f32 v133, 1.0, v133
  s_waitcnt lgkmcnt(4)
  v_mfma_f32_32x32x16_bf16 v[180:195], v[228:231], v[80:83], v[180:195]
  ds_read_b128 v[228:231], v237 offset:22528
  v_add_f32 v134, 1.0, v134
  v_add_f32 v135, 1.0, v135
  v_mfma_f32_32x32x16_bf16 v[180:195], v[232:235], v[84:87], v[180:195]
  ds_read_b128 v[232:235], v237 offset:23552
  v_rcp_f32 v128, v128
  v_rcp_f32 v129, v129
  s_waitcnt lgkmcnt(4)
  v_mfma_f32_32x32x16_bf16 v[180:195], v[212:215], v[88:91], v[180:195]
  ds_read_b128 v[212:215], v237 offset:24576
  v_rcp_f32 v130, v130
  v_rcp_f32 v131, v131
  v_mfma_f32_32x32x16_bf16 v[180:195], v[216:219], v[92:95], v[180:195]
  ds_read_b128 v[216:219], v237 offset:25600
  v_rcp_f32 v132, v132
  v_rcp_f32 v133, v133
  s_waitcnt lgkmcnt(4)
  v_mfma_f32_32x32x16_bf16 v[180:195], v[220:223], v[96:99], v[180:195]
  ds_read_b128 v[220:223], v237 offset:26624
  v_rcp_f32 v134, v134
  v_rcp_f32 v135, v135
  v_mfma_f32_32x32x16_bf16 v[180:195], v[224:227], v[100:103], v[180:195]
  ds_read_b128 v[224:227], v237 offset:27648
  v_mul_f32 v136, v136, v15
  v_mul_f32 v137, v137, v15
  s_waitcnt lgkmcnt(4)
  v_mfma_f32_32x32x16_bf16 v[180:195], v[228:231], v[104:107], v[180:195]
  ds_read_b128 v[228:231], v237 offset:28672
  v_mul_f32 v138, v138, v15
  v_mul_f32 v139, v139, v15
  v_mfma_f32_32x32x16_bf16 v[180:195], v[232:235], v[108:111], v[180:195]
  ds_read_b128 v[232:235], v237 offset:29696
  v_mul_f32 v140, v140, v15
  v_mul_f32 v141, v141, v15
  s_waitcnt lgkmcnt(4)
  v_mfma_f32_32x32x16_bf16 v[180:195], v[212:215], v[112:115], v[180:195]
  ds_read_b128 v[212:215], v237 offset:30720
  v_mul_f32 v142, v142, v15
  v_mul_f32 v143, v143, v15
  v_mfma_f32_32x32x16_bf16 v[180:195], v[216:219], v[116:119], v[180:195]
  ds_read_b128 v[216:219], v237 offset:31744
  v_mul_f32 v128, v128, v136
  v_mul_f32 v129, v129, v137
  s_waitcnt lgkmcnt(4)
  v_mfma_f32_32x32x16_bf16 v[180:195], v[220:223], v[120:123], v[180:195]
  v_mul_f32 v130, v130, v138
  v_mul_f32 v131, v131, v139
  v_mfma_f32_32x32x16_bf16 v[180:195], v[224:227], v[124:127], v[180:195]
  v_mul_f32 v132, v132, v140
  v_mul_f32 v133, v133, v141
  s_waitcnt lgkmcnt(2)
  v_mfma_f32_32x32x16_bf16 v[180:195], v[228:231], a[240:243], v[180:195]
  v_mul_f32 v134, v134, v142
  v_mul_f32 v135, v135, v143
  v_mfma_f32_32x32x16_bf16 v[180:195], v[232:235], a[244:247], v[180:195]
  v_cvt_pk_bf16_f32 v248, v128, v129
  v_cvt_pk_bf16_f32 v249, v130, v131
  s_waitcnt lgkmcnt(0)
  v_mfma_f32_32x32x16_bf16 v[180:195], v[212:215], a[248:251], v[180:195]
  v_cvt_pk_bf16_f32 v250, v132, v133
  v_mfma_f32_32x32x16_bf16 v[180:195], v[216:219], a[252:255], v[180:195]
  v_cvt_pk_bf16_f32 v251, v134, v135
  v_mfma_f32_32x32x16_bf16 v[180:195], v[252:255], v[4:7], v[180:195]
  s_lshr_b32 s40, s35, 1
  s_lshl_b32 s40, s40, 7
  s_add_u32 s40, s40, 0
  v_mov_b32 v10, s40
  s_mov_b64 exec, 1
  global_load_dword v11, v10, s[30:31] sc1
  s_mov_b64 exec, -1
  s_nop 5
  v_mul_f32 v128, v239, v180
  v_mul_f32 v129, v239, v181
  v_mul_f32 v130, v239, v182
  v_mul_f32 v131, v239, v183
  v_mul_f32 v132, v239, v184
  v_mul_f32 v133, v239, v185
  v_mul_f32 v134, v239, v186
  v_mul_f32 v135, v239, v187
  v_exp_f32 v128, v128
  v_exp_f32 v129, v129
  v_exp_f32 v130, v130
  v_exp_f32 v131, v131
  v_exp_f32 v132, v132
  v_exp_f32 v133, v133
  v_exp_f32 v134, v134
  v_exp_f32 v135, v135
  v_mul_f32 v136, v180, v188
  v_mul_f32 v137, v181, v189
  v_mul_f32 v138, v182, v190
  v_mul_f32 v139, v183, v191
  v_mul_f32 v140, v184, v192
  v_mul_f32 v141, v185, v193
  v_mul_f32 v142, v186, v194
  v_mul_f32 v143, v187, v195
  v_add_f32 v128, 1.0, v128
  v_add_f32 v129, 1.0, v129
  v_add_f32 v130, 1.0, v130
  v_add_f32 v131, 1.0, v131
  v_add_f32 v132, 1.0, v132
  v_add_f32 v133, 1.0, v133
  v_add_f32 v134, 1.0, v134
  v_add_f32 v135, 1.0, v135
  v_rcp_f32 v128, v128
  v_rcp_f32 v129, v129
  v_rcp_f32 v130, v130
  v_rcp_f32 v131, v131
  v_rcp_f32 v132, v132
  v_rcp_f32 v133, v133
  v_rcp_f32 v134, v134
  v_rcp_f32 v135, v135
  v_mul_f32 v136, v136, v15
  v_mul_f32 v137, v137, v15
  v_mul_f32 v138, v138, v15
  v_mul_f32 v139, v139, v15
  v_mul_f32 v140, v140, v15
  v_mul_f32 v141, v141, v15
  v_mul_f32 v142, v142, v15
  v_mul_f32 v143, v143, v15
  v_mul_f32 v128, v128, v136
  v_mul_f32 v129, v129, v137
  v_mul_f32 v130, v130, v138
  v_mul_f32 v131, v131, v139
  v_mul_f32 v132, v132, v140
  v_mul_f32 v133, v133, v141
  v_mul_f32 v134, v134, v142
  v_mul_f32 v135, v135, v143
  v_cvt_pk_bf16_f32 v144, v128, v129
  v_cvt_pk_bf16_f32 v145, v130, v131
  v_cvt_pk_bf16_f32 v146, v132, v133
  v_cvt_pk_bf16_f32 v147, v134, v135
  global_store_dwordx4 v236, v[248:251], s[30:31] offset:1024 sc1
  global_store_dwordx4 v236, v[144:147], s[30:31] offset:2048 sc1
  s_mul_i32 s40, s35, 224
  s_mul_i32 s41, s32, 28
  s_add_u32 s40, s40, s41
  s_lshl_b32 s40, s40, 10
  s_add_u32 s40, s40, 11534336
  v_add_u32 v12, s40, v2
  v_add_u32 v13, 114688, v12
  s_waitcnt vmcnt(2)
  s_mov_b32 s92, 0
  s_mov_b64 exec, 1
L_s4ap_92:
  v_cmp_gt_u32 vcc, 16, v11
  s_cbranch_vccz L_s4aok_93
  s_add_u32 s92, s92, 1
  s_cmp_gt_u32 s92, 200000
  s_cbranch_scc1 L_s4atm_94
  global_load_dword v11, v10, s[30:31] sc1
  s_waitcnt vmcnt(0)
  s_branch L_s4ap_92
L_s4atm_94:
  v_mov_b32 v10, 32
  v_mov_b32 v11, 10
  global_store_dword v10, v11, s[28:29]
L_s4aok_93:
  s_mov_b64 exec, -1
  global_load_dwordx4 v[80:83], v12, s[30:31] offset:0 sc1
  global_load_dwordx4 v[84:87], v13, s[30:31] offset:0 sc1
  global_load_dwordx4 v[88:91], v12, s[30:31] offset:1024 sc1
  global_load_dwordx4 v[92:95], v13, s[30:31] offset:1024 sc1
  global_load_dwordx4 v[96:99], v12, s[30:31] offset:2048 sc1
  global_load_dwordx4 v[100:103], v13, s[30:31] offset:2048 sc1
  global_load_dwordx4 v[104:107], v12, s[30:31] offset:3072 sc1
  global_load_dwordx4 v[108:111], v13, s[30:31] offset:3072 sc1
  v_add_u32 v12, 7168, v12
  v_add_u32 v13, 7168, v13
  global_load_dwordx4 v[112:115], v12, s[30:31] offset:0 sc1
  global_load_dwordx4 v[116:119], v13, s[30:31] offset:0 sc1
  global_load_dwordx4 v[120:123], v12, s[30:31] offset:1024 sc1
  global_load_dwordx4 v[124:127], v13, s[30:31] offset:1024 sc1
  global_load_dwordx4 v[128:131], v12, s[30:31] offset:2048 sc1
  global_load_dwordx4 v[132:135], v13, s[30:31] offset:2048 sc1
  v_and_b32 v8, 31, v1
  v_lshrrev_b32 v9, 5, v1
  v_and_b32 v10, 7, v8
  v_xor_b32 v10, v10, v9
  v_lshlrev_b32 v8, 8, v8
  s_lshl_b32 s40, s32, 14
  s_add_u32 s40, s40, 98304
  v_add_u32 v8, s40, v8
  v_xor_b32 v9, 0, v10
  v_lshl_add_u32 v248, v9, 4, v8
  v_xor_b32 v9, 2, v10
  v_lshl_add_u32 v249, v9, 4, v8
  v_xor_b32 v9, 4, v10
  v_lshl_add_u32 v250, v9, 4, v8
  v_xor_b32 v9, 6, v10
  v_lshl_add_u32 v251, v9, 4, v8
  v_lshrrev_b32 v8, 2, v0
  v_and_b32 v9, 3, v0
  v_lshlrev_b32 v9, 2, v9
  v_and_b32 v10, 7, v8
  v_xor_b32 v9, v9, v10
  v_lshlrev_b32 v8, 8, v8
  v_add_u32 v8, 98304, v8
  v_xor_b32 v10, 0, v9
  v_lshl_add_u32 v177, v10, 4, v8
  v_xor_b32 v10, 1, v9
  v_lshl_add_u32 v178, v10, 4, v8
  v_xor_b32 v10, 2, v9
  v_lshl_add_u32 v179, v10, 4, v8
  v_xor_b32 v10, 3, v9
  v_lshl_add_u32 v180, v10, 4, v8
  v_lshlrev_b32 v160, 16, v240
  v_and_b32 v161, 0xffff0000, v240
  v_lshlrev_b32 v162, 16, v241
  v_and_b32 v163, 0xffff0000, v241
  v_lshlrev_b32 v164, 16, v242
  v_and_b32 v165, 0xffff0000, v242
  v_lshlrev_b32 v166, 16, v243
  v_and_b32 v167, 0xffff0000, v243
  v_lshlrev_b32 v168, 16, v244
  v_and_b32 v169, 0xffff0000, v244
  v_lshlrev_b32 v170, 16, v245
  v_and_b32 v171, 0xffff0000, v245
  v_lshlrev_b32 v172, 16, v246
  v_and_b32 v173, 0xffff0000, v246
  v_lshlrev_b32 v174, 16, v247
  v_and_b32 v175, 0xffff0000, v247
  v_accvgpr_read_b32 v224, a224
  v_accvgpr_read_b32 v225, a225
  v_accvgpr_read_b32 v226, a226
  v_accvgpr_read_b32 v227, a227
  v_accvgpr_read_b32 v228, a228
  v_accvgpr_read_b32 v229, a229
  v_accvgpr_read_b32 v230, a230
  v_accvgpr_read_b32 v231, a231
  v_accvgpr_read_b32 v232, a232
  v_accvgpr_read_b32 v233, a233
  v_accvgpr_read_b32 v234, a234
  v_accvgpr_read_b32 v235, a235
  v_accvgpr_read_b32 v236, a236
  v_accvgpr_read_b32 v237, a237
  v_accvgpr_read_b32 v238, a238
  v_accvgpr_read_b32 v239, a239
  v_lshrrev_b32 v8, 2, v0
  s_lshl_b32 s40, s35, 6
  v_add_u32 v8, s40, v8
  v_lshlrev_b32 v8, 10, v8
  v_and_b32 v9, 3, v0
  v_lshl_add_u32 v8, v9, 5, v8
  s_lshl_b32 s40, s36, 7
  v_add_u32 v176, s40, v8
  s_waitcnt vmcnt(12)
  s_barrier
  s_cmp_lg_u32 s32, 0
  s_cbranch_scc1 L_s4arr_95
  s_lshl_b32 s40, s37, 7
  s_add_u32 s40, s40, 20480
  v_mov_b32 v10, s40
  v_mov_b32 v11, 1
  s_mov_b64 exec, 1
  global_atomic_add v10, v11, s[30:31] sc1
  s_mov_b64 exec, -1
L_s4arr_95:
  v_mfma_f32_32x32x16_bf16 v[16:31], a[0:3], v[80:83], 0
  v_mfma_f32_32x32x16_bf16 v[32:47], a[0:3], v[84:87], 0
  v_mfma_f32_32x32x16_bf16 v[48:63], a[4:7], v[80:83], 0
  v_mfma_f32_32x32x16_bf16 v[64:79], a[4:7], v[84:87], 0
  global_load_dwordx4 v[136:139], v12, s[30:31] offset:3072 sc1
  global_load_dwordx4 v[140:143], v13, s[30:31] offset:3072 sc1
  s_waitcnt vmcnt(12)
  v_mfma_f32_32x32x16_bf16 v[16:31], a[8:11], v[88:91], v[16:31]
  v_mfma_f32_32x32x16_bf16 v[32:47], a[8:11], v[92:95], v[32:47]
  v_mfma_f32_32x32x16_bf16 v[48:63], a[12:15], v[88:91], v[48:63]
  v_mfma_f32_32x32x16_bf16 v[64:79], a[12:15], v[92:95], v[64:79]
  v_add_u32 v12, 7168, v12
  v_add_u32 v13, 7168, v13
  global_load_dwordx4 v[144:147], v12, s[30:31] offset:0 sc1
  global_load_dwordx4 v[148:151], v13, s[30:31] offset:0 sc1
  s_waitcnt vmcnt(12)
  v_mfma_f32_32x32x16_bf16 v[16:31], a[16:19], v[96:99], v[16:31]
  v_mfma_f32_32x32x16_bf16 v[32:47], a[16:19], v[100:103], v[32:47]
  v_mfma_f32_32x32x16_bf16 v[48:63], a[20:23], v[96:99], v[48:63]
  v_mfma_f32_32x32x16_bf16 v[64:79], a[20:23], v[100:103], v[64:79]
  global_load_dwordx4 v[152:155], v12, s[30:31] offset:1024 sc1
  global_load_dwordx4 v[156:159], v13, s[30:31] offset:1024 sc1
  s_waitcnt vmcnt(12)
  v_mfma_f32_32x32x16_bf16 v[16:31], a[24:27], v[104:107], v[16:31]
  v_mfma_f32_32x32x16_bf16 v[32:47], a[24:27], v[108:111], v[32:47]
  v_mfma_f32_32x32x16_bf16 v[48:63], a[28:31], v[104:107], v[48:63]
  v_mfma_f32_32x32x16_bf16 v[64:79], a[28:31], v[108:111], v[64:79]
  global_load_dwordx4 v[80:83], v12, s[30:31] offset:2048 sc1
  global_load_dwordx4 v[84:87], v13, s[30:31] offset:2048 sc1
  s_waitcnt vmcnt(12)
  v_mfma_f32_32x32x16_bf16 v[16:31], a[56:59], v[112:115], v[16:31]
  v_mfma_f32_32x32x16_bf16 v[32:47], a[56:59], v[116:119], v[32:47]
  v_mfma_f32_32x32x16_bf16 v[48:63], a[60:63], v[112:115], v[48:63]
  v_mfma_f32_32x32x16_bf16 v[64:79], a[60:63], v[116:119], v[64:79]
  global_load_dwordx4 v[88:91], v12, s[30:31] offset:3072 sc1
  global_load_dwordx4 v[92:95], v13, s[30:31] offset:3072 sc1
  s_waitcnt vmcnt(12)
  v_mfma_f32_32x32x16_bf16 v[16:31], a[64:67], v[120:123], v[16:31]
  v_mfma_f32_32x32x16_bf16 v[32:47], a[64:67], v[124:127], v[32:47]
  v_mfma_f32_32x32x16_bf16 v[48:63], a[68:71], v[120:123], v[48:63]
  v_mfma_f32_32x32x16_bf16 v[64:79], a[68:71], v[124:127], v[64:79]
  v_add_u32 v12, 7168, v12
  v_add_u32 v13, 7168, v13
  global_load_dwordx4 v[96:99], v12, s[30:31] offset:0 sc1
  global_load_dwordx4 v[100:103], v13, s[30:31] offset:0 sc1
  s_waitcnt vmcnt(12)
  v_mfma_f32_32x32x16_bf16 v[16:31], a[72:75], v[128:131], v[16:31]
  v_mfma_f32_32x32x16_bf16 v[32:47], a[72:75], v[132:135], v[32:47]
  v_mfma_f32_32x32x16_bf16 v[48:63], a[76:79], v[128:131], v[48:63]
  v_mfma_f32_32x32x16_bf16 v[64:79], a[76:79], v[132:135], v[64:79]
  global_load_dwordx4 v[104:107], v12, s[30:31] offset:1024 sc1
  global_load_dwordx4 v[108:111], v13, s[30:31] offset:1024 sc1
  s_waitcnt vmcnt(12)
  v_mfma_f32_32x32x16_bf16 v[16:31], a[80:83], v[136:139], v[16:31]
  v_mfma_f32_32x32x16_bf16 v[32:47], a[80:83], v[140:143], v[32:47]
  v_mfma_f32_32x32x16_bf16 v[48:63], a[84:87], v[136:139], v[48:63]
  v_mfma_f32_32x32x16_bf16 v[64:79], a[84:87], v[140:143], v[64:79]
  global_load_dwordx4 v[112:115], v12, s[30:31] offset:2048 sc1
  global_load_dwordx4 v[116:119], v13, s[30:31] offset:2048 sc1
  s_waitcnt vmcnt(12)
  v_mfma_f32_32x32x16_bf16 v[16:31], a[112:115], v[144:147], v[16:31]
  v_mfma_f32_32x32x16_bf16 v[32:47], a[112:115], v[148:151], v[32:47]
  v_mfma_f32_32x32x16_bf16 v[48:63], a[116:119], v[144:147], v[48:63]
  v_mfma_f32_32x32x16_bf16 v[64:79], a[116:119], v[148:151], v[64:79]
  global_load_dwordx4 v[120:123], v12, s[30:31] offset:3072 sc1
  global_load_dwordx4 v[124:127], v13, s[30:31] offset:3072 sc1
  s_waitcnt vmcnt(12)
  v_mfma_f32_32x32x16_bf16 v[16:31], a[120:123], v[152:155], v[16:31]
  v_mfma_f32_32x32x16_bf16 v[32:47], a[120:123], v[156:159], v[32:47]
  v_mfma_f32_32x32x16_bf16 v[48:63], a[124:127], v[152:155], v[48:63]
  v_mfma_f32_32x32x16_bf16 v[64:79], a[124:127], v[156:159], v[64:79]
  s_lshr_b32 s83, s35, 1
  s_cmp_lg_u32 s32, 0
  s_cbranch_scc1 L_wt_96
  s_lshl_b32 s40, s83, 7
  s_add_u32 s40, s40, 20480
  v_lshlrev_b32 v10, 7, v1
  v_add_u32 v10, s40, v10
  s_mov_b64 exec, 1
  s_mov_b32 s92, 0
L_poll_97:
  global_load_dword v11, v10, s[30:31] sc1
L_pchk_100:
  s_add_u32 s92, s92, 1
  s_cmp_gt_u32 s92, 200000
  s_cbranch_scc1 L_ptm_99
  s_waitcnt vmcnt(0)
  v_cmp_gt_u32 vcc, 16, v11
  s_cbranch_vccnz L_poll_97
  s_branch L_pok_98
L_ptm_99:
  s_waitcnt vmcnt(0)
  v_mov_b32 v10, 32
  v_mov_b32 v11, 8
  s_mov_b64 exec, 1
  global_store_dword v10, v11, s[28:29]
L_pok_98:
  s_mov_b64 exec, -1
L_wt_96:
  s_barrier
  v_add_u32 v12, 4294949888, v12
  v_add_u32 v13, 4294949888, v13
  global_load_dwordx4 v[128:131], v12, s[30:31] offset:0 sc1
  global_load_dwordx4 v[132:135], v13, s[30:31] offset:0 sc1
  s_waitcnt vmcnt(12)
  v_mfma_f32_32x32x16_bf16 v[16:31], a[128:131], v[80:83], v[16:31]
  v_mfma_f32_32x32x16_bf16 v[32:47], a[128:131], v[84:87], v[32:47]
  v_mfma_f32_32x32x16_bf16 v[48:63], a[132:135], v[80:83], v[48:63]
  v_mfma_f32_32x32x16_bf16 v[64:79], a[132:135], v[84:87], v[64:79]
  global_load_dwordx4 v[136:139], v12, s[30:31] offset:1024 sc1
  global_load_dwordx4 v[140:143], v13, s[30:31] offset:1024 sc1
  s_waitcnt vmcnt(12)
  v_mfma_f32_32x32x16_bf16 v[16:31], a[136:139], v[88:91], v[16:31]
  v_mfma_f32_32x32x16_bf16 v[32:47], a[136:139], v[92:95], v[32:47]
  v_mfma_f32_32x32x16_bf16 v[48:63], a[140:143], v[88:91], v[48:63]
  v_mfma_f32_32x32x16_bf16 v[64:79], a[140:143], v[92:95], v[64:79]
  global_load_dwordx4 v[144:147], v12, s[30:31] offset:2048 sc1
  global_load_dwordx4 v[148:151], v13, s[30:31] offset:2048 sc1
  s_waitcnt vmcnt(12)
  v_mfma_f32_32x32x16_bf16 v[16:31], a[168:171], v[96:99], v[16:31]
  v_mfma_f32_32x32x16_bf16 v[32:47], a[168:171], v[100:103], v[32:47]
  v_mfma_f32_32x32x16_bf16 v[48:63], a[172:175], v[96:99], v[48:63]
  v_mfma_f32_32x32x16_bf16 v[64:79], a[172:175], v[100:103], v[64:79]
  v_add_u32 v12, 7168, v12
  v_add_u32 v13, 7168, v13
  global_load_dwordx4 v[152:155], v12, s[30:31] offset:0 sc1
  global_load_dwordx4 v[156:159], v13, s[30:31] offset:0 sc1
  s_waitcnt vmcnt(12)
  v_mfma_f32_32x32x16_bf16 v[16:31], a[176:179], v[104:107], v[16:31]
  v_mfma_f32_32x32x16_bf16 v[32:47], a[176:179], v[108:111], v[32:47]
  v_mfma_f32_32x32x16_bf16 v[48:63], a[180:183], v[104:107], v[48:63]
  v_mfma_f32_32x32x16_bf16 v[64:79], a[180:183], v[108:111], v[64:79]
  global_load_dwordx4 v[80:83], v12, s[30:31] offset:1024 sc1
  global_load_dwordx4 v[84:87], v13, s[30:31] offset:1024 sc1
  s_waitcnt vmcnt(12)
  v_mfma_f32_32x32x16_bf16 v[16:31], a[184:187], v[112:115], v[16:31]
  v_mfma_f32_32x32x16_bf16 v[32:47], a[184:187], v[116:119], v[32:47]
  v_mfma_f32_32x32x16_bf16 v[48:63], a[188:191], v[112:115], v[48:63]
  v_mfma_f32_32x32x16_bf16 v[64:79], a[188:191], v[116:119], v[64:79]
  global_load_dwordx4 v[88:91], v12, s[30:31] offset:2048 sc1
  global_load_dwordx4 v[92:95], v13, s[30:31] offset:2048 sc1
  s_waitcnt vmcnt(12)
  v_mfma_f32_32x32x16_bf16 v[16:31], a[192:195], v[120:123], v[16:31]
  v_mfma_f32_32x32x16_bf16 v[32:47], a[192:195], v[124:127], v[32:47]
  v_mfma_f32_32x32x16_bf16 v[48:63], a[196:199], v[120:123], v[48:63]
  v_mfma_f32_32x32x16_bf16 v[64:79], a[196:199], v[124:127], v[64:79]
  v_add_u32 v12, 7168, v12
  v_add_u32 v13, 7168, v13
  global_load_dwordx4 v[96:99], v12, s[30:31] offset:0 sc1
  global_load_dwordx4 v[100:103], v13, s[30:31] offset:0 sc1
  s_waitcnt vmcnt(12)
  v_mfma_f32_32x32x16_bf16 v[16:31], a[32:35], v[128:131], v[16:31]
  v_mfma_f32_32x32x16_bf16 v[32:47], a[32:35], v[132:135], v[32:47]
  v_mfma_f32_32x32x16_bf16 v[48:63], a[36:39], v[128:131], v[48:63]
  v_mfma_f32_32x32x16_bf16 v[64:79], a[36:39], v[132:135], v[64:79]
  global_load_dwordx4 v[104:107], v12, s[30:31] offset:1024 sc1
  global_load_dwordx4 v[108:111], v13, s[30:31] offset:1024 sc1
  s_waitcnt vmcnt(12)
  v_mfma_f32_32x32x16_bf16 v[16:31], a[40:43], v[136:139], v[16:31]
  v_mfma_f32_32x32x16_bf16 v[32:47], a[40:43], v[140:143], v[32:47]
  v_mfma_f32_32x32x16_bf16 v[48:63], a[44:47], v[136:139], v[48:63]
  v_mfma_f32_32x32x16_bf16 v[64:79], a[44:47], v[140:143], v[64:79]
  global_load_dwordx4 v[112:115], v12, s[30:31] offset:2048 sc1
  global_load_dwordx4 v[116:119], v13, s[30:31] offset:2048 sc1
  s_waitcnt vmcnt(12)
  v_mfma_f32_32x32x16_bf16 v[16:31], a[48:51], v[144:147], v[16:31]
  v_mfma_f32_32x32x16_bf16 v[32:47], a[48:51], v[148:151], v[32:47]
  v_mfma_f32_32x32x16_bf16 v[48:63], a[52:55], v[144:147], v[48:63]
  v_mfma_f32_32x32x16_bf16 v[64:79], a[52:55], v[148:151], v[64:79]
  v_add_u32 v12, 7168, v12
  v_add_u32 v13, 7168, v13
  global_load_dwordx4 v[120:123], v12, s[30:31] offset:0 sc1
  global_load_dwordx4 v[124:127], v13, s[30:31] offset:0 sc1
  s_waitcnt vmcnt(12)
  v_mfma_f32_32x32x16_bf16 v[16:31], a[88:91], v[152:155], v[16:31]
  v_mfma_f32_32x32x16_bf16 v[32:47], a[88:91], v[156:159], v[32:47]
  v_mfma_f32_32x32x16_bf16 v[48:63], a[92:95], v[152:155], v[48:63]
  v_mfma_f32_32x32x16_bf16 v[64:79], a[92:95], v[156:159], v[64:79]
  global_load_dwordx4 v[128:131], v12, s[30:31] offset:1024 sc1
  global_load_dwordx4 v[132:135], v13, s[30:31] offset:1024 sc1
  s_waitcnt vmcnt(12)
  v_mfma_f32_32x32x16_bf16 v[16:31], a[96:99], v[80:83], v[16:31]
  v_mfma_f32_32x32x16_bf16 v[32:47], a[96:99], v[84:87], v[32:47]
  v_mfma_f32_32x32x16_bf16 v[48:63], a[100:103], v[80:83], v[48:63]
  v_mfma_f32_32x32x16_bf16 v[64:79], a[100:103], v[84:87], v[64:79]
  global_load_dwordx4 v[136:139], v12, s[30:31] offset:2048 sc1
  global_load_dwordx4 v[140:143], v13, s[30:31] offset:2048 sc1
  s_waitcnt vmcnt(12)
  v_mfma_f32_32x32x16_bf16 v[16:31], a[104:107], v[88:91], v[16:31]
  v_mfma_f32_32x32x16_bf16 v[32:47], a[104:107], v[92:95], v[32:47]
  v_mfma_f32_32x32x16_bf16 v[48:63], a[108:111], v[88:91], v[48:63]
  v_mfma_f32_32x32x16_bf16 v[64:79], a[108:111], v[92:95], v[64:79]
  s_waitcnt vmcnt(10)
  v_mfma_f32_32x32x16_bf16 v[16:31], a[144:147], v[96:99], v[16:31]
  v_mfma_f32_32x32x16_bf16 v[32:47], a[144:147], v[100:103], v[32:47]
  v_mfma_f32_32x32x16_bf16 v[48:63], a[148:151], v[96:99], v[48:63]
  v_mfma_f32_32x32x16_bf16 v[64:79], a[148:151], v[100:103], v[64:79]
  s_waitcnt vmcnt(8)
  v_mfma_f32_32x32x16_bf16 v[16:31], a[152:155], v[104:107], v[16:31]
  v_mfma_f32_32x32x16_bf16 v[32:47], a[152:155], v[108:111], v[32:47]
  v_mfma_f32_32x32x16_bf16 v[48:63], a[156:159], v[104:107], v[48:63]
  v_mfma_f32_32x32x16_bf16 v[64:79], a[156:159], v[108:111], v[64:79]
  s_waitcnt vmcnt(6)
  v_mfma_f32_32x32x16_bf16 v[16:31], a[160:163], v[112:115], v[16:31]
  v_mfma_f32_32x32x16_bf16 v[32:47], a[160:163], v[116:119], v[32:47]
  v_mfma_f32_32x32x16_bf16 v[48:63], a[164:167], v[112:115], v[48:63]
  v_mfma_f32_32x32x16_bf16 v[64:79], a[164:167], v[116:119], v[64:79]
  s_waitcnt vmcnt(4)
  v_mfma_f32_32x32x16_bf16 v[16:31], a[200:203], v[120:123], v[16:31]
  v_mfma_f32_32x32x16_bf16 v[32:47], a[200:203], v[124:127], v[32:47]
  v_mfma_f32_32x32x16_bf16 v[48:63], a[204:207], v[120:123], v[48:63]
  v_mfma_f32_32x32x16_bf16 v[64:79], a[204:207], v[124:127], v[64:79]
  s_waitcnt vmcnt(2)
  v_mfma_f32_32x32x16_bf16 v[16:31], a[208:211], v[128:131], v[16:31]
  v_mfma_f32_32x32x16_bf16 v[32:47], a[208:211], v[132:135], v[32:47]
  v_mfma_f32_32x32x16_bf16 v[48:63], a[212:215], v[128:131], v[48:63]
  v_mfma_f32_32x32x16_bf16 v[64:79], a[212:215], v[132:135], v[64:79]
  s_waitcnt vmcnt(0)
  v_mfma_f32_32x32x16_bf16 v[16:31], a[216:219], v[136:139], v[16:31]
  v_mfma_f32_32x32x16_bf16 v[32:47], a[216:219], v[140:143], v[32:47]
  v_mfma_f32_32x32x16_bf16 v[48:63], a[220:223], v[136:139], v[48:63]
  v_mfma_f32_32x32x16_bf16 v[64:79], a[220:223], v[140:143], v[64:79]
  s_nop 11
  ds_write_b128 v248, v[16:19] offset:0
  ds_write_b128 v249, v[20:23] offset:0
  ds_write_b128 v250, v[24:27] offset:0
  ds_write_b128 v251, v[28:31] offset:0
  ds_write_b128 v248, v[32:35] offset:8192
  ds_write_b128 v249, v[36:39] offset:8192
  ds_write_b128 v250, v[40:43] offset:8192
  ds_write_b128 v251, v[44:47] offset:8192
  ds_write_b128 v248, v[48:51] offset:128
  ds_write_b128 v249, v[52:55] offset:128
  ds_write_b128 v250, v[56:59] offset:128
  ds_write_b128 v251, v[60:63] offset:128
  ds_write_b128 v248, v[64:67] offset:8320
  ds_write_b128 v249, v[68:71] offset:8320
  ds_write_b128 v250, v[72:75] offset:8320
  ds_write_b128 v251, v[76:79] offset:8320
  s_waitcnt lgkmcnt(0)
  s_barrier
  ds_read_b128 v[208:211], v177 offset:0
  ds_read_b128 v[212:215], v178 offset:0
  ds_read_b128 v[216:219], v179 offset:0
  ds_read_b128 v[220:223], v180 offset:0
  ds_read_b128 v[80:83], v177 offset:16384
  ds_read_b128 v[84:87], v178 offset:16384
  ds_read_b128 v[88:91], v179 offset:16384
  ds_read_b128 v[92:95], v180 offset:16384
  ds_read_b128 v[96:99], v177 offset:32768
  ds_read_b128 v[100:103], v178 offset:32768
  ds_read_b128 v[104:107], v179 offset:32768
  ds_read_b128 v[108:111], v180 offset:32768
  ds_read_b128 v[112:115], v177 offset:49152
  ds_read_b128 v[116:119], v178 offset:49152
  ds_read_b128 v[120:123], v179 offset:49152
  ds_read_b128 v[124:127], v180 offset:49152
  s_waitcnt lgkmcnt(8)
  v_add_f32 v208, v208, v80
  v_add_f32 v209, v209, v81
  v_add_f32 v210, v210, v82
  v_add_f32 v211, v211, v83
  v_add_f32 v212, v212, v84
  v_add_f32 v213, v213, v85
  v_add_f32 v214, v214, v86
  v_add_f32 v215, v215, v87
  v_add_f32 v216, v216, v88
  v_add_f32 v217, v217, v89
  v_add_f32 v218, v218, v90
  v_add_f32 v219, v219, v91
  v_add_f32 v220, v220, v92
  v_add_f32 v221, v221, v93
  v_add_f32 v222, v222, v94
  v_add_f32 v223, v223, v95
  s_waitcnt lgkmcnt(0)
  v_add_f32 v96, v96, v112
  v_add_f32 v97, v97, v113
  v_add_f32 v98, v98, v114
  v_add_f32 v99, v99, v115
  v_add_f32 v100, v100, v116
  v_add_f32 v101, v101, v117
  v_add_f32 v102, v102, v118
  v_add_f32 v103, v103, v119
  v_add_f32 v104, v104, v120
  v_add_f32 v105, v105, v121
  v_add_f32 v106, v106, v122
  v_add_f32 v107, v107, v123
  v_add_f32 v108, v108, v124
  v_add_f32 v109, v109, v125
  v_add_f32 v110, v110, v126
  v_add_f32 v111, v111, v127
  v_add_f32 v208, v208, v96
  v_add_f32 v209, v209, v97
  v_add_f32 v210, v210, v98
  v_add_f32 v211, v211, v99
  v_add_f32 v212, v212, v100
  v_add_f32 v213, v213, v101
  v_add_f32 v214, v214, v102
  v_add_f32 v215, v215, v103
  v_add_f32 v216, v216, v104
  v_add_f32 v217, v217, v105
  v_add_f32 v218, v218, v106
  v_add_f32 v219, v219, v107
  v_add_f32 v220, v220, v108
  v_add_f32 v221, v221, v109
  v_add_f32 v222, v222, v110
  v_add_f32 v223, v223, v111
  v_fma_f32 v208, v224, v208, v160
  v_fma_f32 v209, v225, v209, v161
  v_fma_f32 v210, v226, v210, v162
  v_fma_f32 v211, v227, v211, v163
  v_fma_f32 v212, v228, v212, v164
  v_fma_f32 v213, v229, v213, v165
  v_fma_f32 v214, v230, v214, v166
  v_fma_f32 v215, v231, v215, v167
  v_fma_f32 v216, v232, v216, v168
  v_fma_f32 v217, v233, v217, v169
  v_fma_f32 v218, v234, v218, v170
  v_fma_f32 v219, v235, v219, v171
  v_fma_f32 v220, v236, v220, v172
  v_fma_f32 v221, v237, v221, v173
  v_fma_f32 v222, v238, v222, v174
  v_fma_f32 v223, v239, v223, v175
  v_cvt_pk_bf16_f32 v96, v208, v209
  v_cvt_pk_bf16_f32 v97, v210, v211
  v_cvt_pk_bf16_f32 v98, v212, v213
  v_cvt_pk_bf16_f32 v99, v214, v215
  v_cvt_pk_bf16_f32 v100, v216, v217
  v_cvt_pk_bf16_f32 v101, v218, v219
  v_cvt_pk_bf16_f32 v102, v220, v221
  v_cvt_pk_bf16_f32 v103, v222, v223
  global_store_dwordx4 v176, v[96:99], s[26:27]
  global_store_dwordx4 v176, v[100:103], s[26:27] offset:16
  s_waitcnt vmcnt(0) lgkmcnt(0)
L_END:
  s_endpgm
  .p2align 6
L_ATTN_P:
  v_exp_f32 v16, v16
  v_exp_f32 v17, v17
  v_exp_f32 v18, v18
  v_cvt_pk_bf16_f32 v48, v16, v17
  v_mfma_f32_32x32x16_bf16 v[80:95], v[156:159], v[60:63], v[80:95]
  ds_read_b128 v[140:143], v160 offset:1024
  v_exp_f32 v19, v19
  v_exp_f32 v20, v20
  v_cvt_pk_bf16_f32 v49, v18, v19
  v_exp_f32 v21, v21
  v_exp_f32 v22, v22
  v_cvt_pk_bf16_f32 v50, v20, v21
  v_mfma_f32_32x32x16_bf16 v[32:47], v[136:139], v[132:135], v[112:127]
  v_exp_f32 v23, v23
  v_exp_f32 v24, v24
  v_cvt_pk_bf16_f32 v51, v22, v23
  v_exp_f32 v25, v25
  v_exp_f32 v26, v26
  v_exp_f32 v27, v27
  s_waitcnt lgkmcnt(1)
  v_mfma_f32_32x32x16_bf16 v[64:79], v[144:147], v[48:51], v[64:79]
  v_cvt_pk_bf16_f32 v52, v24, v25
  v_exp_f32 v28, v28
  v_exp_f32 v29, v29
  v_cvt_pk_bf16_f32 v53, v26, v27
  v_exp_f32 v30, v30
  v_exp_f32 v31, v31
  v_cvt_pk_bf16_f32 v54, v28, v29
  v_cvt_pk_bf16_f32 v55, v30, v31
  v_exp_f32 v32, v32
  v_exp_f32 v33, v33
  v_exp_f32 v34, v34
  v_cvt_pk_bf16_f32 v56, v32, v33
  v_mfma_f32_32x32x16_bf16 v[64:79], v[148:151], v[52:55], v[64:79]
  v_exp_f32 v35, v35
  v_exp_f32 v36, v36
  v_cvt_pk_bf16_f32 v57, v34, v35
  v_exp_f32 v37, v37
  v_exp_f32 v38, v38
  v_cvt_pk_bf16_f32 v58, v36, v37
  s_waitcnt lgkmcnt(0)
  v_mfma_f32_32x32x16_bf16 v[16:31], v[140:143], v[128:131], v[96:111]
  ds_read_b128 v[152:155], v161 offset:1024
  ds_read_b128 v[156:159], v161 offset:1536
  v_exp_f32 v39, v39
  v_exp_f32 v40, v40
  v_cvt_pk_bf16_f32 v59, v38, v39
  v_exp_f32 v41, v41
  v_exp_f32 v42, v42
  v_exp_f32 v43, v43
  v_mfma_f32_32x32x16_bf16 v[80:95], v[144:147], v[56:59], v[80:95]
  v_cvt_pk_bf16_f32 v60, v40, v41
  v_exp_f32 v44, v44
  v_exp_f32 v45, v45
  v_cvt_pk_bf16_f32 v61, v42, v43
  v_exp_f32 v46, v46
  v_exp_f32 v47, v47
  v_cvt_pk_bf16_f32 v62, v44, v45
  v_cvt_pk_bf16_f32 v63, v46, v47
  v_exp_f32 v16, v16
  v_exp_f32 v17, v17
  v_exp_f32 v18, v18
  v_cvt_pk_bf16_f32 v48, v16, v17
  v_mfma_f32_32x32x16_bf16 v[80:95], v[148:151], v[60:63], v[80:95]
  ds_read_b128 v[136:139], v160 offset:2048
  v_exp_f32 v19, v19
  v_exp_f32 v20, v20
  v_cvt_pk_bf16_f32 v49, v18, v19
  v_exp_f32 v21, v21
  v_exp_f32 v22, v22
  v_cvt_pk_bf16_f32 v50, v20, v21
  v_mfma_f32_32x32x16_bf16 v[32:47], v[140:143], v[132:135], v[112:127]
  v_exp_f32 v23, v23
  v_exp_f32 v24, v24
  v_cvt_pk_bf16_f32 v51, v22, v23
  v_exp_f32 v25, v25
  v_exp_f32 v26, v26
  v_exp_f32 v27, v27
  s_waitcnt lgkmcnt(1)
  v_mfma_f32_32x32x16_bf16 v[64:79], v[152:155], v[48:51], v[64:79]
  v_cvt_pk_bf16_f32 v52, v24, v25
  v_exp_f32 v28, v28
  v_exp_f32 v29, v29
  v_cvt_pk_bf16_f32 v53, v26, v27
  v_exp_f32 v30, v30
  v_exp_f32 v31, v31
  v_cvt_pk_bf16_f32 v54, v28, v29
  v_cvt_pk_bf16_f32 v55, v30, v31
  v_exp_f32 v32, v32
  v_exp_f32 v33, v33
  v_exp_f32 v34, v34
  v_cvt_pk_bf16_f32 v56, v32, v33
  v_mfma_f32_32x32x16_bf16 v[64:79], v[156:159], v[52:55], v[64:79]
  v_exp_f32 v35, v35
  v_exp_f32 v36, v36
  v_cvt_pk_bf16_f32 v57, v34, v35
  v_exp_f32 v37, v37
  v_exp_f32 v38, v38
  v_cvt_pk_bf16_f32 v58, v36, v37
  s_waitcnt lgkmcnt(0)
  v_mfma_f32_32x32x16_bf16 v[16:31], v[136:139], v[128:131], v[96:111]
  ds_read_b128 v[144:147], v161 offset:2048
  ds_read_b128 v[148:151], v161 offset:2560
  v_exp_f32 v39, v39
  v_exp_f32 v40, v40
  v_cvt_pk_bf16_f32 v59, v38, v39
  v_exp_f32 v41, v41
  v_exp_f32 v42, v42
  v_exp_f32 v43, v43
  v_mfma_f32_32x32x16_bf16 v[80:95], v[152:155], v[56:59], v[80:95]
  v_cvt_pk_bf16_f32 v60, v40, v41
  v_exp_f32 v44, v44
  v_exp_f32 v45, v45
  v_cvt_pk_bf16_f32 v61, v42, v43
  v_exp_f32 v46, v46
  v_exp_f32 v47, v47
  v_cvt_pk_bf16_f32 v62, v44, v45
  v_cvt_pk_bf16_f32 v63, v46, v47
  v_exp_f32 v16, v16
  v_exp_f32 v17, v17
  v_exp_f32 v18, v18
  v_cvt_pk_bf16_f32 v48, v16, v17
  v_mfma_f32_32x32x16_bf16 v[80:95], v[156:159], v[60:63], v[80:95]
  ds_read_b128 v[140:143], v160 offset:3072
  v_exp_f32 v19, v19
  v_exp_f32 v20, v20
  v_cvt_pk_bf16_f32 v49, v18, v19
  v_exp_f32 v21, v21
  v_exp_f32 v22, v22
  v_cvt_pk_bf16_f32 v50, v20, v21
  v_mfma_f32_32x32x16_bf16 v[32:47], v[136:139], v[132:135], v[112:127]
  v_exp_f32 v23, v23
  v_exp_f32 v24, v24
  v_cvt_pk_bf16_f32 v51, v22, v23
  v_exp_f32 v25, v25
  v_exp_f32 v26, v26
  v_exp_f32 v27, v27
  s_waitcnt lgkmcnt(1)
  v_mfma_f32_32x32x16_bf16 v[64:79], v[144:147], v[48:51], v[64:79]
  v_cvt_pk_bf16_f32 v52, v24, v25
  v_exp_f32 v28, v28
  v_exp_f32 v29, v29
  v_cvt_pk_bf16_f32 v53, v26, v27
  v_exp_f32 v30, v30
  v_exp_f32 v31, v31
  v_cvt_pk_bf16_f32 v54, v28, v29
  v_cvt_pk_bf16_f32 v55, v30, v31
  v_exp_f32 v32, v32
  v_exp_f32 v33, v33
  v_exp_f32 v34, v34
  v_cvt_pk_bf16_f32 v56, v32, v33
  v_mfma_f32_32x32x16_bf16 v[64:79], v[148:151], v[52:55], v[64:79]
  v_exp_f32 v35, v35
  v_exp_f32 v36, v36
  v_cvt_pk_bf16_f32 v57, v34, v35
  v_exp_f32 v37, v37
  v_exp_f32 v38, v38
  v_cvt_pk_bf16_f32 v58, v36, v37
  s_waitcnt lgkmcnt(0)
  v_mfma_f32_32x32x16_bf16 v[16:31], v[140:143], v[128:131], v[96:111]
  ds_read_b128 v[152:155], v161 offset:3072
  ds_read_b128 v[156:159], v161 offset:3584
  v_exp_f32 v39, v39
  v_exp_f32 v40, v40
  v_cvt_pk_bf16_f32 v59, v38, v39
  v_exp_f32 v41, v41
  v_exp_f32 v42, v42
  v_exp_f32 v43, v43
  v_mfma_f32_32x32x16_bf16 v[80:95], v[144:147], v[56:59], v[80:95]
  v_cvt_pk_bf16_f32 v60, v40, v41
  v_exp_f32 v44, v44
  v_exp_f32 v45, v45
  v_cvt_pk_bf16_f32 v61, v42, v43
  v_exp_f32 v46, v46
  v_exp_f32 v47, v47
  v_cvt_pk_bf16_f32 v62, v44, v45
  v_cvt_pk_bf16_f32 v63, v46, v47
  v_exp_f32 v16, v16
  v_exp_f32 v17, v17
  v_exp_f32 v18, v18
  v_cvt_pk_bf16_f32 v48, v16, v17
  v_mfma_f32_32x32x16_bf16 v[80:95], v[148:151], v[60:63], v[80:95]
  ds_read_b128 v[136:139], v160 offset:4096
  v_exp_f32 v19, v19
  v_exp_f32 v20, v20
  v_cvt_pk_bf16_f32 v49, v18, v19
  v_exp_f32 v21, v21
  v_exp_f32 v22, v22
  v_cvt_pk_bf16_f32 v50, v20, v21
  v_mfma_f32_32x32x16_bf16 v[32:47], v[140:143], v[132:135], v[112:127]
  v_exp_f32 v23, v23
  v_exp_f32 v24, v24
  v_cvt_pk_bf16_f32 v51, v22, v23
  v_exp_f32 v25, v25
  v_exp_f32 v26, v26
  v_exp_f32 v27, v27
  s_waitcnt lgkmcnt(1)
  v_mfma_f32_32x32x16_bf16 v[64:79], v[152:155], v[48:51], v[64:79]
  v_cvt_pk_bf16_f32 v52, v24, v25
  v_exp_f32 v28, v28
  v_exp_f32 v29, v29
  v_cvt_pk_bf16_f32 v53, v26, v27
  v_exp_f32 v30, v30
  v_exp_f32 v31, v31
  v_cvt_pk_bf16_f32 v54, v28, v29
  v_cvt_pk_bf16_f32 v55, v30, v31
  v_exp_f32 v32, v32
  v_exp_f32 v33, v33
  v_exp_f32 v34, v34
  v_cvt_pk_bf16_f32 v56, v32, v33
  v_mfma_f32_32x32x16_bf16 v[64:79], v[156:159], v[52:55], v[64:79]
  v_exp_f32 v35, v35
  v_exp_f32 v36, v36
  v_cvt_pk_bf16_f32 v57, v34, v35
  v_exp_f32 v37, v37
  v_exp_f32 v38, v38
  v_cvt_pk_bf16_f32 v58, v36, v37
  s_waitcnt lgkmcnt(0)
  v_mfma_f32_32x32x16_bf16 v[16:31], v[136:139], v[128:131], v[96:111]
  ds_read_b128 v[144:147], v161 offset:4096
  ds_read_b128 v[148:151], v161 offset:4608
  v_exp_f32 v39, v39
  v_exp_f32 v40, v40
  v_cvt_pk_bf16_f32 v59, v38, v39
  v_exp_f32 v41, v41
  v_exp_f32 v42, v42
  v_exp_f32 v43, v43
  v_mfma_f32_32x32x16_bf16 v[80:95], v[152:155], v[56:59], v[80:95]
  v_cvt_pk_bf16_f32 v60, v40, v41
  v_exp_f32 v44, v44
  v_exp_f32 v45, v45
  v_cvt_pk_bf16_f32 v61, v42, v43
  v_exp_f32 v46, v46
  v_exp_f32 v47, v47
  v_cvt_pk_bf16_f32 v62, v44, v45
  v_cvt_pk_bf16_f32 v63, v46, v47
  v_add_u32 v160, 4096, v160
  v_add_u32 v161, v161, v162
  s_sub_u32 s94, s94, 1
  s_cmp_lg_u32 s94, 0
  s_cbranch_scc1 L_ATTN_P
  s_setpc_b64 s[84:85]
  .p2align 6
L_ATTN_D:
  v_exp_f32 v16, v16
  v_exp_f32 v17, v17
  v_exp_f32 v18, v18
  v_cvt_pk_bf16_f32 v48, v16, v17
  v_mfma_f32_32x32x16_bf16 v[80:95], v[156:159], v[60:63], v[80:95]
  ds_read_b128 v[140:143], v160 offset:1024
  v_exp_f32 v19, v19
  s_mov_b32 m0, s77
  v_exp_f32 v20, v20
  global_load_lds_dwordx4 v202, s[98:99] sc1
  s_add_u32 s77, s77, s89
  v_add_u32 v202, s89, v202
  v_cvt_pk_bf16_f32 v49, v18, v19
  v_exp_f32 v21, v21
  v_exp_f32 v22, v22
  v_cvt_pk_bf16_f32 v50, v20, v21
  v_mfma_f32_32x32x16_bf16 v[32:47], v[136:139], v[132:135], v[112:127]
  v_exp_f32 v23, v23
  v_exp_f32 v24, v24
  v_cvt_pk_bf16_f32 v51, v22, v23
  v_exp_f32 v25, v25
  v_exp_f32 v26, v26
  v_exp_f32 v27, v27
  s_waitcnt lgkmcnt(1)
  v_mfma_f32_32x32x16_bf16 v[64:79], v[144:147], v[48:51], v[64:79]
  v_cvt_pk_bf16_f32 v52, v24, v25
  v_exp_f32 v28, v28
  v_exp_f32 v29, v29
  v_cvt_pk_bf16_f32 v53, v26, v27
  v_exp_f32 v30, v30
  v_exp_f32 v31, v31
  v_cvt_pk_bf16_f32 v54, v28, v29
  v_cvt_pk_bf16_f32 v55, v30, v31
  v_exp_f32 v32, v32
  v_exp_f32 v33, v33
  v_exp_f32 v34, v34
  v_cvt_pk_bf16_f32 v56, v32, v33
  v_mfma_f32_32x32x16_bf16 v[64:79], v[148:151], v[52:55], v[64:79]
  v_exp_f32 v35, v35
  s_mov_b32 m0, s82
  v_exp_f32 v36, v36
  global_load_lds_dwordx4 v203, s[100:101] sc1
  s_add_u32 s82, s82, s89
  v_add_u32 v203, s89, v203
  v_cvt_pk_bf16_f32 v57, v34, v35
  v_exp_f32 v37, v37
  v_exp_f32 v38, v38
  v_cvt_pk_bf16_f32 v58, v36, v37
  s_waitcnt lgkmcnt(0)
  v_mfma_f32_32x32x16_bf16 v[16:31], v[140:143], v[128:131], v[96:111]
  ds_read_b128 v[152:155], v161 offset:1024
  ds_read_b128 v[156:159], v161 offset:1536
  v_exp_f32 v39, v39
  v_exp_f32 v40, v40
  v_cvt_pk_bf16_f32 v59, v38, v39
  v_exp_f32 v41, v41
  v_exp_f32 v42, v42
  v_exp_f32 v43, v43
  v_mfma_f32_32x32x16_bf16 v[80:95], v[144:147], v[56:59], v[80:95]
  v_cvt_pk_bf16_f32 v60, v40, v41
  v_exp_f32 v44, v44
  v_exp_f32 v45, v45
  v_cvt_pk_bf16_f32 v61, v42, v43
  v_exp_f32 v46, v46
  v_exp_f32 v47, v47
  v_cvt_pk_bf16_f32 v62, v44, v45
  v_cvt_pk_bf16_f32 v63, v46, v47
  v_exp_f32 v16, v16
  v_exp_f32 v17, v17
  v_exp_f32 v18, v18
  v_cvt_pk_bf16_f32 v48, v16, v17
  v_mfma_f32_32x32x16_bf16 v[80:95], v[148:151], v[60:63], v[80:95]
  ds_read_b128 v[136:139], v160 offset:2048
  v_exp_f32 v19, v19
  s_mov_b32 m0, s77
  v_exp_f32 v20, v20
  global_load_lds_dwordx4 v202, s[98:99] sc1
  s_add_u32 s77, s77, s89
  v_add_u32 v202, s89, v202
  v_cvt_pk_bf16_f32 v49, v18, v19
  v_exp_f32 v21, v21
  v_exp_f32 v22, v22
  v_cvt_pk_bf16_f32 v50, v20, v21
  v_mfma_f32_32x32x16_bf16 v[32:47], v[140:143], v[132:135], v[112:127]
  v_exp_f32 v23, v23
  v_exp_f32 v24, v24
  v_cvt_pk_bf16_f32 v51, v22, v23
  v_exp_f32 v25, v25
  v_exp_f32 v26, v26
  v_exp_f32 v27, v27
  s_waitcnt lgkmcnt(1)
  v_mfma_f32_32x32x16_bf16 v[64:79], v[152:155], v[48:51], v[64:79]
  v_cvt_pk_bf16_f32 v52, v24, v25
  v_exp_f32 v28, v28
  v_exp_f32 v29, v29
  v_cvt_pk_bf16_f32 v53, v26, v27
  v_exp_f32 v30, v30
  v_exp_f32 v31, v31
  v_cvt_pk_bf16_f32 v54, v28, v29
  v_cvt_pk_bf16_f32 v55, v30, v31
  v_exp_f32 v32, v32
  v_exp_f32 v33, v33
  v_exp_f32 v34, v34
  v_cvt_pk_bf16_f32 v56, v32, v33
  v_mfma_f32_32x32x16_bf16 v[64:79], v[156:159], v[52:55], v[64:79]
  v_exp_f32 v35, v35
  s_mov_b32 m0, s82
  v_exp_f32 v36, v36
  global_load_lds_dwordx4 v203, s[100:101] sc1
  s_add_u32 s82, s82, s89
  v_add_u32 v203, s89, v203
  v_cvt_pk_bf16_f32 v57, v34, v35
  v_exp_f32 v37, v37
  v_exp_f32 v38, v38
  v_cvt_pk_bf16_f32 v58, v36, v37
  s_waitcnt lgkmcnt(0)
  v_mfma_f32_32x32x16_bf16 v[16:31], v[136:139], v[128:131], v[96:111]
  ds_read_b128 v[144:147], v161 offset:2048
  ds_read_b128 v[148:151], v161 offset:2560
  v_exp_f32 v39, v39
  v_exp_f32 v40, v40
  v_cvt_pk_bf16_f32 v59, v38, v39
  v_exp_f32 v41, v41
  v_exp_f32 v42, v42
  v_exp_f32 v43, v43
  v_mfma_f32_32x32x16_bf16 v[80:95], v[152:155], v[56:59], v[80:95]
  v_cvt_pk_bf16_f32 v60, v40, v41
  v_exp_f32 v44, v44
  v_exp_f32 v45, v45
  v_cvt_pk_bf16_f32 v61, v42, v43
  v_exp_f32 v46, v46
  v_exp_f32 v47, v47
  v_cvt_pk_bf16_f32 v62, v44, v45
  v_cvt_pk_bf16_f32 v63, v46, v47
  v_exp_f32 v16, v16
  v_exp_f32 v17, v17
  v_exp_f32 v18, v18
  v_cvt_pk_bf16_f32 v48, v16, v17
  v_mfma_f32_32x32x16_bf16 v[80:95], v[156:159], v[60:63], v[80:95]
  ds_read_b128 v[140:143], v160 offset:3072
  v_exp_f32 v19, v19
  s_mov_b32 m0, s77
  v_exp_f32 v20, v20
  global_load_lds_dwordx4 v202, s[98:99] sc1
  s_add_u32 s77, s77, s89
  v_add_u32 v202, s89, v202
  v_cvt_pk_bf16_f32 v49, v18, v19
  v_exp_f32 v21, v21
  v_exp_f32 v22, v22
  v_cvt_pk_bf16_f32 v50, v20, v21
  v_mfma_f32_32x32x16_bf16 v[32:47], v[136:139], v[132:135], v[112:127]
  v_exp_f32 v23, v23
  v_exp_f32 v24, v24
  v_cvt_pk_bf16_f32 v51, v22, v23
  v_exp_f32 v25, v25
  v_exp_f32 v26, v26
  v_exp_f32 v27, v27
  s_waitcnt lgkmcnt(1)
  v_mfma_f32_32x32x16_bf16 v[64:79], v[144:147], v[48:51], v[64:79]
  v_cvt_pk_bf16_f32 v52, v24, v25
  v_exp_f32 v28, v28
  v_exp_f32 v29, v29
  v_cvt_pk_bf16_f32 v53, v26, v27
  v_exp_f32 v30, v30
  v_exp_f32 v31, v31
  v_cvt_pk_bf16_f32 v54, v28, v29
  v_cvt_pk_bf16_f32 v55, v30, v31
  v_exp_f32 v32, v32
  v_exp_f32 v33, v33
  v_exp_f32 v34, v34
  v_cvt_pk_bf16_f32 v56, v32, v33
  v_mfma_f32_32x32x16_bf16 v[64:79], v[148:151], v[52:55], v[64:79]
  v_exp_f32 v35, v35
  s_mov_b32 m0, s82
  v_exp_f32 v36, v36
  global_load_lds_dwordx4 v203, s[100:101] sc1
  s_add_u32 s82, s82, s89
  v_add_u32 v203, s89, v203
  v_cvt_pk_bf16_f32 v57, v34, v35
  v_exp_f32 v37, v37
  v_exp_f32 v38, v38
  v_cvt_pk_bf16_f32 v58, v36, v37
  s_waitcnt lgkmcnt(0)
  v_mfma_f32_32x32x16_bf16 v[16:31], v[140:143], v[128:131], v[96:111]
  ds_read_b128 v[152:155], v161 offset:3072
  ds_read_b128 v[156:159], v161 offset:3584
  v_exp_f32 v39, v39
  v_exp_f32 v40, v40
  v_cvt_pk_bf16_f32 v59, v38, v39
  v_exp_f32 v41, v41
  v_exp_f32 v42, v42
  v_exp_f32 v43, v43
  v_mfma_f32_32x32x16_bf16 v[80:95], v[144:147], v[56:59], v[80:95]
  v_cvt_pk_bf16_f32 v60, v40, v41
  v_exp_f32 v44, v44
  v_exp_f32 v45, v45
  v_cvt_pk_bf16_f32 v61, v42, v43
  v_exp_f32 v46, v46
  v_exp_f32 v47, v47
  v_cvt_pk_bf16_f32 v62, v44, v45
  v_cvt_pk_bf16_f32 v63, v46, v47
  v_exp_f32 v16, v16
  v_exp_f32 v17, v17
  v_exp_f32 v18, v18
  v_cvt_pk_bf16_f32 v48, v16, v17
  v_mfma_f32_32x32x16_bf16 v[80:95], v[148:151], v[60:63], v[80:95]
  ds_read_b128 v[136:139], v160 offset:4096
  v_exp_f32 v19, v19
  s_mov_b32 m0, s77
  v_exp_f32 v20, v20
  global_load_lds_dwordx4 v202, s[98:99] sc1
  s_add_u32 s77, s77, s89
  v_add_u32 v202, s89, v202
  v_cvt_pk_bf16_f32 v49, v18, v19
  v_exp_f32 v21, v21
  v_exp_f32 v22, v22
  v_cvt_pk_bf16_f32 v50, v20, v21
  v_mfma_f32_32x32x16_bf16 v[32:47], v[140:143], v[132:135], v[112:127]
  v_exp_f32 v23, v23
  v_exp_f32 v24, v24
  v_cvt_pk_bf16_f32 v51, v22, v23
  v_exp_f32 v25, v25
  v_exp_f32 v26, v26
  v_exp_f32 v27, v27
  s_waitcnt lgkmcnt(1)
  v_mfma_f32_32x32x16_bf16 v[64:79], v[152:155], v[48:51], v[64:79]
  v_cvt_pk_bf16_f32 v52, v24, v25
  v_exp_f32 v28, v28
  v_exp_f32 v29, v29
  v_cvt_pk_bf16_f32 v53, v26, v27
  v_exp_f32 v30, v30
  v_exp_f32 v31, v31
  v_cvt_pk_bf16_f32 v54, v28, v29
  v_cvt_pk_bf16_f32 v55, v30, v31
  v_exp_f32 v32, v32
  v_exp_f32 v33, v33
  v_exp_f32 v34, v34
  v_cvt_pk_bf16_f32 v56, v32, v33
  v_mfma_f32_32x32x16_bf16 v[64:79], v[156:159], v[52:55], v[64:79]
  v_exp_f32 v35, v35
  s_mov_b32 m0, s82
  v_exp_f32 v36, v36
  global_load_lds_dwordx4 v203, s[100:101] sc1
  s_add_u32 s82, s82, s89
  v_add_u32 v203, s89, v203
  v_cvt_pk_bf16_f32 v57, v34, v35
  v_exp_f32 v37, v37
  v_exp_f32 v38, v38
  v_cvt_pk_bf16_f32 v58, v36, v37
  s_waitcnt lgkmcnt(0)
  v_mfma_f32_32x32x16_bf16 v[16:31], v[136:139], v[128:131], v[96:111]
  ds_read_b128 v[144:147], v161 offset:4096
  ds_read_b128 v[148:151], v161 offset:4608
  v_exp_f32 v39, v39
  v_exp_f32 v40, v40
  v_cvt_pk_bf16_f32 v59, v38, v39
  v_exp_f32 v41, v41
  v_exp_f32 v42, v42
  v_exp_f32 v43, v43
  v_mfma_f32_32x32x16_bf16 v[80:95], v[152:155], v[56:59], v[80:95]
  v_cvt_pk_bf16_f32 v60, v40, v41
  v_exp_f32 v44, v44
  v_exp_f32 v45, v45
  v_cvt_pk_bf16_f32 v61, v42, v43
  v_exp_f32 v46, v46
  v_exp_f32 v47, v47
  v_cvt_pk_bf16_f32 v62, v44, v45
  v_cvt_pk_bf16_f32 v63, v46, v47
  v_add_u32 v160, 4096, v160
  v_add_u32 v161, v161, v162
  s_sub_u32 s94, s94, 1
  s_cmp_lg_u32 s94, 0
  s_cbranch_scc1 L_ATTN_D
  s_setpc_b64 s[84:85]
L_CODE_END:
  s_endpgm

.section .rodata,"a"
.p2align 6
.amdhsa_kernel adaLN_cond__grouped_kv_mqa__swiglu_ffn__prompt_kernel
  .amdhsa_next_free_vgpr 512
  .amdhsa_next_free_sgpr 102
  .amdhsa_accum_offset 256
  .amdhsa_group_segment_fixed_size 0
  .amdhsa_kernarg_size 112
  .amdhsa_user_sgpr_count 2
  .amdhsa_user_sgpr_kernarg_segment_ptr 1
  .amdhsa_system_sgpr_workgroup_id_x 1
.end_amdhsa_kernel
```
